```python
import torch

def _softmax(x, axis=-1):
    return torch.softmax(x, dim=axis)

def _gelu(x):
    return torch.nn.functional.gelu(x, approximate='tanh')

def _silu(x):
    return torch.nn.functional.silu(x)

def _sigmoid(x):
    return torch.sigmoid(x)

def _layernorm(x, axis=-1, eps=1e-05):
    m = x.mean(dim=axis, keepdim=True)
    v = x.var(dim=axis, keepdim=True, unbiased=False)
    return (x - m) / torch.sqrt(v + eps)

def _scatter_add(tgt, idx, src, axis=0):
    return tgt.clone().index_add_(axis, idx, src)

def _segment_sum(src, seg, n):
    out = torch.zeros((n,) + src.shape[1:], dtype=src.dtype)
    return out.index_add_(0, seg, src)

def _pad(x, pw):
    flat = tuple((v for pair in reversed(pw) for v in pair))
    return torch.nn.functional.pad(x, flat)
kernel_name = 'standalone__ragged_sequences_varlen_flash_attn__ragged'

def setup_inputs():

    _w = lambda a: (lambda t: t.to(torch.bfloat16) if t.is_floating_point() else t)(torch.as_tensor(a))
    cu = torch.tensor([0, 1918, 2650, 4254, 4580, 5262, 6323, 6815, 7972], dtype=torch.int64)
    T = int(cu[-1])
    Hq, Hkv, D = (16, 8, 128)
    assert Hq % Hkv == 0
    return {'q': _w((lambda *s: torch.randn(*s, dtype=torch.bfloat16) * 0.8)(T, Hq, D)), 'k': _w((lambda *s: torch.randn(*s, dtype=torch.bfloat16) * 0.8)(T, Hkv, D)), 'v': _w((lambda *s: torch.randn(*s, dtype=torch.bfloat16) * 0.05)(T, Hkv, D)), 'cu': _w(cu)}

def reference(q, k, v, cu):
    T, Hq, D = q.shape
    Hkv = k.shape[1]
    rep = Hq // Hkv
    scale = D ** (-0.5)
    outs = []
    for i in range(len(cu) - 1):
        s, e = (int(cu[i]), int(cu[i + 1]))
        L = e - s
        qi = q[s:e].clone()
        ki = (lambda x, n, axis: torch.repeat_interleave(x, n, dim=axis))(k[s:e], rep, axis=1)
        vi = (lambda x, n, axis: torch.repeat_interleave(x, n, dim=axis))(v[s:e], rep, axis=1)
        logits = torch.einsum('qhd,khd->hqk', qi, ki) * scale
        ar = torch.arange(L)
        neg = (lambda x, dt: x.to(dt))(ar[None, :] > ar[:, None], logits.dtype) * -1000000000.0
        p = _softmax(logits + neg[None, :, :], axis=-1)
        outs.append(torch.einsum('hqk,khd->qhd', p, vi))
    return torch.concatenate(outs, axis=0)
```

```asm
; @launch grid=(256,1,1) block=(256,1,1) lds=150592
.amdgcn_target "amdgcn-amd-amdhsa--gfx950"
.text
.globl standalone__ragged_sequences_varlen_flash_attn__ragged_kernel
.p2align 8
.type standalone__ragged_sequences_varlen_flash_attn__ragged_kernel,@function
standalone__ragged_sequences_varlen_flash_attn__ragged_kernel:
  s_cmp_ge_u32 s2, 256
  s_cbranch_scc1 Lend2
  s_mov_b32 s56, 0
Lcold:
  s_load_dwordx4 s[60:63], s[0:1], 0
  s_load_dwordx2 s[64:65], s[0:1], 16
  s_load_dwordx2 s[66:67], s[0:1], 32
  v_lshrrev_b32 v26, 6, v0
  s_getpc_b64 s[68:69]
Lpc:
  v_readfirstlane_b32 s55, v26
  s_lshr_b32 s3, s2, 3
  s_and_b32 s70, s2, 1
  s_lshl1_add_u32 s72, s3, s70
  s_lshl2_add_u32 s71, s72, s55
  s_lshl_b32 s71, s71, 8
  s_add_u32 s71, s71, Ltab-Lpc+28672
  s_load_dwordx8 s[44:51], s[68:69], s71
  v_lshrrev_b32 v27, 5, v0
  s_lshl_b32 s3, s3, 10
  v_lshl_add_u32 v27, v27, 7, s3
  global_load_dword a153, v27, s[68:69]
  v_and_b32 v25, 63, v0
  v_lshl_add_u32 v27, v25, 2, s71
  global_load_dword v21, v27, s[68:69]
  v_add_u32 v27, 65536, v27
  global_load_dword v34, v27, s[68:69]
  s_lshl_b32 s72, s72, 8
  s_add_u32 s72, s72, Ltab-Lpc+12288
  v_lshl_add_u32 v27, v25, 2, s72
  global_load_dword v20, v27, s[68:69]
  s_mov_b32 s72, Ltab-Lpc+4096
  v_lshl_add_u32 v24, v0, 4, s72
  global_load_dwordx4 v[12:15], v24, s[68:69] offset:-4096
  global_load_dwordx4 v[16:19], v24, s[68:69]
  v_add_u32 v24, 4096, v24
  global_load_dwordx4 v[8:11], v24, s[68:69]
  v_bfe_u32 v24, v0, 4, 2
  v_and_b32 v25, 15, v0
  v_lshlrev_b32 v25, 4, v25
  v_lshl_add_u32 v24, v24, 15, v25
  s_and_b32 s71, s55, 1
  s_lshr_b32 s72, s55, 1
  s_lshl2_add_u32 s71, s72, s71
  s_lshl3_add_u32 s72, s72, s71
  v_lshl_add_u32 v4, s72, 11, v24
  v_lshl_add_u32 v5, s71, 11, v24
  v_add_u32 v6, 2016, v4
  v_add_u32 v7, 9168, v5
  v_add_u32 v5, 7152, v5
  v_bfe_u32 v24, v0, 4, 2
  v_lshlrev_b32 v26, 6, v24
  v_xor_b32 v25, v25, v26
  v_lshl_add_u32 v25, v24, 12, v25
  v_and_b32 v24, 1, v24
  v_lshl_add_u32 v23, v24, 8, v25
  v_xor_b32 v33, 0x100, v23
  s_mul_i32 s30, s55, 4160
  s_add_u32 s31, s30, 49920
  s_lshl1_add_u32 s76, s30, 117248
  s_and_b32 s70, s2, 6
  s_lshl_b32 s71, s70, 8
  s_lshl_b32 s70, s70, 9
  s_mov_b32 s7, 0x20000
  s_mov_b32 s11, s7
  s_mov_b32 s15, s7
  s_waitcnt lgkmcnt(0)
  s_mov_b32 s14, s46
  s_xor_b32 s38, s44, s70
  s_xor_b32 s39, s45, s70
  s_mov_b64 s[12:13], s[60:61]
  s_mov_b64 s[4:5], s[62:63]
  s_mov_b32 m0, s30
  s_lshr_b32 s6, s46, 1
  s_xor_b32 s24, s51, s71
  buffer_load_dwordx4 v4, s[4:7], s24 offen offset:0  lds
  buffer_load_dwordx4 v5, s[4:7], s24 offen offset:1040  lds
  buffer_load_dwordx4 v6, s[4:7], s24 offen offset:2080  lds
  buffer_load_dwordx4 v7, s[4:7], s24 offen offset:3120  lds
  s_add_u32 m0, s76, 0
  s_add_u32 s62, s38, 0
  buffer_load_dwordx4 v23, s[12:15], s62 offen offset:0 nt lds
  s_add_u32 s62, s38, 15344
  buffer_load_dwordx4 v23, s[12:15], s62 offen offset:1040 nt lds
  s_add_u32 s62, s38, 47072
  buffer_load_dwordx4 v23, s[12:15], s62 offen offset:2080 nt lds
  s_add_u32 s62, s38, 29648
  buffer_load_dwordx4 v23, s[12:15], s62 offen offset:3120 nt lds
  s_add_u32 m0, s76, 4160
  s_add_u32 s62, s38, 0
  buffer_load_dwordx4 v33, s[12:15], s62 offen offset:0 nt lds
  s_add_u32 s62, s38, 15344
  buffer_load_dwordx4 v33, s[12:15], s62 offen offset:1040 nt lds
  s_add_u32 s62, s38, 47072
  buffer_load_dwordx4 v33, s[12:15], s62 offen offset:2080 nt lds
  s_add_u32 s62, s38, 29648
  buffer_load_dwordx4 v33, s[12:15], s62 offen offset:3120 nt lds
  s_mov_b32 s10, s6
  s_mov_b64 s[8:9], s[64:65]
  s_mov_b64 s[16:17], s[66:67]
  v_and_b32 v28, 7, v0
  v_cmp_gt_u32 vcc, 2, v28
  v_mov_b32 v29, s70
  v_mov_b32 v30, s71
  v_cndmask_b32 v29, 0, v29, vcc
  v_cmp_eq_u32 vcc, 7, v28
  s_lshr_b32 s70, s70, 9
  s_nop 0
  v_cndmask_b32 v29, v29, v30, vcc
  s_mov_b32 s58, 0x5f800000
  v_bfe_u32 v24, v0, 4, 2
  v_bfe_u32 v25, v0, 2, 2
  v_mov_b32 v26, 0xb9d83e03
  v_cmp_eq_u32 vcc, v24, v25
  v_and_b32 v32, 3, v0
  v_mul_u32_u24 v32, 0x55, v32
  v_cndmask_b32 v26, 0, v26, vcc
  v_accvgpr_write_b32 a154, v26
  v_accvgpr_write_b32 a155, 0
  v_accvgpr_write_b32 a156, 0
  v_accvgpr_write_b32 a157, v26
  s_mov_b32 s42, 0xf0000
  s_mov_b32 s43, 0xfff00ff
  s_mov_b32 s44, 0x1f0001
  s_mov_b32 s45, 0x1fff01ff
  s_mov_b32 s46, 0x3f0003
  s_mov_b32 s47, 0x3fff03ff
  s_mov_b32 s48, 0x7f0007
  s_mov_b32 s49, 0x7fff07ff
  s_mov_b64 s[52:53], 0
  v_mov_b32 v3, 0xff800000
  v_accvgpr_write_b32 a148, 0
  v_accvgpr_write_b32 a149, 0
  v_accvgpr_write_b32 a150, 0
  v_accvgpr_write_b32 a151, 0
  s_mov_b32 s18, 0
  s_mov_b32 s19, 0x20000
  s_mov_b64 s[20:21], s[4:5]
  s_mov_b32 s22, 0
  s_mov_b32 s23, 0x20000
  s_mov_b64 s[96:97], s[4:5]
  s_mov_b32 s98, 0
  s_mov_b32 s99, 0x20000
  s_cmp_lt_u32 s55, 2
  s_cselect_b64 s[100:101], s[4:5], s[8:9]
  s_cselect_b32 s63, 4294933248, s58
  s_cselect_b32 s63, s63, 4294933248
  s_mul_i32 s41, s55, 4352
  s_add_u32 s41, s41, 50688
  s_add_u32 s64, s63, s76
  v_and_b32 v22, 1, v0
  v_mul_u32_u24 v22, 0xaaaa, v22
  v_add_u32 v22, 0x4444, v22
  s_mov_b32 s54, 0
  s_mov_b32 s32, 3
  s_mov_b32 s26, 0
  s_mov_b32 s27, 16640
  s_mov_b32 s28, 33280
  v_mfma_f32_32x32x16_bf16 v[128:143], a[148:151], a[148:151], 0
  v_mfma_f32_32x32x16_bf16 v[144:159], a[148:151], a[148:151], 0
  v_mfma_f32_32x32x16_bf16 v[160:175], a[148:151], a[148:151], 0
  v_mfma_f32_32x32x16_bf16 v[176:191], a[148:151], a[148:151], 0
  v_mfma_f32_32x32x16_bf16 v[192:207], a[148:151], a[148:151], 0
  v_mfma_f32_32x32x16_bf16 v[208:223], a[148:151], a[148:151], 0
  v_mfma_f32_32x32x16_bf16 v[224:239], a[148:151], a[148:151], 0
  v_mfma_f32_32x32x16_bf16 v[240:255], a[148:151], a[148:151], 0
  v_mfma_f32_32x32x16_bf16 a[128:143], a[148:151], a[148:151], 0
  s_waitcnt vmcnt(12)
  v_xor_b32 v21, v21, v29
  v_xor_b32 v20, s70, v20
  v_and_b32 v28, 1, v34
  v_lshlrev_b32 v28, v28, v30
  v_xor_b32 v34, v34, v28
  v_add_u32 v24, s63, v12
  v_add_u32 v25, s63, v13
  v_add_u32 v26, s63, v14
  v_add_u32 v27, s63, v15
  v_mov_b32 v1, v10
  v_mov_b32 v2, v11
  v_readlane_b32 s78, v20, s32
  v_accvgpr_write_b32 a144, v19
  v_accvgpr_write_b32 a145, v19
  v_accvgpr_write_b32 a146, v19
  v_accvgpr_write_b32 a147, v19
  v_bfe_u32 v19, v0, 1, 1
  s_cmp_eq_u32 s55, 0
  s_cbranch_scc1 Lpad0
  s_cmp_eq_u32 s55, 1
  s_cbranch_scc1 Lpad1
  s_cmp_eq_u32 s55, 2
  s_cbranch_scc1 Lpad2
  s_branch Lpad3
Lpads_back:
  s_add_u32 s62, s54, 6
  v_readlane_b32 s40, v21, s62
  s_add_u32 s62, s54, 3
  v_readlane_b32 s33, v21, s62
  s_add_u32 s62, s54, 4
  v_readlane_b32 s34, v21, s62
  s_add_u32 s62, s54, 5
  v_readlane_b32 s35, v21, s62
  s_add_u32 s62, s54, 7
  v_readlane_b32 s57, v21, s62
  s_add_u32 s54, s54, 8
  s_mov_b32 s18, s14
  s_mov_b64 s[36:37], s[38:39]
  s_waitcnt vmcnt(8)
  s_barrier
  ds_read_b128 a[64:67], v1 offset:0
  ds_read_b128 a[68:71], v1 offset:64
  ds_read_b128 a[72:75], v1 offset:128
  ds_read_b128 a[76:79], v1 offset:192
  ds_read_b128 a[80:83], v1 offset:256
  ds_read_b128 a[84:87], v1 offset:320
  ds_read_b128 a[88:91], v1 offset:384
  ds_read_b128 a[92:95], v1 offset:448
  s_add_u32 m0, s64, 0
  s_add_u32 s62, s39, 0
  buffer_load_dwordx4 v23, s[12:15], s62 offen offset:0 nt lds
  s_add_u32 s62, s39, 15344
  buffer_load_dwordx4 v23, s[12:15], s62 offen offset:1040 nt lds
  s_add_u32 s62, s39, 47072
  buffer_load_dwordx4 v23, s[12:15], s62 offen offset:2080 nt lds
  s_add_u32 s62, s39, 29648
  buffer_load_dwordx4 v23, s[12:15], s62 offen offset:3120 nt lds
  s_waitcnt vmcnt(8)
  ds_read_b128 v[72:75], v12 offset:0
  ds_read_b128 v[76:79], v13 offset:0
  ds_read_b128 v[88:91], v14 offset:0
  ds_read_b128 v[92:95], v15 offset:0
  s_add_u32 m0, s64, 4160
  s_add_u32 s62, s39, 0
  buffer_load_dwordx4 v33, s[12:15], s62 offen offset:0 nt lds
  s_add_u32 s62, s39, 15344
  buffer_load_dwordx4 v33, s[12:15], s62 offen offset:1040 nt lds
  s_add_u32 s62, s39, 47072
  buffer_load_dwordx4 v33, s[12:15], s62 offen offset:2080 nt lds
  s_add_u32 s62, s39, 29648
  buffer_load_dwordx4 v33, s[12:15], s62 offen offset:3120 nt lds
  s_waitcnt lgkmcnt(0)
  v_smfmac_f32_16x16x32_bf16 v[144:147], a[154:155], v[72:75], v32
  v_readlane_b32 s38, v21, s54
  v_smfmac_f32_16x16x32_bf16 v[148:151], a[156:157], v[72:75], v32
  s_add_u32 s62, s54, 1
  v_readlane_b32 s39, v21, s62
  v_smfmac_f32_16x16x32_bf16 v[152:155], a[154:155], v[76:79], v32
  s_add_u32 s62, s54, 2
  v_readlane_b32 s14, v21, s62
  v_smfmac_f32_16x16x32_bf16 v[156:159], a[156:157], v[76:79], v32
  s_nop 2
  v_smfmac_f32_16x16x32_bf16 v[176:179], a[154:155], v[88:91], v32
  v_cvt_pk_bf16_f32 v144, v144, v145
  v_cvt_pk_bf16_f32 v145, v146, v147
  v_smfmac_f32_16x16x32_bf16 v[180:183], a[156:157], v[88:91], v32
  v_cvt_pk_bf16_f32 v146, v148, v149
  v_cvt_pk_bf16_f32 v147, v150, v151
  v_smfmac_f32_16x16x32_bf16 v[184:187], a[154:155], v[92:95], v32
  v_accvgpr_write_b32 a0, v144
  v_accvgpr_write_b32 a1, v145
  v_smfmac_f32_16x16x32_bf16 v[188:191], a[156:157], v[92:95], v32
  v_accvgpr_write_b32 a2, v146
  v_accvgpr_write_b32 a3, v147
  v_cvt_pk_bf16_f32 v152, v152, v153
  v_cvt_pk_bf16_f32 v153, v154, v155
  v_mfma_f32_16x16x32_bf16 v[64:67], a[64:67], a[0:3], 0
  v_cvt_pk_bf16_f32 v154, v156, v157
  v_cvt_pk_bf16_f32 v155, v158, v159
  v_mfma_f32_16x16x32_bf16 v[68:71], a[80:83], a[0:3], 0
  v_accvgpr_write_b32 a4, v152
  v_accvgpr_write_b32 a5, v153
  v_accvgpr_write_b32 a6, v154
  v_accvgpr_write_b32 a7, v155
  v_cvt_pk_bf16_f32 v176, v176, v177
  v_cvt_pk_bf16_f32 v177, v178, v179
  v_mfma_f32_16x16x32_bf16 v[64:67], a[68:71], a[4:7], v[64:67]
  v_cvt_pk_bf16_f32 v178, v180, v181
  v_cvt_pk_bf16_f32 v179, v182, v183
  v_mfma_f32_16x16x32_bf16 v[68:71], a[84:87], a[4:7], v[68:71]
  v_accvgpr_write_b32 a8, v176
  v_accvgpr_write_b32 a9, v177
  v_accvgpr_write_b32 a10, v178
  v_accvgpr_write_b32 a11, v179
  v_cvt_pk_bf16_f32 v184, v184, v185
  v_cvt_pk_bf16_f32 v185, v186, v187
  v_mfma_f32_16x16x32_bf16 v[64:67], a[72:75], a[8:11], v[64:67]
  v_cvt_pk_bf16_f32 v186, v188, v189
  v_cvt_pk_bf16_f32 v187, v190, v191
  v_mfma_f32_16x16x32_bf16 v[68:71], a[88:91], a[8:11], v[68:71]
  v_accvgpr_write_b32 a12, v184
  v_accvgpr_write_b32 a13, v185
  v_accvgpr_write_b32 a14, v186
  v_accvgpr_write_b32 a15, v187
  s_nop 1
  v_mfma_f32_16x16x32_bf16 v[64:67], a[76:79], a[12:15], v[64:67]
  s_nop 2
  v_mfma_f32_16x16x32_bf16 v[68:71], a[92:95], a[12:15], v[68:71]
  s_waitcnt vmcnt(8)
  ds_read_b128 v[40:43], v12 offset:4160
  ds_read_b128 v[44:47], v13 offset:4160
  ds_read_b128 v[48:51], v14 offset:4160
  ds_read_b128 v[52:55], v15 offset:4160
  s_mov_b32 s25, s24
  s_add_u32 m0, s31, 0
  s_add_u32 s24, s24, 131072
  buffer_load_dwordx4 v4, s[8:11], s25 offen offset:0  lds
  buffer_load_dwordx4 v5, s[8:11], s25 offen offset:1040  lds
  buffer_load_dwordx4 v6, s[8:11], s25 offen offset:2080  lds
  buffer_load_dwordx4 v7, s[8:11], s25 offen offset:3120  lds
  s_waitcnt lgkmcnt(0)
  v_smfmac_f32_16x16x32_bf16 v[208:211], a[154:155], v[40:43], v32
  s_nop 2
  v_smfmac_f32_16x16x32_bf16 v[212:215], a[156:157], v[40:43], v32
  s_nop 2
  v_smfmac_f32_16x16x32_bf16 v[216:219], a[154:155], v[44:47], v32
  s_nop 2
  v_smfmac_f32_16x16x32_bf16 v[220:223], a[156:157], v[44:47], v32
  v_cvt_pk_bf16_f32 v208, v208, v209
  v_cvt_pk_bf16_f32 v209, v210, v211
  v_smfmac_f32_16x16x32_bf16 v[240:243], a[154:155], v[48:51], v32
  v_cvt_pk_bf16_f32 v210, v212, v213
  v_cvt_pk_bf16_f32 v211, v214, v215
  v_smfmac_f32_16x16x32_bf16 v[244:247], a[156:157], v[48:51], v32
  v_accvgpr_write_b32 a16, v208
  v_accvgpr_write_b32 a17, v209
  v_smfmac_f32_16x16x32_bf16 v[248:251], a[154:155], v[52:55], v32
  v_accvgpr_write_b32 a18, v210
  v_accvgpr_write_b32 a19, v211
  v_smfmac_f32_16x16x32_bf16 v[252:255], a[156:157], v[52:55], v32
  v_cvt_pk_bf16_f32 v216, v216, v217
  v_cvt_pk_bf16_f32 v217, v218, v219
  v_mfma_f32_16x16x32_bf16 v[72:75], a[64:67], a[16:19], 0
  v_cvt_pk_bf16_f32 v218, v220, v221
  v_cvt_pk_bf16_f32 v219, v222, v223
  v_mfma_f32_16x16x32_bf16 v[76:79], a[80:83], a[16:19], 0
  v_accvgpr_write_b32 a20, v216
  v_accvgpr_write_b32 a21, v217
  v_accvgpr_write_b32 a22, v218
  v_accvgpr_write_b32 a23, v219
  v_cvt_pk_bf16_f32 v240, v240, v241
  v_cvt_pk_bf16_f32 v241, v242, v243
  v_mfma_f32_16x16x32_bf16 v[72:75], a[68:71], a[20:23], v[72:75]
  v_cvt_pk_bf16_f32 v242, v244, v245
  v_cvt_pk_bf16_f32 v243, v246, v247
  v_mfma_f32_16x16x32_bf16 v[76:79], a[84:87], a[20:23], v[76:79]
  v_accvgpr_write_b32 a24, v240
  v_accvgpr_write_b32 a25, v241
  v_accvgpr_write_b32 a26, v242
  v_accvgpr_write_b32 a27, v243
  v_cvt_pk_bf16_f32 v248, v248, v249
  v_cvt_pk_bf16_f32 v249, v250, v251
  v_mfma_f32_16x16x32_bf16 v[72:75], a[72:75], a[24:27], v[72:75]
  v_cvt_pk_bf16_f32 v250, v252, v253
  v_cvt_pk_bf16_f32 v251, v254, v255
  v_mfma_f32_16x16x32_bf16 v[76:79], a[88:91], a[24:27], v[76:79]
  v_accvgpr_write_b32 a28, v248
  v_accvgpr_write_b32 a29, v249
  v_accvgpr_write_b32 a30, v250
  v_accvgpr_write_b32 a31, v251
  s_nop 1
  v_mfma_f32_16x16x32_bf16 v[72:75], a[76:79], a[28:31], v[72:75]
  v_mfma_f32_16x16x32_bf16 v[76:79], a[92:95], a[28:31], v[76:79]
  s_cmp_eq_u32 s33, 0
  s_cbranch_scc1 LmPc
LmPc_back:
  s_nop 0
  v_max3_f32 v28, v64, v65, v66
  v_max3_f32 v28, v28, v67, v68
  v_max3_f32 v28, v28, v69, v70
  v_max_f32 v28, v28, v71
  v_max3_f32 v30, v72, v73, v74
  v_max3_f32 v30, v30, v75, v76
  v_max3_f32 v30, v30, v77, v78
  v_max_f32 v30, v30, v79
  s_cmp_lg_u32 s56, 0
  s_cbranch_scc1 LsafeAc
LsafeAc_back:
  v_permlane32_swap_b32 v28, v30
  v_max_f32 v28, v28, v30
  v_mov_b32 v30, v28
  s_nop 1
  v_permlane16_swap_b32 v28, v30
  v_max_f32 v28, v28, v30
  v_mov_b32 v30, v28
  s_nop 1
  v_permlane32_swap_b32 v28, v30
  v_pk_mul_f32 v[48:49], v[28:29], -1.0 op_sel_hi:[0,0]
  v_pk_mul_f32 v[50:51], v[28:29], -1.0 op_sel_hi:[0,0]
  v_pk_mul_f32 v[52:53], v[30:31], -1.0 op_sel_hi:[0,0]
  v_pk_mul_f32 v[54:55], v[30:31], -1.0 op_sel_hi:[0,0]
  v_pk_add_f32 v[64:65], v[64:65], v[48:49]
  v_pk_add_f32 v[66:67], v[66:67], v[48:49]
  v_pk_add_f32 v[68:69], v[68:69], v[48:49]
  v_pk_add_f32 v[70:71], v[70:71], v[48:49]
  v_pk_add_f32 v[72:73], v[72:73], v[52:53]
  v_pk_add_f32 v[74:75], v[74:75], v[52:53]
  v_pk_add_f32 v[76:77], v[76:77], v[52:53]
  v_pk_add_f32 v[78:79], v[78:79], v[52:53]
  v_mfma_f32_32x32x16_bf16 v[144:159], a[148:151], a[148:151], 0
  v_exp_f32 v64, v64
  v_exp_f32 v65, v65
  v_exp_f32 v66, v66
  v_exp_f32 v67, v67
  v_mfma_f32_32x32x16_bf16 v[176:191], a[148:151], a[148:151], 0
  v_exp_f32 v68, v68
  v_exp_f32 v69, v69
  v_exp_f32 v70, v70
  v_exp_f32 v71, v71
  v_mfma_f32_32x32x16_bf16 v[208:223], a[148:151], a[148:151], 0
  v_exp_f32 v72, v72
  v_exp_f32 v73, v73
  v_exp_f32 v74, v74
  v_exp_f32 v75, v75
  v_mfma_f32_32x32x16_bf16 v[240:255], a[148:151], a[148:151], 0
  v_exp_f32 v76, v76
  v_exp_f32 v77, v77
  v_exp_f32 v78, v78
  v_exp_f32 v79, v79
  v_cvt_pk_bf16_f32 v64, v64, v65
  v_cvt_pk_bf16_f32 v65, v66, v67
  v_cvt_pk_bf16_f32 v66, v68, v69
  v_cvt_pk_bf16_f32 v67, v70, v71
  v_cvt_pk_bf16_f32 v68, v72, v73
  v_cvt_pk_bf16_f32 v69, v74, v75
  v_cvt_pk_bf16_f32 v70, v76, v77
  v_cvt_pk_bf16_f32 v71, v78, v79
  s_waitcnt vmcnt(8)
  ds_read_b128 v[96:99], v24 offset:0
  ds_read_b128 v[100:103], v25 offset:0
  ds_read_b128 v[104:107], v26 offset:0
  ds_read_b128 v[108:111], v27 offset:0
  s_add_u32 m0, s30, 16640
  s_nop 0
  buffer_load_dwordx4 v4, s[4:7], s24 offen offset:0  lds
  buffer_load_dwordx4 v5, s[4:7], s24 offen offset:1040  lds
  buffer_load_dwordx4 v6, s[4:7], s24 offen offset:2080  lds
  buffer_load_dwordx4 v7, s[4:7], s24 offen offset:3120  lds
  s_waitcnt lgkmcnt(0)
  v_smfmac_f32_16x16x32_bf16 v[128:131], a[154:155], v[96:99], v32
  s_nop 2
  v_smfmac_f32_16x16x32_bf16 v[132:135], a[156:157], v[96:99], v32
  s_nop 2
  v_smfmac_f32_16x16x32_bf16 v[136:139], a[154:155], v[100:103], v32
  s_nop 2
  v_smfmac_f32_16x16x32_bf16 v[140:143], a[156:157], v[100:103], v32
  v_cvt_pk_bf16_f32 v128, v128, v129
  v_cvt_pk_bf16_f32 v129, v130, v131
  v_smfmac_f32_16x16x32_bf16 v[160:163], a[154:155], v[104:107], v32
  v_cvt_pk_bf16_f32 v130, v132, v133
  v_cvt_pk_bf16_f32 v131, v134, v135
  v_smfmac_f32_16x16x32_bf16 v[164:167], a[156:157], v[104:107], v32
  v_accvgpr_write_b32 a32, v128
  v_accvgpr_write_b32 a33, v129
  v_smfmac_f32_16x16x32_bf16 v[168:171], a[154:155], v[108:111], v32
  v_accvgpr_write_b32 a34, v130
  v_accvgpr_write_b32 a35, v131
  v_smfmac_f32_16x16x32_bf16 v[172:175], a[156:157], v[108:111], v32
  v_cvt_pk_bf16_f32 v136, v136, v137
  v_cvt_pk_bf16_f32 v137, v138, v139
  v_mfma_f32_16x16x32_bf16 v[96:99], a[64:67], a[32:35], 0
  v_cvt_pk_bf16_f32 v138, v140, v141
  v_cvt_pk_bf16_f32 v139, v142, v143
  v_mfma_f32_16x16x32_bf16 v[100:103], a[80:83], a[32:35], 0
  v_accvgpr_write_b32 a36, v136
  v_accvgpr_write_b32 a37, v137
  v_accvgpr_write_b32 a38, v138
  v_accvgpr_write_b32 a39, v139
  v_cvt_pk_bf16_f32 v160, v160, v161
  v_cvt_pk_bf16_f32 v161, v162, v163
  v_mfma_f32_16x16x32_bf16 v[96:99], a[68:71], a[36:39], v[96:99]
  v_cvt_pk_bf16_f32 v162, v164, v165
  v_cvt_pk_bf16_f32 v163, v166, v167
  v_mfma_f32_16x16x32_bf16 v[100:103], a[84:87], a[36:39], v[100:103]
  v_accvgpr_write_b32 a40, v160
  v_accvgpr_write_b32 a41, v161
  v_accvgpr_write_b32 a42, v162
  v_accvgpr_write_b32 a43, v163
  v_cvt_pk_bf16_f32 v168, v168, v169
  v_cvt_pk_bf16_f32 v169, v170, v171
  v_mfma_f32_16x16x32_bf16 v[96:99], a[72:75], a[40:43], v[96:99]
  v_cvt_pk_bf16_f32 v170, v172, v173
  v_cvt_pk_bf16_f32 v171, v174, v175
  v_mfma_f32_16x16x32_bf16 v[100:103], a[88:91], a[40:43], v[100:103]
  v_accvgpr_write_b32 a44, v168
  v_accvgpr_write_b32 a45, v169
  v_accvgpr_write_b32 a46, v170
  v_accvgpr_write_b32 a47, v171
  s_nop 1
  v_mfma_f32_16x16x32_bf16 v[96:99], a[76:79], a[44:47], v[96:99]
  s_nop 2
  v_mfma_f32_16x16x32_bf16 v[100:103], a[92:95], a[44:47], v[100:103]
  s_waitcnt vmcnt(8)
  ds_read_b128 v[112:115], v24 offset:4160
  ds_read_b128 v[116:119], v25 offset:4160
  ds_read_b128 v[120:123], v26 offset:4160
  ds_read_b128 v[124:127], v27 offset:4160
  s_mov_b32 s25, s24
  s_add_u32 m0, s31, 16640
  s_add_u32 s24, s24, 131072
  buffer_load_dwordx4 v4, s[8:11], s25 offen offset:0  lds
  buffer_load_dwordx4 v5, s[8:11], s25 offen offset:1040  lds
  buffer_load_dwordx4 v6, s[8:11], s25 offen offset:2080  lds
  buffer_load_dwordx4 v7, s[8:11], s25 offen offset:3120  lds
  s_waitcnt lgkmcnt(0)
  v_smfmac_f32_16x16x32_bf16 v[192:195], a[154:155], v[112:115], v32
  s_nop 2
  v_smfmac_f32_16x16x32_bf16 v[196:199], a[156:157], v[112:115], v32
  s_nop 2
  v_smfmac_f32_16x16x32_bf16 v[200:203], a[154:155], v[116:119], v32
  s_nop 2
  v_smfmac_f32_16x16x32_bf16 v[204:207], a[156:157], v[116:119], v32
  v_cvt_pk_bf16_f32 v192, v192, v193
  v_cvt_pk_bf16_f32 v193, v194, v195
  v_smfmac_f32_16x16x32_bf16 v[224:227], a[154:155], v[120:123], v32
  v_cvt_pk_bf16_f32 v194, v196, v197
  v_cvt_pk_bf16_f32 v195, v198, v199
  v_smfmac_f32_16x16x32_bf16 v[228:231], a[156:157], v[120:123], v32
  v_accvgpr_write_b32 a48, v192
  v_accvgpr_write_b32 a49, v193
  v_smfmac_f32_16x16x32_bf16 v[232:235], a[154:155], v[124:127], v32
  v_accvgpr_write_b32 a50, v194
  v_accvgpr_write_b32 a51, v195
  v_smfmac_f32_16x16x32_bf16 v[236:239], a[156:157], v[124:127], v32
  v_cvt_pk_bf16_f32 v200, v200, v201
  v_cvt_pk_bf16_f32 v201, v202, v203
  v_mfma_f32_16x16x32_bf16 v[104:107], a[64:67], a[48:51], 0
  s_add_u32 m0, s30, 33280
  s_nop 0
  buffer_load_dwordx4 v4, s[4:7], s24 offen offset:0  lds
  v_mfma_f32_16x16x32_bf16 v[108:111], a[80:83], a[48:51], 0
  v_cvt_pk_bf16_f32 v202, v204, v205
  v_cvt_pk_bf16_f32 v203, v206, v207
  v_mfma_f32_32x32x16_bf16 v[128:143], a[148:151], a[148:151], 0
  v_accvgpr_write_b32 a52, v200
  v_accvgpr_write_b32 a53, v201
  v_accvgpr_write_b32 a54, v202
  v_accvgpr_write_b32 a55, v203
  v_cvt_pk_bf16_f32 v224, v224, v225
  v_cvt_pk_bf16_f32 v225, v226, v227
  v_mfma_f32_16x16x32_bf16 v[104:107], a[68:71], a[52:55], v[104:107]
  buffer_load_dwordx4 v5, s[4:7], s24 offen offset:1040  lds
  v_mfma_f32_16x16x32_bf16 v[108:111], a[84:87], a[52:55], v[108:111]
  v_cvt_pk_bf16_f32 v226, v228, v229
  v_cvt_pk_bf16_f32 v227, v230, v231
  v_mfma_f32_32x32x16_bf16 v[160:175], a[148:151], a[148:151], 0
  v_accvgpr_write_b32 a56, v224
  v_accvgpr_write_b32 a57, v225
  v_accvgpr_write_b32 a58, v226
  v_accvgpr_write_b32 a59, v227
  v_cvt_pk_bf16_f32 v232, v232, v233
  v_cvt_pk_bf16_f32 v233, v234, v235
  v_mfma_f32_16x16x32_bf16 v[104:107], a[72:75], a[56:59], v[104:107]
  buffer_load_dwordx4 v6, s[4:7], s24 offen offset:2080  lds
  v_mfma_f32_16x16x32_bf16 v[108:111], a[88:91], a[56:59], v[108:111]
  v_cvt_pk_bf16_f32 v234, v236, v237
  v_cvt_pk_bf16_f32 v235, v238, v239
  v_mfma_f32_32x32x16_bf16 v[192:207], a[148:151], a[148:151], 0
  v_accvgpr_write_b32 a60, v232
  v_accvgpr_write_b32 a61, v233
  v_accvgpr_write_b32 a62, v234
  v_accvgpr_write_b32 a63, v235
  v_max3_f32 v28, v96, v97, v98
  v_max3_f32 v28, v28, v99, v100
  v_mfma_f32_16x16x32_bf16 v[104:107], a[76:79], a[60:63], v[104:107]
  buffer_load_dwordx4 v7, s[4:7], s24 offen offset:3120  lds
  v_mfma_f32_16x16x32_bf16 v[108:111], a[92:95], a[60:63], v[108:111]
  v_max3_f32 v28, v28, v101, v102
  v_max_f32 v28, v28, v103
  v_mfma_f32_32x32x16_bf16 v[224:239], a[148:151], a[148:151], 0
  ds_read_b128 a[64:67], v1 offset:512
  ds_read_b128 a[68:71], v1 offset:576
  ds_read_b128 a[72:75], v1 offset:640
  ds_read_b128 a[76:79], v1 offset:704
  ds_read_b128 a[80:83], v1 offset:768
  ds_read_b128 a[84:87], v1 offset:832
  ds_read_b128 a[88:91], v1 offset:896
  ds_read_b128 a[92:95], v1 offset:960
  v_max3_f32 v30, v104, v105, v106
  v_max3_f32 v30, v30, v107, v108
  v_max3_f32 v30, v30, v109, v110
  v_max_f32 v30, v30, v111
  s_cmp_lg_u32 s56, 0
  s_cbranch_scc1 LsafeBc
LsafeBc_back:
  v_permlane32_swap_b32 v28, v30
  v_max_f32 v28, v28, v30
  v_mov_b32 v30, v28
  s_nop 1
  v_permlane16_swap_b32 v28, v30
  v_max_f32 v28, v28, v30
  v_mov_b32 v30, v28
  s_nop 1
  v_permlane32_swap_b32 v28, v30
  v_pk_mul_f32 v[56:57], v[28:29], -1.0 op_sel_hi:[0,0]
  v_pk_mul_f32 v[58:59], v[28:29], -1.0 op_sel_hi:[0,0]
  v_pk_mul_f32 v[60:61], v[30:31], -1.0 op_sel_hi:[0,0]
  v_pk_mul_f32 v[62:63], v[30:31], -1.0 op_sel_hi:[0,0]
  v_pk_add_f32 v[96:97], v[96:97], v[56:57]
  v_pk_add_f32 v[98:99], v[98:99], v[56:57]
  v_pk_add_f32 v[100:101], v[100:101], v[56:57]
  v_pk_add_f32 v[102:103], v[102:103], v[56:57]
  v_pk_add_f32 v[104:105], v[104:105], v[60:61]
  v_pk_add_f32 v[106:107], v[106:107], v[60:61]
  v_pk_add_f32 v[108:109], v[108:109], v[60:61]
  v_pk_add_f32 v[110:111], v[110:111], v[60:61]
  s_mov_b32 s73, 1
  s_bitcmp1_b32 s40, 9
  s_waitcnt vmcnt(8) lgkmcnt(0)
  s_cbranch_scc1 LcoldE
  s_bitcmp1_b32 s40, 4
  s_cselect_b32 s62, 3, s33
  s_sub_u32 s73, s62, 2
  s_bitcmp1_b32 s55, 0
  s_cbranch_scc0 LF0w0
  s_branch LF0w1
LcoldE:
  s_add_u32 m0, s76, 0
  s_add_u32 s62, s38, 0
  buffer_load_dwordx4 v23, s[12:15], s62 offen offset:0 nt lds
  s_add_u32 s62, s38, 15344
  buffer_load_dwordx4 v23, s[12:15], s62 offen offset:1040 nt lds
  s_add_u32 s62, s38, 47072
  buffer_load_dwordx4 v23, s[12:15], s62 offen offset:2080 nt lds
  s_add_u32 s62, s38, 29648
  buffer_load_dwordx4 v23, s[12:15], s62 offen offset:3120 nt lds
  s_add_u32 m0, s76, 4160
  s_add_u32 s62, s38, 0
  buffer_load_dwordx4 v33, s[12:15], s62 offen offset:0 nt lds
  s_add_u32 s62, s38, 15344
  buffer_load_dwordx4 v33, s[12:15], s62 offen offset:1040 nt lds
  s_add_u32 s62, s38, 47072
  buffer_load_dwordx4 v33, s[12:15], s62 offen offset:2080 nt lds
  s_add_u32 s62, s38, 29648
  buffer_load_dwordx4 v33, s[12:15], s62 offen offset:3120 nt lds
  s_cmp_gt_u32 s33, 1
  s_cbranch_scc0 LSF0
  s_bitcmp1_b32 s55, 0
  s_cbranch_scc0 LF0w0
  s_branch LF0w1
LmPc:
  s_bitcmp1_b32 s40, 0
  s_cbranch_scc1 LmPc_odd
  v_cndmask_b32 v64, v64, v3, s[42:43]
  v_cndmask_b32 v65, v65, v3, s[44:45]
  v_cndmask_b32 v66, v66, v3, s[46:47]
  v_cndmask_b32 v67, v67, v3, s[48:49]
  v_mov_b32 v68, v3
  v_mov_b32 v69, v3
  v_mov_b32 v70, v3
  v_mov_b32 v71, v3
  v_cndmask_b32 v72, v72, v3, s[42:43]
  v_cndmask_b32 v73, v73, v3, s[44:45]
  v_cndmask_b32 v74, v74, v3, s[46:47]
  v_cndmask_b32 v75, v75, v3, s[48:49]
  v_mov_b32 v76, v3
  v_mov_b32 v77, v3
  v_mov_b32 v78, v3
  v_mov_b32 v79, v3
  s_branch LmPc_back
LmPc_odd:
  v_cndmask_b32 v68, v68, v3, s[42:43]
  v_cndmask_b32 v69, v69, v3, s[44:45]
  v_cndmask_b32 v70, v70, v3, s[46:47]
  v_cndmask_b32 v71, v71, v3, s[48:49]
  v_cndmask_b32 v76, v76, v3, s[42:43]
  v_cndmask_b32 v77, v77, v3, s[44:45]
  v_cndmask_b32 v78, v78, v3, s[46:47]
  v_cndmask_b32 v79, v79, v3, s[48:49]
  s_branch LmPc_back
Lpad0:
  s_branch Lpad4
  .p2align 5
LE0:
  v_mfma_f32_16x16x32_bf16 v[80:83], a[64:67], a[0:3], v[48:51]
  s_barrier
  v_mfma_f32_16x16x32_bf16 v[80:83], a[68:71], a[4:7], v[80:83]
  s_mov_b32 s25, s24
  v_exp_f32 v96, v96
  v_mfma_f32_16x16x32_bf16 v[80:83], a[72:75], a[8:11], v[80:83]
  s_mov_b32 s10, s6
  ds_read_b64_tr_b16 a[96:97], v2 offset:0
  ds_read_b64_tr_b16 a[98:99], v2 offset:256
  v_mfma_f32_16x16x32_bf16 v[80:83], a[76:79], a[12:15], v[80:83]
  s_and_b32 s61, s78, 0xffff
  v_exp_f32 v97, v97
  v_mfma_f32_16x16x32_bf16 v[88:91], a[64:67], a[16:19], v[52:55]
  s_lshl_b32 s24, s61, 8
  ds_read_b64_tr_b16 a[100:101], v2 offset:16
  ds_read_b64_tr_b16 a[102:103], v2 offset:272
  v_mfma_f32_16x16x32_bf16 v[88:91], a[68:71], a[20:23], v[88:91]
  s_lshr_b32 s61, s78, 16
  v_exp_f32 v98, v98
  v_mfma_f32_16x16x32_bf16 v[88:91], a[72:75], a[24:27], v[88:91]
  s_lshl_b32 s6, s61, 11
  ds_read_b64_tr_b16 a[104:105], v2 offset:32
  ds_read_b64_tr_b16 a[106:107], v2 offset:288
  v_mfma_f32_16x16x32_bf16 v[88:91], a[76:79], a[28:31], v[88:91]
  s_add_u32 m0, s26, s30
  v_exp_f32 v99, v99
  v_mfma_f32_16x16x32_bf16 v[84:87], a[80:83], a[0:3], v[48:51]
  s_add_u32 s32, s32, 1
  ds_read_b64_tr_b16 a[108:109], v2 offset:48
  ds_read_b64_tr_b16 a[110:111], v2 offset:304
  v_mfma_f32_16x16x32_bf16 v[84:87], a[84:87], a[4:7], v[84:87]
  v_exp_f32 v100, v100
  v_mfma_f32_16x16x32_bf16 v[84:87], a[88:91], a[8:11], v[84:87]
  ds_read_b64_tr_b16 a[112:113], v2 offset:64
  ds_read_b64_tr_b16 a[114:115], v2 offset:320
  v_mfma_f32_16x16x32_bf16 v[84:87], a[92:95], a[12:15], v[84:87]
  v_exp_f32 v101, v101
  v_mfma_f32_16x16x32_bf16 v[92:95], a[80:83], a[16:19], v[52:55]
  ds_read_b64_tr_b16 a[116:117], v2 offset:80
  ds_read_b64_tr_b16 a[118:119], v2 offset:336
  v_mfma_f32_16x16x32_bf16 v[92:95], a[84:87], a[20:23], v[92:95]
  v_exp_f32 v102, v102
  v_mfma_f32_16x16x32_bf16 v[92:95], a[88:91], a[24:27], v[92:95]
  ds_read_b64_tr_b16 a[120:121], v2 offset:96
  ds_read_b64_tr_b16 a[122:123], v2 offset:352
  v_mfma_f32_16x16x32_bf16 v[92:95], a[92:95], a[28:31], v[92:95]
  v_exp_f32 v103, v103
  v_mfma_f32_16x16x32_bf16 v[112:115], a[64:67], a[32:35], v[56:59]
  ds_read_b64_tr_b16 a[124:125], v2 offset:112
  ds_read_b64_tr_b16 a[126:127], v2 offset:368
  v_mfma_f32_16x16x32_bf16 v[112:115], a[68:71], a[36:39], v[112:115]
  v_exp_f32 v104, v104
  v_mfma_f32_16x16x32_bf16 v[112:115], a[72:75], a[40:43], v[112:115]
  v_add_u32 v1, s27, v10
  v_cvt_pk_bf16_f32 v96, v96, v97
  v_mfma_f32_16x16x32_bf16 v[112:115], a[76:79], a[44:47], v[112:115]
  v_exp_f32 v105, v105
  v_mfma_f32_16x16x32_bf16 v[120:123], a[64:67], a[48:51], v[60:63]
  v_cvt_pk_bf16_f32 v97, v98, v99
  v_cvt_pk_bf16_f32 v98, v100, v101
  v_mfma_f32_16x16x32_bf16 v[120:123], a[68:71], a[52:55], v[120:123]
  v_exp_f32 v106, v106
  v_mfma_f32_16x16x32_bf16 v[120:123], a[72:75], a[56:59], v[120:123]
  buffer_load_dwordx4 v4, s[4:7], s24 offen offset:0  lds
  v_mfma_f32_16x16x32_bf16 v[120:123], a[76:79], a[60:63], v[120:123]
  v_exp_f32 v107, v107
  v_mfma_f32_16x16x32_bf16 v[116:119], a[80:83], a[32:35], v[56:59]
  v_cvt_pk_bf16_f32 v99, v102, v103
  v_cvt_pk_bf16_f32 v100, v104, v105
  v_mfma_f32_16x16x32_bf16 v[116:119], a[84:87], a[36:39], v[116:119]
  v_exp_f32 v108, v108
  v_mfma_f32_16x16x32_bf16 v[116:119], a[88:91], a[40:43], v[116:119]
  v_cvt_pk_bf16_f32 v101, v106, v107
  v_mfma_f32_16x16x32_bf16 v[116:119], a[92:95], a[44:47], v[116:119]
  v_exp_f32 v109, v109
  v_mfma_f32_16x16x32_bf16 v[124:127], a[80:83], a[48:51], v[60:63]
  buffer_load_dwordx4 v5, s[4:7], s24 offen offset:1040  lds
  v_mfma_f32_16x16x32_bf16 v[124:127], a[84:87], a[52:55], v[124:127]
  v_exp_f32 v110, v110
  v_mfma_f32_16x16x32_bf16 v[124:127], a[88:91], a[56:59], v[124:127]
  v_cvt_pk_bf16_f32 v102, v108, v109
  v_mfma_f32_16x16x32_bf16 v[124:127], a[92:95], a[60:63], v[124:127]
  s_waitcnt lgkmcnt(0)
  v_exp_f32 v111, v111
  v_mfma_f32_16x16x32_bf16 v[128:131], a[96:99], v[64:67], v[128:131]
  ds_read_b128 a[64:67], v1 offset:0
  ds_read_b128 a[68:71], v1 offset:64
  v_mfma_f32_16x16x32_bf16 v[160:163], a[96:99], v[68:71], v[160:163]
  v_exp_f32 v80, v80
  v_mfma_f32_16x16x32_bf16 v[132:135], a[100:103], v[64:67], v[132:135]
  ds_read_b128 a[72:75], v1 offset:128
  ds_read_b128 a[76:79], v1 offset:192
  v_mfma_f32_16x16x32_bf16 v[164:167], a[100:103], v[68:71], v[164:167]
  v_exp_f32 v81, v81
  v_mfma_f32_16x16x32_bf16 v[136:139], a[104:107], v[64:67], v[136:139]
  ds_read_b128 a[80:83], v1 offset:256
  ds_read_b128 a[84:87], v1 offset:320
  v_mfma_f32_16x16x32_bf16 v[168:171], a[104:107], v[68:71], v[168:171]
  v_exp_f32 v82, v82
  v_mfma_f32_16x16x32_bf16 v[140:143], a[108:111], v[64:67], v[140:143]
  ds_read_b128 a[88:91], v1 offset:384
  ds_read_b128 a[92:95], v1 offset:448
  v_mfma_f32_16x16x32_bf16 v[172:175], a[108:111], v[68:71], v[172:175]
  v_exp_f32 v83, v83
  v_mfma_f32_16x16x32_bf16 v[144:147], a[112:115], v[64:67], v[144:147]
  buffer_load_dwordx4 v6, s[4:7], s24 offen offset:2080  lds
  v_mfma_f32_16x16x32_bf16 v[176:179], a[112:115], v[68:71], v[176:179]
  v_exp_f32 v84, v84
  v_mfma_f32_16x16x32_bf16 v[148:151], a[116:119], v[64:67], v[148:151]
  v_cvt_pk_bf16_f32 v103, v110, v111
  v_cvt_pk_bf16_f32 v80, v80, v81
  v_mfma_f32_16x16x32_bf16 v[180:183], a[116:119], v[68:71], v[180:183]
  v_exp_f32 v85, v85
  v_mfma_f32_16x16x32_bf16 v[152:155], a[120:123], v[64:67], v[152:155]
  buffer_load_dwordx4 v7, s[4:7], s24 offen offset:3120  lds
  v_mfma_f32_16x16x32_bf16 v[184:187], a[120:123], v[68:71], v[184:187]
  v_exp_f32 v86, v86
  v_mfma_f32_16x16x32_bf16 v[156:159], a[124:127], v[64:67], v[156:159]
  v_cvt_pk_bf16_f32 v81, v82, v83
  v_cvt_pk_bf16_f32 v82, v84, v85
  v_mfma_f32_16x16x32_bf16 v[188:191], a[124:127], v[68:71], v[188:191]
  s_add_u32 m0, s76, 0
  v_exp_f32 v87, v87
  v_smfmac_f32_16x16x64_bf16 a[128:131], a[144:147], v[64:71], v22
  v_cvt_pk_bf16_f32 v83, v86, v87
  v_mfma_f32_16x16x32_bf16 v[192:195], a[96:99], v[96:99], v[192:195]
  v_exp_f32 v88, v88
  v_mfma_f32_16x16x32_bf16 v[224:227], a[96:99], v[100:103], v[224:227]
  s_add_u32 s62, s38, 0
  buffer_load_dwordx4 v23, s[12:15], s62 offen offset:0 nt lds
  v_mfma_f32_16x16x32_bf16 v[196:199], a[100:103], v[96:99], v[196:199]
  v_exp_f32 v89, v89
  v_mfma_f32_16x16x32_bf16 v[228:231], a[100:103], v[100:103], v[228:231]
  v_cvt_pk_bf16_f32 v84, v88, v89
  v_mfma_f32_16x16x32_bf16 v[200:203], a[104:107], v[96:99], v[200:203]
  v_exp_f32 v90, v90
  v_mfma_f32_16x16x32_bf16 v[232:235], a[104:107], v[100:103], v[232:235]
  s_add_u32 s62, s38, 15344
  buffer_load_dwordx4 v23, s[12:15], s62 offen offset:1040 nt lds
  v_mfma_f32_16x16x32_bf16 v[204:207], a[108:111], v[96:99], v[204:207]
  v_exp_f32 v91, v91
  v_mfma_f32_16x16x32_bf16 v[236:239], a[108:111], v[100:103], v[236:239]
  v_cvt_pk_bf16_f32 v85, v90, v91
  v_mfma_f32_16x16x32_bf16 v[208:211], a[112:115], v[96:99], v[208:211]
  v_exp_f32 v92, v92
  v_mfma_f32_16x16x32_bf16 v[240:243], a[112:115], v[100:103], v[240:243]
  s_add_u32 s62, s38, 47072
  buffer_load_dwordx4 v23, s[12:15], s62 offen offset:2080 nt lds
  v_mfma_f32_16x16x32_bf16 v[212:215], a[116:119], v[96:99], v[212:215]
  v_exp_f32 v93, v93
  v_mfma_f32_16x16x32_bf16 v[244:247], a[116:119], v[100:103], v[244:247]
  s_add_u32 s62, s38, 29648
  buffer_load_dwordx4 v23, s[12:15], s62 offen offset:3120 nt lds
  v_mfma_f32_16x16x32_bf16 v[216:219], a[120:123], v[96:99], v[216:219]
  s_sub_u32 s33, s33, 1
  v_exp_f32 v94, v94
  v_mfma_f32_16x16x32_bf16 v[248:251], a[120:123], v[100:103], v[248:251]
  s_mov_b32 s73, 1
  v_cvt_pk_bf16_f32 v86, v92, v93
  v_mfma_f32_16x16x32_bf16 v[220:223], a[124:127], v[96:99], v[220:223]
  v_exp_f32 v95, v95
  v_mfma_f32_16x16x32_bf16 v[252:255], a[124:127], v[100:103], v[252:255]
  s_waitcnt lgkmcnt(0)
  v_cvt_pk_bf16_f32 v87, v94, v95
  v_smfmac_f32_16x16x64_bf16 a[132:135], a[144:147], v[96:103], v22
LE1:
  v_mfma_f32_16x16x32_bf16 v[64:67], a[64:67], a[0:3], v[48:51]
  s_add_u32 m0, s28, s31
  ds_read_b64_tr_b16 a[96:97], v2 offset:512
  ds_read_b64_tr_b16 a[98:99], v2 offset:768
  v_mfma_f32_16x16x32_bf16 v[64:67], a[68:71], a[4:7], v[64:67]
  s_mov_b32 s29, s26
  v_exp_f32 v112, v112
  v_mfma_f32_16x16x32_bf16 v[64:67], a[72:75], a[8:11], v[64:67]
  s_mov_b32 s26, s27
  ds_read_b64_tr_b16 a[100:101], v2 offset:528
  ds_read_b64_tr_b16 a[102:103], v2 offset:784
  v_mfma_f32_16x16x32_bf16 v[64:67], a[76:79], a[12:15], v[64:67]
  s_mov_b32 s27, s28
  v_exp_f32 v113, v113
  v_mfma_f32_16x16x32_bf16 v[72:75], a[64:67], a[16:19], v[52:55]
  s_mov_b32 s28, s29
  ds_read_b64_tr_b16 a[104:105], v2 offset:544
  ds_read_b64_tr_b16 a[106:107], v2 offset:800
  v_mfma_f32_16x16x32_bf16 v[72:75], a[68:71], a[20:23], v[72:75]
  v_exp_f32 v114, v114
  v_mfma_f32_16x16x32_bf16 v[72:75], a[72:75], a[24:27], v[72:75]
  ds_read_b64_tr_b16 a[108:109], v2 offset:560
  ds_read_b64_tr_b16 a[110:111], v2 offset:816
  v_mfma_f32_16x16x32_bf16 v[72:75], a[76:79], a[28:31], v[72:75]
  v_exp_f32 v115, v115
  v_mfma_f32_16x16x32_bf16 v[68:71], a[80:83], a[0:3], v[48:51]
  ds_read_b64_tr_b16 a[112:113], v2 offset:576
  ds_read_b64_tr_b16 a[114:115], v2 offset:832
  v_mfma_f32_16x16x32_bf16 v[68:71], a[84:87], a[4:7], v[68:71]
  v_exp_f32 v116, v116
  v_mfma_f32_16x16x32_bf16 v[68:71], a[88:91], a[8:11], v[68:71]
  ds_read_b64_tr_b16 a[116:117], v2 offset:592
  ds_read_b64_tr_b16 a[118:119], v2 offset:848
  v_mfma_f32_16x16x32_bf16 v[68:71], a[92:95], a[12:15], v[68:71]
  v_exp_f32 v117, v117
  v_mfma_f32_16x16x32_bf16 v[76:79], a[80:83], a[16:19], v[52:55]
  ds_read_b64_tr_b16 a[120:121], v2 offset:608
  ds_read_b64_tr_b16 a[122:123], v2 offset:864
  v_mfma_f32_16x16x32_bf16 v[76:79], a[84:87], a[20:23], v[76:79]
  v_exp_f32 v118, v118
  v_mfma_f32_16x16x32_bf16 v[76:79], a[88:91], a[24:27], v[76:79]
  ds_read_b64_tr_b16 a[124:125], v2 offset:624
  ds_read_b64_tr_b16 a[126:127], v2 offset:880
  v_mfma_f32_16x16x32_bf16 v[76:79], a[92:95], a[28:31], v[76:79]
  v_exp_f32 v119, v119
  v_mfma_f32_16x16x32_bf16 v[96:99], a[64:67], a[32:35], v[56:59]
  v_cvt_pk_bf16_f32 v112, v112, v113
  v_cvt_pk_bf16_f32 v113, v114, v115
  v_mfma_f32_16x16x32_bf16 v[96:99], a[68:71], a[36:39], v[96:99]
  v_exp_f32 v120, v120
  v_mfma_f32_16x16x32_bf16 v[96:99], a[72:75], a[40:43], v[96:99]
  v_cvt_pk_bf16_f32 v114, v116, v117
  v_cvt_pk_bf16_f32 v115, v118, v119
  v_mfma_f32_16x16x32_bf16 v[96:99], a[76:79], a[44:47], v[96:99]
  v_exp_f32 v121, v121
  v_mfma_f32_16x16x32_bf16 v[104:107], a[64:67], a[48:51], v[60:63]
  v_cvt_pk_bf16_f32 v116, v120, v121
  v_mfma_f32_16x16x32_bf16 v[104:107], a[68:71], a[52:55], v[104:107]
  v_exp_f32 v122, v122
  v_mfma_f32_16x16x32_bf16 v[104:107], a[72:75], a[56:59], v[104:107]
  buffer_load_dwordx4 v4, s[8:11], s25 offen offset:0  lds
  v_mfma_f32_16x16x32_bf16 v[104:107], a[76:79], a[60:63], v[104:107]
  v_exp_f32 v123, v123
  v_mfma_f32_16x16x32_bf16 v[100:103], a[80:83], a[32:35], v[56:59]
  v_cvt_pk_bf16_f32 v117, v122, v123
  v_mfma_f32_16x16x32_bf16 v[100:103], a[84:87], a[36:39], v[100:103]
  v_exp_f32 v124, v124
  v_mfma_f32_16x16x32_bf16 v[100:103], a[88:91], a[40:43], v[100:103]
  v_mfma_f32_16x16x32_bf16 v[100:103], a[92:95], a[44:47], v[100:103]
  v_exp_f32 v125, v125
  v_mfma_f32_16x16x32_bf16 v[108:111], a[80:83], a[48:51], v[60:63]
  buffer_load_dwordx4 v5, s[8:11], s25 offen offset:1040  lds
  v_mfma_f32_16x16x32_bf16 v[108:111], a[84:87], a[52:55], v[108:111]
  v_exp_f32 v126, v126
  v_mfma_f32_16x16x32_bf16 v[108:111], a[88:91], a[56:59], v[108:111]
  v_cvt_pk_bf16_f32 v118, v124, v125
  v_mfma_f32_16x16x32_bf16 v[108:111], a[92:95], a[60:63], v[108:111]
  s_waitcnt lgkmcnt(0)
  v_exp_f32 v127, v127
  v_mfma_f32_16x16x32_bf16 v[128:131], a[96:99], v[80:83], v[128:131]
  ds_read_b128 a[64:67], v1 offset:512
  ds_read_b128 a[68:71], v1 offset:576
  v_mfma_f32_16x16x32_bf16 v[160:163], a[96:99], v[84:87], v[160:163]
  v_exp_f32 v64, v64
  v_mfma_f32_16x16x32_bf16 v[132:135], a[100:103], v[80:83], v[132:135]
  ds_read_b128 a[72:75], v1 offset:640
  ds_read_b128 a[76:79], v1 offset:704
  v_mfma_f32_16x16x32_bf16 v[164:167], a[100:103], v[84:87], v[164:167]
  v_exp_f32 v65, v65
  v_mfma_f32_16x16x32_bf16 v[136:139], a[104:107], v[80:83], v[136:139]
  ds_read_b128 a[80:83], v1 offset:768
  ds_read_b128 a[84:87], v1 offset:832
  v_mfma_f32_16x16x32_bf16 v[168:171], a[104:107], v[84:87], v[168:171]
  v_exp_f32 v66, v66
  v_mfma_f32_16x16x32_bf16 v[140:143], a[108:111], v[80:83], v[140:143]
  ds_read_b128 a[88:91], v1 offset:896
  ds_read_b128 a[92:95], v1 offset:960
  v_mfma_f32_16x16x32_bf16 v[172:175], a[108:111], v[84:87], v[172:175]
  v_exp_f32 v67, v67
  v_mfma_f32_16x16x32_bf16 v[144:147], a[112:115], v[80:83], v[144:147]
  buffer_load_dwordx4 v6, s[8:11], s25 offen offset:2080  lds
  v_mfma_f32_16x16x32_bf16 v[176:179], a[112:115], v[84:87], v[176:179]
  v_exp_f32 v68, v68
  v_mfma_f32_16x16x32_bf16 v[148:151], a[116:119], v[80:83], v[148:151]
  v_cvt_pk_bf16_f32 v119, v126, v127
  v_cvt_pk_bf16_f32 v64, v64, v65
  v_mfma_f32_16x16x32_bf16 v[180:183], a[116:119], v[84:87], v[180:183]
  v_exp_f32 v69, v69
  v_mfma_f32_16x16x32_bf16 v[152:155], a[120:123], v[80:83], v[152:155]
  buffer_load_dwordx4 v7, s[8:11], s25 offen offset:3120  lds
  v_mfma_f32_16x16x32_bf16 v[184:187], a[120:123], v[84:87], v[184:187]
  v_exp_f32 v70, v70
  v_mfma_f32_16x16x32_bf16 v[156:159], a[124:127], v[80:83], v[156:159]
  v_cvt_pk_bf16_f32 v65, v66, v67
  v_cvt_pk_bf16_f32 v66, v68, v69
  v_mfma_f32_16x16x32_bf16 v[188:191], a[124:127], v[84:87], v[188:191]
  s_add_u32 m0, s76, 4160
  v_exp_f32 v71, v71
  v_smfmac_f32_16x16x64_bf16 a[128:131], a[144:147], v[80:87], v22
  v_cvt_pk_bf16_f32 v67, v70, v71
  v_mfma_f32_16x16x32_bf16 v[192:195], a[96:99], v[112:115], v[192:195]
  v_exp_f32 v72, v72
  v_mfma_f32_16x16x32_bf16 v[224:227], a[96:99], v[116:119], v[224:227]
  s_add_u32 s62, s38, 0
  buffer_load_dwordx4 v33, s[12:15], s62 offen offset:0 nt lds
  v_mfma_f32_16x16x32_bf16 v[196:199], a[100:103], v[112:115], v[196:199]
  v_exp_f32 v73, v73
  v_mfma_f32_16x16x32_bf16 v[228:231], a[100:103], v[116:119], v[228:231]
  v_cvt_pk_bf16_f32 v68, v72, v73
  v_readlane_b32 s78, v20, s32
  v_mfma_f32_16x16x32_bf16 v[200:203], a[104:107], v[112:115], v[200:203]
  v_exp_f32 v74, v74
  v_mfma_f32_16x16x32_bf16 v[232:235], a[104:107], v[116:119], v[232:235]
  s_add_u32 s62, s38, 15344
  buffer_load_dwordx4 v33, s[12:15], s62 offen offset:1040 nt lds
  v_mfma_f32_16x16x32_bf16 v[204:207], a[108:111], v[112:115], v[204:207]
  v_exp_f32 v75, v75
  v_mfma_f32_16x16x32_bf16 v[236:239], a[108:111], v[116:119], v[236:239]
  v_cvt_pk_bf16_f32 v69, v74, v75
  v_add_u32 v2, s26, v11
  v_mfma_f32_16x16x32_bf16 v[208:211], a[112:115], v[112:115], v[208:211]
  v_exp_f32 v76, v76
  v_mfma_f32_16x16x32_bf16 v[240:243], a[112:115], v[116:119], v[240:243]
  s_add_u32 s62, s38, 47072
  buffer_load_dwordx4 v33, s[12:15], s62 offen offset:2080 nt lds
  v_mfma_f32_16x16x32_bf16 v[212:215], a[116:119], v[112:115], v[212:215]
  v_exp_f32 v77, v77
  v_mfma_f32_16x16x32_bf16 v[244:247], a[116:119], v[116:119], v[244:247]
  s_add_u32 s62, s38, 29648
  buffer_load_dwordx4 v33, s[12:15], s62 offen offset:3120 nt lds
  v_mfma_f32_16x16x32_bf16 v[216:219], a[120:123], v[112:115], v[216:219]
  s_sub_u32 s33, s33, 1
  v_exp_f32 v78, v78
  v_mfma_f32_16x16x32_bf16 v[248:251], a[120:123], v[116:119], v[248:251]
  s_mov_b32 s73, 1
  v_cvt_pk_bf16_f32 v70, v76, v77
  v_mfma_f32_16x16x32_bf16 v[220:223], a[124:127], v[112:115], v[220:223]
  v_exp_f32 v79, v79
  v_mfma_f32_16x16x32_bf16 v[252:255], a[124:127], v[116:119], v[252:255]
  s_waitcnt vmcnt(16) lgkmcnt(0)
  v_cvt_pk_bf16_f32 v71, v78, v79
  v_smfmac_f32_16x16x64_bf16 a[132:135], a[144:147], v[112:119], v22
  s_bitcmp1_b32 s55, 0
  s_cbranch_scc0 LF0w0
  s_branch LF0w1
  .p2align 12
Lpad1:
  s_branch Lpad5
  .p2align 5
  .p2align 6
LF0w0:
  v_mfma_f32_16x16x32_bf16 v[80:83], a[64:67], a[0:3], v[48:51]
  s_barrier
  v_mfma_f32_16x16x32_bf16 v[80:83], a[68:71], a[4:7], v[80:83]
  s_mov_b32 s25, s24
  v_exp_f32 v96, v96
  v_mfma_f32_16x16x32_bf16 v[80:83], a[72:75], a[8:11], v[80:83]
  s_mov_b32 s10, s6
  ds_read_b64_tr_b16 a[96:97], v2 offset:0
  ds_read_b64_tr_b16 a[98:99], v2 offset:256
  v_mfma_f32_16x16x32_bf16 v[80:83], a[76:79], a[12:15], v[80:83]
  s_and_b32 s61, s78, 0xffff
  v_exp_f32 v97, v97
  v_mfma_f32_16x16x32_bf16 v[88:91], a[64:67], a[16:19], v[52:55]
  s_lshl_b32 s24, s61, 8
  ds_read_b64_tr_b16 a[100:101], v2 offset:16
  ds_read_b64_tr_b16 a[102:103], v2 offset:272
  v_mfma_f32_16x16x32_bf16 v[88:91], a[68:71], a[20:23], v[88:91]
  s_lshr_b32 s61, s78, 16
  v_exp_f32 v98, v98
  v_mfma_f32_16x16x32_bf16 v[88:91], a[72:75], a[24:27], v[88:91]
  s_lshl_b32 s6, s61, 11
  ds_read_b64_tr_b16 a[104:105], v2 offset:32
  ds_read_b64_tr_b16 a[106:107], v2 offset:288
  v_mfma_f32_16x16x32_bf16 v[88:91], a[76:79], a[28:31], v[88:91]
  s_add_u32 m0, s26, s30
  v_exp_f32 v99, v99
  v_mfma_f32_16x16x32_bf16 v[84:87], a[80:83], a[0:3], v[48:51]
  s_add_u32 s32, s32, 1
  ds_read_b64_tr_b16 a[108:109], v2 offset:48
  ds_read_b64_tr_b16 a[110:111], v2 offset:304
  v_mfma_f32_16x16x32_bf16 v[84:87], a[84:87], a[4:7], v[84:87]
  v_exp_f32 v100, v100
  v_mfma_f32_16x16x32_bf16 v[84:87], a[88:91], a[8:11], v[84:87]
  ds_read_b64_tr_b16 a[112:113], v2 offset:64
  ds_read_b64_tr_b16 a[114:115], v2 offset:320
  v_mfma_f32_16x16x32_bf16 v[84:87], a[92:95], a[12:15], v[84:87]
  v_exp_f32 v101, v101
  v_mfma_f32_16x16x32_bf16 v[92:95], a[80:83], a[16:19], v[52:55]
  ds_read_b64_tr_b16 a[116:117], v2 offset:80
  ds_read_b64_tr_b16 a[118:119], v2 offset:336
  v_mfma_f32_16x16x32_bf16 v[92:95], a[84:87], a[20:23], v[92:95]
  v_exp_f32 v102, v102
  v_mfma_f32_16x16x32_bf16 v[92:95], a[88:91], a[24:27], v[92:95]
  ds_read_b64_tr_b16 a[120:121], v2 offset:96
  ds_read_b64_tr_b16 a[122:123], v2 offset:352
  v_mfma_f32_16x16x32_bf16 v[92:95], a[92:95], a[28:31], v[92:95]
  v_exp_f32 v103, v103
  v_mfma_f32_16x16x32_bf16 v[112:115], a[64:67], a[32:35], v[56:59]
  ds_read_b64_tr_b16 a[124:125], v2 offset:112
  ds_read_b64_tr_b16 a[126:127], v2 offset:368
  v_mfma_f32_16x16x32_bf16 v[112:115], a[68:71], a[36:39], v[112:115]
  v_exp_f32 v104, v104
  v_mfma_f32_16x16x32_bf16 v[112:115], a[72:75], a[40:43], v[112:115]
  v_add_u32 v1, s27, v10
  v_cvt_pk_bf16_f32 v96, v96, v97
  v_mfma_f32_16x16x32_bf16 v[112:115], a[76:79], a[44:47], v[112:115]
  v_exp_f32 v105, v105
  v_mfma_f32_16x16x32_bf16 v[120:123], a[64:67], a[48:51], v[60:63]
  v_cvt_pk_bf16_f32 v97, v98, v99
  v_cvt_pk_bf16_f32 v98, v100, v101
  v_mfma_f32_16x16x32_bf16 v[120:123], a[68:71], a[52:55], v[120:123]
  v_exp_f32 v106, v106
  v_mfma_f32_16x16x32_bf16 v[120:123], a[72:75], a[56:59], v[120:123]
  v_cvt_pk_bf16_f32 v99, v102, v103
  v_cvt_pk_bf16_f32 v100, v104, v105
  v_mfma_f32_16x16x32_bf16 v[120:123], a[76:79], a[60:63], v[120:123]
  v_exp_f32 v107, v107
  v_mfma_f32_16x16x32_bf16 v[116:119], a[80:83], a[32:35], v[56:59]
  v_cvt_pk_bf16_f32 v101, v106, v107
  v_mfma_f32_16x16x32_bf16 v[116:119], a[84:87], a[36:39], v[116:119]
  v_exp_f32 v108, v108
  v_mfma_f32_16x16x32_bf16 v[116:119], a[88:91], a[40:43], v[116:119]
  v_mfma_f32_16x16x32_bf16 v[116:119], a[92:95], a[44:47], v[116:119]
  v_exp_f32 v109, v109
  v_mfma_f32_16x16x32_bf16 v[124:127], a[80:83], a[48:51], v[60:63]
  v_cvt_pk_bf16_f32 v102, v108, v109
  v_mfma_f32_16x16x32_bf16 v[124:127], a[84:87], a[52:55], v[124:127]
  v_exp_f32 v110, v110
  v_mfma_f32_16x16x32_bf16 v[124:127], a[88:91], a[56:59], v[124:127]
  v_mfma_f32_16x16x32_bf16 v[124:127], a[92:95], a[60:63], v[124:127]
  s_waitcnt lgkmcnt(0)
  v_exp_f32 v111, v111
  v_mfma_f32_16x16x32_bf16 v[128:131], a[96:99], v[64:67], v[128:131]
  ds_read_b128 a[64:67], v1 offset:0
  ds_read_b128 a[68:71], v1 offset:64
  v_mfma_f32_16x16x32_bf16 v[160:163], a[96:99], v[68:71], v[160:163]
  v_exp_f32 v80, v80
  v_mfma_f32_16x16x32_bf16 v[132:135], a[100:103], v[64:67], v[132:135]
  ds_read_b128 a[72:75], v1 offset:128
  ds_read_b128 a[76:79], v1 offset:192
  v_mfma_f32_16x16x32_bf16 v[164:167], a[100:103], v[68:71], v[164:167]
  v_exp_f32 v81, v81
  v_mfma_f32_16x16x32_bf16 v[136:139], a[104:107], v[64:67], v[136:139]
  ds_read_b128 a[80:83], v1 offset:256
  ds_read_b128 a[84:87], v1 offset:320
  v_mfma_f32_16x16x32_bf16 v[168:171], a[104:107], v[68:71], v[168:171]
  v_exp_f32 v82, v82
  v_mfma_f32_16x16x32_bf16 v[140:143], a[108:111], v[64:67], v[140:143]
  ds_read_b128 a[88:91], v1 offset:384
  ds_read_b128 a[92:95], v1 offset:448
  v_mfma_f32_16x16x32_bf16 v[172:175], a[108:111], v[68:71], v[172:175]
  v_exp_f32 v83, v83
  v_mfma_f32_16x16x32_bf16 v[144:147], a[112:115], v[64:67], v[144:147]
  buffer_load_dwordx4 v4, s[4:7], s24 offen offset:0  lds
  v_mfma_f32_16x16x32_bf16 v[176:179], a[112:115], v[68:71], v[176:179]
  v_exp_f32 v84, v84
  v_mfma_f32_16x16x32_bf16 v[148:151], a[116:119], v[64:67], v[148:151]
  v_cvt_pk_bf16_f32 v103, v110, v111
  v_cvt_pk_bf16_f32 v80, v80, v81
  v_mfma_f32_16x16x32_bf16 v[180:183], a[116:119], v[68:71], v[180:183]
  v_exp_f32 v85, v85
  v_mfma_f32_16x16x32_bf16 v[152:155], a[120:123], v[64:67], v[152:155]
  buffer_load_dwordx4 v5, s[4:7], s24 offen offset:1040  lds
  v_mfma_f32_16x16x32_bf16 v[184:187], a[120:123], v[68:71], v[184:187]
  v_exp_f32 v86, v86
  v_mfma_f32_16x16x32_bf16 v[156:159], a[124:127], v[64:67], v[156:159]
  v_cvt_pk_bf16_f32 v81, v82, v83
  v_cvt_pk_bf16_f32 v82, v84, v85
  v_mfma_f32_16x16x32_bf16 v[188:191], a[124:127], v[68:71], v[188:191]
  v_exp_f32 v87, v87
  v_smfmac_f32_16x16x64_bf16 a[128:131], a[144:147], v[64:71], v22
  v_cvt_pk_bf16_f32 v83, v86, v87
  v_mfma_f32_16x16x32_bf16 v[192:195], a[96:99], v[96:99], v[192:195]
  v_exp_f32 v88, v88
  v_mfma_f32_16x16x32_bf16 v[224:227], a[96:99], v[100:103], v[224:227]
  buffer_load_dwordx4 v6, s[4:7], s24 offen offset:2080  lds
  v_mfma_f32_16x16x32_bf16 v[196:199], a[100:103], v[96:99], v[196:199]
  v_exp_f32 v89, v89
  v_mfma_f32_16x16x32_bf16 v[228:231], a[100:103], v[100:103], v[228:231]
  v_cvt_pk_bf16_f32 v84, v88, v89
  v_readlane_b32 s79, v34, s32
  v_mfma_f32_16x16x32_bf16 v[200:203], a[104:107], v[96:99], v[200:203]
  v_exp_f32 v90, v90
  v_mfma_f32_16x16x32_bf16 v[232:235], a[104:107], v[100:103], v[232:235]
  buffer_load_dwordx4 v7, s[4:7], s24 offen offset:3120  lds
  v_mfma_f32_16x16x32_bf16 v[204:207], a[108:111], v[96:99], v[204:207]
  v_exp_f32 v91, v91
  v_mfma_f32_16x16x32_bf16 v[236:239], a[108:111], v[100:103], v[236:239]
  v_cvt_pk_bf16_f32 v85, v90, v91
  v_mfma_f32_16x16x32_bf16 v[208:211], a[112:115], v[96:99], v[208:211]
  v_exp_f32 v92, v92
  v_mfma_f32_16x16x32_bf16 v[240:243], a[112:115], v[100:103], v[240:243]
  v_mfma_f32_16x16x32_bf16 v[212:215], a[116:119], v[96:99], v[212:215]
  v_exp_f32 v93, v93
  v_mfma_f32_16x16x32_bf16 v[244:247], a[116:119], v[100:103], v[244:247]
  v_cvt_pk_bf16_f32 v86, v92, v93
  v_mfma_f32_16x16x32_bf16 v[216:219], a[120:123], v[96:99], v[216:219]
  s_sub_u32 s33, s33, 1
  v_exp_f32 v94, v94
  v_mfma_f32_16x16x32_bf16 v[248:251], a[120:123], v[100:103], v[248:251]
  s_cmp_gt_u32 s33, s73
  v_mfma_f32_16x16x32_bf16 v[220:223], a[124:127], v[96:99], v[220:223]
  v_exp_f32 v95, v95
  v_mfma_f32_16x16x32_bf16 v[252:255], a[124:127], v[100:103], v[252:255]
  s_waitcnt lgkmcnt(0)
  v_cvt_pk_bf16_f32 v87, v94, v95
  v_smfmac_f32_16x16x64_bf16 a[132:135], a[144:147], v[96:103], v22
  s_cbranch_scc0 LG1
LF1w0:
  v_mfma_f32_16x16x32_bf16 v[64:67], a[64:67], a[0:3], v[48:51]
  s_add_u32 m0, s28, s31
  ds_read_b64_tr_b16 a[96:97], v2 offset:512
  ds_read_b64_tr_b16 a[98:99], v2 offset:768
  v_mfma_f32_16x16x32_bf16 v[64:67], a[68:71], a[4:7], v[64:67]
  s_mov_b32 s29, s26
  v_exp_f32 v112, v112
  v_mfma_f32_16x16x32_bf16 v[64:67], a[72:75], a[8:11], v[64:67]
  s_mov_b32 s26, s27
  ds_read_b64_tr_b16 a[100:101], v2 offset:528
  ds_read_b64_tr_b16 a[102:103], v2 offset:784
  v_mfma_f32_16x16x32_bf16 v[64:67], a[76:79], a[12:15], v[64:67]
  s_mov_b32 s27, s28
  v_exp_f32 v113, v113
  v_mfma_f32_16x16x32_bf16 v[72:75], a[64:67], a[16:19], v[52:55]
  s_mov_b32 s28, s29
  ds_read_b64_tr_b16 a[104:105], v2 offset:544
  ds_read_b64_tr_b16 a[106:107], v2 offset:800
  v_mfma_f32_16x16x32_bf16 v[72:75], a[68:71], a[20:23], v[72:75]
  v_exp_f32 v114, v114
  v_mfma_f32_16x16x32_bf16 v[72:75], a[72:75], a[24:27], v[72:75]
  ds_read_b64_tr_b16 a[108:109], v2 offset:560
  ds_read_b64_tr_b16 a[110:111], v2 offset:816
  v_mfma_f32_16x16x32_bf16 v[72:75], a[76:79], a[28:31], v[72:75]
  v_exp_f32 v115, v115
  v_mfma_f32_16x16x32_bf16 v[68:71], a[80:83], a[0:3], v[48:51]
  s_and_b32 s74, s79, 1
  ds_read_b64_tr_b16 a[112:113], v2 offset:576
  ds_read_b64_tr_b16 a[114:115], v2 offset:832
  v_mfma_f32_16x16x32_bf16 v[68:71], a[84:87], a[4:7], v[68:71]
  s_lshl_b32 s98, 16326656, s74
  v_exp_f32 v116, v116
  v_mfma_f32_16x16x32_bf16 v[68:71], a[88:91], a[8:11], v[68:71]
  s_and_b32 s74, s79, -2
  ds_read_b64_tr_b16 a[116:117], v2 offset:592
  ds_read_b64_tr_b16 a[118:119], v2 offset:848
  v_mfma_f32_16x16x32_bf16 v[68:71], a[92:95], a[12:15], v[68:71]
  s_bitcmp1_b32 s79, 0
  v_exp_f32 v117, v117
  v_mfma_f32_16x16x32_bf16 v[76:79], a[80:83], a[16:19], v[52:55]
  s_cselect_b64 s[96:97], s[12:13], s[100:101]
  ds_read_b64_tr_b16 a[120:121], v2 offset:608
  ds_read_b64_tr_b16 a[122:123], v2 offset:864
  v_mfma_f32_16x16x32_bf16 v[76:79], a[84:87], a[20:23], v[76:79]
  s_cselect_b32 s75, 8, 11
  v_exp_f32 v118, v118
  v_mfma_f32_16x16x32_bf16 v[76:79], a[88:91], a[24:27], v[76:79]
  ds_read_b64_tr_b16 a[124:125], v2 offset:624
  ds_read_b64_tr_b16 a[126:127], v2 offset:880
  v_mfma_f32_16x16x32_bf16 v[76:79], a[92:95], a[28:31], v[76:79]
  v_exp_f32 v119, v119
  v_mfma_f32_16x16x32_bf16 v[96:99], a[64:67], a[32:35], v[56:59]
  v_cvt_pk_bf16_f32 v112, v112, v113
  v_cvt_pk_bf16_f32 v113, v114, v115
  v_mfma_f32_16x16x32_bf16 v[96:99], a[68:71], a[36:39], v[96:99]
  v_exp_f32 v120, v120
  v_mfma_f32_16x16x32_bf16 v[96:99], a[72:75], a[40:43], v[96:99]
  v_cvt_pk_bf16_f32 v114, v116, v117
  v_cvt_pk_bf16_f32 v115, v118, v119
  v_mfma_f32_16x16x32_bf16 v[96:99], a[76:79], a[44:47], v[96:99]
  v_exp_f32 v121, v121
  v_mfma_f32_16x16x32_bf16 v[104:107], a[64:67], a[48:51], v[60:63]
  v_cvt_pk_bf16_f32 v116, v120, v121
  v_mfma_f32_16x16x32_bf16 v[104:107], a[68:71], a[52:55], v[104:107]
  v_exp_f32 v122, v122
  v_mfma_f32_16x16x32_bf16 v[104:107], a[72:75], a[56:59], v[104:107]
  v_mfma_f32_16x16x32_bf16 v[104:107], a[76:79], a[60:63], v[104:107]
  v_exp_f32 v123, v123
  v_mfma_f32_16x16x32_bf16 v[100:103], a[80:83], a[32:35], v[56:59]
  v_cvt_pk_bf16_f32 v117, v122, v123
  v_mfma_f32_16x16x32_bf16 v[100:103], a[84:87], a[36:39], v[100:103]
  v_exp_f32 v124, v124
  v_mfma_f32_16x16x32_bf16 v[100:103], a[88:91], a[40:43], v[100:103]
  v_mfma_f32_16x16x32_bf16 v[100:103], a[92:95], a[44:47], v[100:103]
  v_exp_f32 v125, v125
  v_mfma_f32_16x16x32_bf16 v[108:111], a[80:83], a[48:51], v[60:63]
  v_cvt_pk_bf16_f32 v118, v124, v125
  v_mfma_f32_16x16x32_bf16 v[108:111], a[84:87], a[52:55], v[108:111]
  v_exp_f32 v126, v126
  v_mfma_f32_16x16x32_bf16 v[108:111], a[88:91], a[56:59], v[108:111]
  v_mfma_f32_16x16x32_bf16 v[108:111], a[92:95], a[60:63], v[108:111]
  s_waitcnt lgkmcnt(0)
  v_exp_f32 v127, v127
  v_mfma_f32_16x16x32_bf16 v[128:131], a[96:99], v[80:83], v[128:131]
  ds_read_b128 a[64:67], v1 offset:512
  ds_read_b128 a[68:71], v1 offset:576
  v_mfma_f32_16x16x32_bf16 v[160:163], a[96:99], v[84:87], v[160:163]
  v_exp_f32 v64, v64
  v_mfma_f32_16x16x32_bf16 v[132:135], a[100:103], v[80:83], v[132:135]
  ds_read_b128 a[72:75], v1 offset:640
  ds_read_b128 a[76:79], v1 offset:704
  v_mfma_f32_16x16x32_bf16 v[164:167], a[100:103], v[84:87], v[164:167]
  v_exp_f32 v65, v65
  v_mfma_f32_16x16x32_bf16 v[136:139], a[104:107], v[80:83], v[136:139]
  ds_read_b128 a[80:83], v1 offset:768
  ds_read_b128 a[84:87], v1 offset:832
  v_mfma_f32_16x16x32_bf16 v[168:171], a[104:107], v[84:87], v[168:171]
  v_exp_f32 v66, v66
  v_mfma_f32_16x16x32_bf16 v[140:143], a[108:111], v[80:83], v[140:143]
  ds_read_b128 a[88:91], v1 offset:896
  ds_read_b128 a[92:95], v1 offset:960
  v_mfma_f32_16x16x32_bf16 v[172:175], a[108:111], v[84:87], v[172:175]
  v_exp_f32 v67, v67
  v_mfma_f32_16x16x32_bf16 v[144:147], a[112:115], v[80:83], v[144:147]
  buffer_load_dwordx4 v4, s[8:11], s25 offen offset:0  lds
  v_mfma_f32_16x16x32_bf16 v[176:179], a[112:115], v[84:87], v[176:179]
  v_exp_f32 v68, v68
  v_mfma_f32_16x16x32_bf16 v[148:151], a[116:119], v[80:83], v[148:151]
  v_cvt_pk_bf16_f32 v119, v126, v127
  v_cvt_pk_bf16_f32 v64, v64, v65
  v_mfma_f32_16x16x32_bf16 v[180:183], a[116:119], v[84:87], v[180:183]
  v_exp_f32 v69, v69
  v_mfma_f32_16x16x32_bf16 v[152:155], a[120:123], v[80:83], v[152:155]
  buffer_load_dwordx4 v5, s[8:11], s25 offen offset:1040  lds
  v_mfma_f32_16x16x32_bf16 v[184:187], a[120:123], v[84:87], v[184:187]
  v_exp_f32 v70, v70
  v_mfma_f32_16x16x32_bf16 v[156:159], a[124:127], v[80:83], v[156:159]
  v_cvt_pk_bf16_f32 v65, v66, v67
  v_cvt_pk_bf16_f32 v66, v68, v69
  v_mfma_f32_16x16x32_bf16 v[188:191], a[124:127], v[84:87], v[188:191]
  v_exp_f32 v71, v71
  v_smfmac_f32_16x16x64_bf16 a[128:131], a[144:147], v[80:87], v22
  v_lshl_add_u32 v35, v19, s75, v17
  v_mfma_f32_16x16x32_bf16 v[192:195], a[96:99], v[112:115], v[192:195]
  v_exp_f32 v72, v72
  v_mfma_f32_16x16x32_bf16 v[224:227], a[96:99], v[116:119], v[224:227]
  buffer_load_dwordx4 v6, s[8:11], s25 offen offset:2080  lds
  v_mfma_f32_16x16x32_bf16 v[196:199], a[100:103], v[112:115], v[196:199]
  v_exp_f32 v73, v73
  v_mfma_f32_16x16x32_bf16 v[228:231], a[100:103], v[116:119], v[228:231]
  v_cvt_pk_bf16_f32 v67, v70, v71
  v_cvt_pk_bf16_f32 v68, v72, v73
  v_mfma_f32_16x16x32_bf16 v[200:203], a[104:107], v[112:115], v[200:203]
  v_exp_f32 v74, v74
  v_mfma_f32_16x16x32_bf16 v[232:235], a[104:107], v[116:119], v[232:235]
  buffer_load_dwordx4 v7, s[8:11], s25 offen offset:3120  lds
  v_mfma_f32_16x16x32_bf16 v[204:207], a[108:111], v[112:115], v[204:207]
  v_exp_f32 v75, v75
  v_mfma_f32_16x16x32_bf16 v[236:239], a[108:111], v[116:119], v[236:239]
  v_cvt_pk_bf16_f32 v69, v74, v75
  v_readlane_b32 s78, v20, s32
  v_mfma_f32_16x16x32_bf16 v[208:211], a[112:115], v[112:115], v[208:211]
  v_exp_f32 v76, v76
  v_mfma_f32_16x16x32_bf16 v[240:243], a[112:115], v[116:119], v[240:243]
  buffer_load_dword a152, v35, s[96:99], s74 offen
  v_mfma_f32_16x16x32_bf16 v[212:215], a[116:119], v[112:115], v[212:215]
  v_exp_f32 v77, v77
  v_mfma_f32_16x16x32_bf16 v[244:247], a[116:119], v[116:119], v[244:247]
  v_cvt_pk_bf16_f32 v70, v76, v77
  v_add_u32 v2, s26, v11
  v_mfma_f32_16x16x32_bf16 v[216:219], a[120:123], v[112:115], v[216:219]
  s_sub_u32 s33, s33, 1
  v_exp_f32 v78, v78
  v_mfma_f32_16x16x32_bf16 v[248:251], a[120:123], v[116:119], v[248:251]
  s_cmp_gt_u32 s33, s73
  v_mfma_f32_16x16x32_bf16 v[220:223], a[124:127], v[112:115], v[220:223]
  v_exp_f32 v79, v79
  v_mfma_f32_16x16x32_bf16 v[252:255], a[124:127], v[116:119], v[252:255]
  s_waitcnt vmcnt(9) lgkmcnt(0)
  v_cvt_pk_bf16_f32 v71, v78, v79
  v_smfmac_f32_16x16x64_bf16 a[132:135], a[144:147], v[112:119], v22
  s_cbranch_scc1 LF0w0
  s_cmp_gt_u32 s33, 1
  s_cbranch_scc0 LG0
  s_branch LE0
Lpad2:
  s_branch Lpad6
  .p2align 5
LJ1:
  v_mfma_f32_16x16x32_bf16 v[96:99], a[64:67], a[32:35], v[56:59]
  s_add_u32 m0, s28, s31
  v_exp_f32 v120, v120
  v_mfma_f32_16x16x32_bf16 v[96:99], a[68:71], a[36:39], v[96:99]
  s_mov_b32 s29, s26
  ds_read_b64_tr_b16 a[96:97], v2 offset:512
  ds_read_b64_tr_b16 a[98:99], v2 offset:768
  ds_read_b64_tr_b16 a[100:101], v2 offset:528
  v_mfma_f32_16x16x32_bf16 v[96:99], a[72:75], a[40:43], v[96:99]
  s_mov_b32 s26, s27
  v_exp_f32 v121, v121
  v_mfma_f32_16x16x32_bf16 v[96:99], a[76:79], a[44:47], v[96:99]
  s_mov_b32 s27, s28
  ds_read_b64_tr_b16 a[102:103], v2 offset:784
  ds_read_b64_tr_b16 a[104:105], v2 offset:544
  ds_read_b64_tr_b16 a[106:107], v2 offset:800
  v_mfma_f32_16x16x32_bf16 v[100:103], a[80:83], a[32:35], v[56:59]
  s_mov_b32 s28, s29
  v_exp_f32 v122, v122
  v_mfma_f32_16x16x32_bf16 v[100:103], a[84:87], a[36:39], v[100:103]
  ds_read_b64_tr_b16 a[108:109], v2 offset:560
  ds_read_b64_tr_b16 a[110:111], v2 offset:816
  ds_read_b64_tr_b16 a[112:113], v2 offset:576
  v_mfma_f32_16x16x32_bf16 v[100:103], a[88:91], a[40:43], v[100:103]
  v_exp_f32 v123, v123
  v_mfma_f32_16x16x32_bf16 v[100:103], a[92:95], a[44:47], v[100:103]
  ds_read_b64_tr_b16 a[114:115], v2 offset:832
  ds_read_b64_tr_b16 a[116:117], v2 offset:592
  ds_read_b64_tr_b16 a[118:119], v2 offset:848
  v_mfma_f32_16x16x32_bf16 v[104:107], a[64:67], a[48:51], v[60:63]
  v_exp_f32 v124, v124
  v_mfma_f32_16x16x32_bf16 v[104:107], a[68:71], a[52:55], v[104:107]
  ds_read_b64_tr_b16 a[120:121], v2 offset:608
  ds_read_b64_tr_b16 a[122:123], v2 offset:864
  ds_read_b64_tr_b16 a[124:125], v2 offset:624
  ds_read_b64_tr_b16 a[126:127], v2 offset:880
  v_add_u32 v2, s26, v11
  v_mfma_f32_16x16x32_bf16 v[104:107], a[72:75], a[56:59], v[104:107]
  v_exp_f32 v125, v125
  v_mfma_f32_16x16x32_bf16 v[104:107], a[76:79], a[60:63], v[104:107]
  v_cvt_pk_bf16_f32 v116, v120, v121
  v_cvt_pk_bf16_f32 v117, v122, v123
  v_mfma_f32_16x16x32_bf16 v[108:111], a[80:83], a[48:51], v[60:63]
  buffer_load_dwordx4 v4, s[8:11], s25 offen offset:0  lds
  v_mfma_f32_16x16x32_bf16 v[108:111], a[84:87], a[52:55], v[108:111]
  v_exp_f32 v126, v126
  v_mfma_f32_16x16x32_bf16 v[108:111], a[88:91], a[56:59], v[108:111]
  buffer_load_dwordx4 v5, s[8:11], s25 offen offset:1040  lds
  v_mfma_f32_16x16x32_bf16 v[108:111], a[92:95], a[60:63], v[108:111]
  s_waitcnt lgkmcnt(0)
  v_exp_f32 v127, v127
  v_mfma_f32_16x16x32_bf16 v[192:195], a[96:99], v[112:115], v[192:195]
  s_bitcmp1_b32 s40, 1
  v_cvt_pk_bf16_f32 v118, v124, v125
  v_cvt_pk_bf16_f32 v119, v126, v127
  v_mfma_f32_16x16x32_bf16 v[196:199], a[100:103], v[112:115], v[196:199]
  s_cselect_b64 vcc, 0, s[42:43]
  v_cndmask_b32 v96, v96, v3, vcc
  v_cndmask_b32 v104, v104, v3, vcc
  v_mfma_f32_16x16x32_bf16 v[200:203], a[104:107], v[112:115], v[200:203]
  s_cselect_b64 vcc, 0, s[44:45]
  v_cndmask_b32 v97, v97, v3, vcc
  v_cndmask_b32 v105, v105, v3, vcc
  v_mfma_f32_16x16x32_bf16 v[204:207], a[108:111], v[112:115], v[204:207]
  s_cselect_b64 vcc, 0, s[46:47]
  v_cndmask_b32 v98, v98, v3, vcc
  v_cndmask_b32 v106, v106, v3, vcc
  v_mfma_f32_16x16x32_bf16 v[208:211], a[112:115], v[112:115], v[208:211]
  s_cselect_b64 vcc, 0, s[48:49]
  v_cndmask_b32 v99, v99, v3, vcc
  v_cndmask_b32 v107, v107, v3, vcc
  v_mfma_f32_16x16x32_bf16 v[212:215], a[116:119], v[112:115], v[212:215]
  s_cselect_b64 vcc, s[42:43], -1
  v_cndmask_b32 v100, v100, v3, vcc
  v_cndmask_b32 v108, v108, v3, vcc
  v_exp_f32 v96, v96
  v_mfma_f32_16x16x32_bf16 v[216:219], a[120:123], v[112:115], v[216:219]
  s_cselect_b64 vcc, s[44:45], -1
  v_cndmask_b32 v101, v101, v3, vcc
  v_cndmask_b32 v109, v109, v3, vcc
  v_exp_f32 v97, v97
  v_mfma_f32_16x16x32_bf16 v[220:223], a[124:127], v[112:115], v[220:223]
  s_cselect_b64 vcc, s[46:47], -1
  v_cndmask_b32 v102, v102, v3, vcc
  v_cndmask_b32 v110, v110, v3, vcc
  v_exp_f32 v98, v98
  v_mfma_f32_16x16x32_bf16 v[224:227], a[96:99], v[116:119], v[224:227]
  s_cselect_b64 vcc, s[48:49], -1
  v_cndmask_b32 v103, v103, v3, vcc
  v_cndmask_b32 v111, v111, v3, vcc
  v_exp_f32 v99, v99
  v_mfma_f32_16x16x32_bf16 v[228:231], a[100:103], v[116:119], v[228:231]
  buffer_load_dwordx4 v6, s[8:11], s25 offen offset:2080  lds
  v_cvt_pk_bf16_f32 v96, v96, v97
  v_readlane_b32 s78, v20, s32
  v_mfma_f32_16x16x32_bf16 v[232:235], a[104:107], v[116:119], v[232:235]
  v_exp_f32 v100, v100
  v_mfma_f32_16x16x32_bf16 v[236:239], a[108:111], v[116:119], v[236:239]
  s_waitcnt vmcnt(15)
  v_exp_f32 v101, v101
  v_mfma_f32_16x16x32_bf16 v[240:243], a[112:115], v[116:119], v[240:243]
  s_cmp_eq_u32 s59, s34
  buffer_load_dwordx4 v7, s[8:11], s25 offen offset:3120  lds
  v_cvt_pk_bf16_f32 v97, v98, v99
  v_mfma_f32_16x16x32_bf16 v[244:247], a[116:119], v[116:119], v[244:247]
  s_cbranch_scc1 LJ1_rlx
  s_waitcnt vmcnt(8)
LJ1_rlx:
  v_exp_f32 v102, v102
  v_mfma_f32_16x16x32_bf16 v[248:251], a[120:123], v[116:119], v[248:251]
  v_exp_f32 v103, v103
  v_mfma_f32_16x16x32_bf16 v[252:255], a[124:127], v[116:119], v[252:255]
  v_cvt_pk_bf16_f32 v98, v100, v101
  v_cvt_pk_bf16_f32 v99, v102, v103
  v_smfmac_f32_16x16x64_bf16 a[132:135], a[144:147], v[112:119], v22
LL0:
  s_mov_b32 s25, s24
  s_mov_b32 s10, s6
  s_and_b32 s61, s78, 0xffff
  s_lshl_b32 s24, s61, 8
  s_barrier
  ds_read_b64_tr_b16 a[96:97], v2 offset:0
  ds_read_b64_tr_b16 a[98:99], v2 offset:256
  ds_read_b64_tr_b16 a[100:101], v2 offset:16
  ds_read_b64_tr_b16 a[102:103], v2 offset:272
  ds_read_b64_tr_b16 a[104:105], v2 offset:32
  ds_read_b64_tr_b16 a[106:107], v2 offset:288
  ds_read_b64_tr_b16 a[108:109], v2 offset:48
  ds_read_b64_tr_b16 a[110:111], v2 offset:304
  ds_read_b64_tr_b16 a[112:113], v2 offset:64
  ds_read_b64_tr_b16 a[114:115], v2 offset:320
  ds_read_b64_tr_b16 a[116:117], v2 offset:80
  ds_read_b64_tr_b16 a[118:119], v2 offset:336
  ds_read_b64_tr_b16 a[120:121], v2 offset:96
  ds_read_b64_tr_b16 a[122:123], v2 offset:352
  ds_read_b64_tr_b16 a[124:125], v2 offset:112
  ds_read_b64_tr_b16 a[126:127], v2 offset:368
  v_exp_f32 v104, v104
  v_exp_f32 v105, v105
  v_exp_f32 v106, v106
  s_waitcnt lgkmcnt(12)
  v_mfma_f32_16x16x32_bf16 v[192:195], a[96:99], v[96:99], v[192:195]
  s_lshr_b32 s61, s78, 16
  v_exp_f32 v107, v107
  v_mfma_f32_16x16x32_bf16 v[196:199], a[100:103], v[96:99], v[196:199]
  s_waitcnt lgkmcnt(6)
  v_exp_f32 v108, v108
  v_mfma_f32_16x16x32_bf16 v[200:203], a[104:107], v[96:99], v[200:203]
  s_lshl_b32 s6, s61, 11
  v_exp_f32 v109, v109
  v_mfma_f32_16x16x32_bf16 v[204:207], a[108:111], v[96:99], v[204:207]
  s_add_u32 s32, s32, 1
  v_exp_f32 v110, v110
  v_mfma_f32_16x16x32_bf16 v[208:211], a[112:115], v[96:99], v[208:211]
  s_waitcnt lgkmcnt(0)
  v_exp_f32 v111, v111
  v_mfma_f32_16x16x32_bf16 v[212:215], a[116:119], v[96:99], v[212:215]
  s_add_u32 s70, s26, s30
  v_cvt_pk_bf16_f32 v100, v104, v105
  v_cvt_pk_bf16_f32 v101, v106, v107
  v_mfma_f32_16x16x32_bf16 v[216:219], a[120:123], v[96:99], v[216:219]
  s_add_u32 s71, s28, s31
  v_cvt_pk_bf16_f32 v102, v108, v109
  v_cvt_pk_bf16_f32 v103, v110, v111
  v_mfma_f32_16x16x32_bf16 v[220:223], a[124:127], v[96:99], v[220:223]
  s_add_u32 s64, s36, 16384
  v_accvgpr_read_b32 v24, a128
  v_accvgpr_read_b32 v25, a129
  v_add_u32 v1, s27, v10
  v_smfmac_f32_16x16x64_bf16 a[132:135], a[144:147], v[96:103], v22
  s_add_u32 s65, s36, 32768
  v_accvgpr_read_b32 v26, a130
  v_readlane_b32 s78, v20, s32
  v_mfma_f32_16x16x32_bf16 v[224:227], a[96:99], v[100:103], v[224:227]
  s_mov_b32 s29, s26
  v_accvgpr_read_b32 v27, a131
  v_add_f32 v24, v24, v25
  v_mfma_f32_16x16x32_bf16 v[228:231], a[100:103], v[100:103], v[228:231]
  s_mov_b32 s26, s27
  v_add_f32 v26, v26, v27
  v_add_f32 v25, v24, v26
  v_mfma_f32_16x16x32_bf16 v[232:235], a[104:107], v[100:103], v[232:235]
  s_mov_b32 s27, s28
  v_rcp_f32 v24, v24
  v_mfma_f32_16x16x32_bf16 v[236:239], a[108:111], v[100:103], v[236:239]
  s_mov_b32 s28, s29
  v_cmp_ngt_f32 vcc, s58, v25
  v_rcp_f32 v26, v26
  v_mfma_f32_16x16x32_bf16 v[240:243], a[112:115], v[100:103], v[240:243]
  s_or_b64 s[52:53], s[52:53], vcc
  v_accvgpr_read_b32 v28, a132
  v_accvgpr_read_b32 v29, a133
  v_mfma_f32_16x16x32_bf16 v[244:247], a[116:119], v[100:103], v[244:247]
  s_add_u32 s66, s36, 49152
  v_accvgpr_read_b32 v30, a134
  v_accvgpr_read_b32 v31, a135
  v_mfma_f32_16x16x32_bf16 v[248:251], a[120:123], v[100:103], v[248:251]
  s_add_u32 s67, s37, 16384
  v_add_f32 v28, v28, v29
  v_add_f32 v30, v30, v31
  v_mfma_f32_16x16x32_bf16 v[252:255], a[124:127], v[100:103], v[252:255]
  s_add_u32 s68, s37, 32768
  v_add_f32 v29, v28, v30
  v_rcp_f32 v28, v28
  v_cmp_ngt_f32 vcc, s58, v29
  v_rcp_f32 v30, v30
  v_add_u32 v2, s26, v11
  s_add_u32 s69, s37, 49152
  s_or_b64 s[52:53], s[52:53], vcc
  s_cmp_eq_u32 s35, 0
  s_cbranch_scc1 Ltail
  s_branch Lidle0
  .p2align 12
Lpad3:
  s_branch Lpad7
  .p2align 5
  .p2align 6
LF0w1:
  v_mfma_f32_16x16x32_bf16 v[80:83], a[64:67], a[0:3], v[48:51]
  s_barrier
  v_mfma_f32_16x16x32_bf16 v[80:83], a[68:71], a[4:7], v[80:83]
  s_mov_b32 s25, s24
  v_exp_f32 v96, v96
  v_mfma_f32_16x16x32_bf16 v[80:83], a[72:75], a[8:11], v[80:83]
  s_mov_b32 s10, s6
  ds_read_b64_tr_b16 a[96:97], v2 offset:0
  ds_read_b64_tr_b16 a[98:99], v2 offset:256
  v_mfma_f32_16x16x32_bf16 v[80:83], a[76:79], a[12:15], v[80:83]
  s_and_b32 s61, s78, 0xffff
  v_exp_f32 v97, v97
  v_mfma_f32_16x16x32_bf16 v[88:91], a[64:67], a[16:19], v[52:55]
  s_lshl_b32 s24, s61, 8
  ds_read_b64_tr_b16 a[100:101], v2 offset:16
  ds_read_b64_tr_b16 a[102:103], v2 offset:272
  v_mfma_f32_16x16x32_bf16 v[88:91], a[68:71], a[20:23], v[88:91]
  s_lshr_b32 s61, s78, 16
  v_exp_f32 v98, v98
  v_mfma_f32_16x16x32_bf16 v[88:91], a[72:75], a[24:27], v[88:91]
  s_lshl_b32 s6, s61, 11
  ds_read_b64_tr_b16 a[104:105], v2 offset:32
  ds_read_b64_tr_b16 a[106:107], v2 offset:288
  v_mfma_f32_16x16x32_bf16 v[88:91], a[76:79], a[28:31], v[88:91]
  s_add_u32 m0, s26, s30
  v_exp_f32 v99, v99
  v_mfma_f32_16x16x32_bf16 v[84:87], a[80:83], a[0:3], v[48:51]
  s_add_u32 s32, s32, 1
  ds_read_b64_tr_b16 a[108:109], v2 offset:48
  ds_read_b64_tr_b16 a[110:111], v2 offset:304
  v_mfma_f32_16x16x32_bf16 v[84:87], a[84:87], a[4:7], v[84:87]
  v_exp_f32 v100, v100
  v_mfma_f32_16x16x32_bf16 v[84:87], a[88:91], a[8:11], v[84:87]
  ds_read_b64_tr_b16 a[112:113], v2 offset:64
  ds_read_b64_tr_b16 a[114:115], v2 offset:320
  v_mfma_f32_16x16x32_bf16 v[84:87], a[92:95], a[12:15], v[84:87]
  v_exp_f32 v101, v101
  v_mfma_f32_16x16x32_bf16 v[92:95], a[80:83], a[16:19], v[52:55]
  ds_read_b64_tr_b16 a[116:117], v2 offset:80
  ds_read_b64_tr_b16 a[118:119], v2 offset:336
  v_mfma_f32_16x16x32_bf16 v[92:95], a[84:87], a[20:23], v[92:95]
  v_exp_f32 v102, v102
  v_mfma_f32_16x16x32_bf16 v[92:95], a[88:91], a[24:27], v[92:95]
  ds_read_b64_tr_b16 a[120:121], v2 offset:96
  ds_read_b64_tr_b16 a[122:123], v2 offset:352
  v_mfma_f32_16x16x32_bf16 v[92:95], a[92:95], a[28:31], v[92:95]
  v_exp_f32 v103, v103
  v_mfma_f32_16x16x32_bf16 v[112:115], a[64:67], a[32:35], v[56:59]
  ds_read_b64_tr_b16 a[124:125], v2 offset:112
  ds_read_b64_tr_b16 a[126:127], v2 offset:368
  v_mfma_f32_16x16x32_bf16 v[112:115], a[68:71], a[36:39], v[112:115]
  v_exp_f32 v104, v104
  v_mfma_f32_16x16x32_bf16 v[112:115], a[72:75], a[40:43], v[112:115]
  v_add_u32 v1, s27, v10
  v_cvt_pk_bf16_f32 v96, v96, v97
  v_mfma_f32_16x16x32_bf16 v[112:115], a[76:79], a[44:47], v[112:115]
  v_exp_f32 v105, v105
  v_mfma_f32_16x16x32_bf16 v[120:123], a[64:67], a[48:51], v[60:63]
  v_cvt_pk_bf16_f32 v97, v98, v99
  v_cvt_pk_bf16_f32 v98, v100, v101
  v_mfma_f32_16x16x32_bf16 v[120:123], a[68:71], a[52:55], v[120:123]
  v_exp_f32 v106, v106
  v_mfma_f32_16x16x32_bf16 v[120:123], a[72:75], a[56:59], v[120:123]
  v_cvt_pk_bf16_f32 v99, v102, v103
  v_cvt_pk_bf16_f32 v100, v104, v105
  v_mfma_f32_16x16x32_bf16 v[120:123], a[76:79], a[60:63], v[120:123]
  v_exp_f32 v107, v107
  v_mfma_f32_16x16x32_bf16 v[116:119], a[80:83], a[32:35], v[56:59]
  v_cvt_pk_bf16_f32 v101, v106, v107
  v_mfma_f32_16x16x32_bf16 v[116:119], a[84:87], a[36:39], v[116:119]
  v_exp_f32 v108, v108
  v_mfma_f32_16x16x32_bf16 v[116:119], a[88:91], a[40:43], v[116:119]
  v_mfma_f32_16x16x32_bf16 v[116:119], a[92:95], a[44:47], v[116:119]
  v_exp_f32 v109, v109
  v_mfma_f32_16x16x32_bf16 v[124:127], a[80:83], a[48:51], v[60:63]
  v_cvt_pk_bf16_f32 v102, v108, v109
  v_mfma_f32_16x16x32_bf16 v[124:127], a[84:87], a[52:55], v[124:127]
  v_exp_f32 v110, v110
  v_mfma_f32_16x16x32_bf16 v[124:127], a[88:91], a[56:59], v[124:127]
  v_mfma_f32_16x16x32_bf16 v[124:127], a[92:95], a[60:63], v[124:127]
  s_waitcnt lgkmcnt(0)
  v_exp_f32 v111, v111
  v_mfma_f32_16x16x32_bf16 v[128:131], a[96:99], v[64:67], v[128:131]
  ds_read_b128 a[64:67], v1 offset:0
  ds_read_b128 a[68:71], v1 offset:64
  v_mfma_f32_16x16x32_bf16 v[160:163], a[96:99], v[68:71], v[160:163]
  v_exp_f32 v80, v80
  v_mfma_f32_16x16x32_bf16 v[132:135], a[100:103], v[64:67], v[132:135]
  ds_read_b128 a[72:75], v1 offset:128
  ds_read_b128 a[76:79], v1 offset:192
  v_mfma_f32_16x16x32_bf16 v[164:167], a[100:103], v[68:71], v[164:167]
  v_exp_f32 v81, v81
  v_mfma_f32_16x16x32_bf16 v[136:139], a[104:107], v[64:67], v[136:139]
  ds_read_b128 a[80:83], v1 offset:256
  ds_read_b128 a[84:87], v1 offset:320
  v_mfma_f32_16x16x32_bf16 v[168:171], a[104:107], v[68:71], v[168:171]
  v_exp_f32 v82, v82
  v_mfma_f32_16x16x32_bf16 v[140:143], a[108:111], v[64:67], v[140:143]
  ds_read_b128 a[88:91], v1 offset:384
  ds_read_b128 a[92:95], v1 offset:448
  v_mfma_f32_16x16x32_bf16 v[172:175], a[108:111], v[68:71], v[172:175]
  v_exp_f32 v83, v83
  v_mfma_f32_16x16x32_bf16 v[144:147], a[112:115], v[64:67], v[144:147]
  v_cvt_pk_bf16_f32 v103, v110, v111
  v_cvt_pk_bf16_f32 v80, v80, v81
  v_mfma_f32_16x16x32_bf16 v[176:179], a[112:115], v[68:71], v[176:179]
  v_exp_f32 v84, v84
  v_mfma_f32_16x16x32_bf16 v[148:151], a[116:119], v[64:67], v[148:151]
  buffer_load_dwordx4 v4, s[4:7], s24 offen offset:0  lds
  v_mfma_f32_16x16x32_bf16 v[180:183], a[116:119], v[68:71], v[180:183]
  v_exp_f32 v85, v85
  v_mfma_f32_16x16x32_bf16 v[152:155], a[120:123], v[64:67], v[152:155]
  v_cvt_pk_bf16_f32 v81, v82, v83
  v_cvt_pk_bf16_f32 v82, v84, v85
  v_mfma_f32_16x16x32_bf16 v[184:187], a[120:123], v[68:71], v[184:187]
  v_exp_f32 v86, v86
  v_mfma_f32_16x16x32_bf16 v[156:159], a[124:127], v[64:67], v[156:159]
  buffer_load_dwordx4 v5, s[4:7], s24 offen offset:1040  lds
  v_mfma_f32_16x16x32_bf16 v[188:191], a[124:127], v[68:71], v[188:191]
  v_exp_f32 v87, v87
  v_smfmac_f32_16x16x64_bf16 a[128:131], a[144:147], v[64:71], v22
  v_cvt_pk_bf16_f32 v83, v86, v87
  v_mfma_f32_16x16x32_bf16 v[192:195], a[96:99], v[96:99], v[192:195]
  v_exp_f32 v88, v88
  v_mfma_f32_16x16x32_bf16 v[224:227], a[96:99], v[100:103], v[224:227]
  v_readlane_b32 s79, v34, s32
  v_mfma_f32_16x16x32_bf16 v[196:199], a[100:103], v[96:99], v[196:199]
  v_exp_f32 v89, v89
  v_mfma_f32_16x16x32_bf16 v[228:231], a[100:103], v[100:103], v[228:231]
  buffer_load_dwordx4 v6, s[4:7], s24 offen offset:2080  lds
  v_mfma_f32_16x16x32_bf16 v[200:203], a[104:107], v[96:99], v[200:203]
  v_exp_f32 v90, v90
  v_mfma_f32_16x16x32_bf16 v[232:235], a[104:107], v[100:103], v[232:235]
  v_cvt_pk_bf16_f32 v84, v88, v89
  v_mfma_f32_16x16x32_bf16 v[204:207], a[108:111], v[96:99], v[204:207]
  v_exp_f32 v91, v91
  v_mfma_f32_16x16x32_bf16 v[236:239], a[108:111], v[100:103], v[236:239]
  buffer_load_dwordx4 v7, s[4:7], s24 offen offset:3120  lds
  v_mfma_f32_16x16x32_bf16 v[208:211], a[112:115], v[96:99], v[208:211]
  v_exp_f32 v92, v92
  v_mfma_f32_16x16x32_bf16 v[240:243], a[112:115], v[100:103], v[240:243]
  v_cvt_pk_bf16_f32 v85, v90, v91
  v_mfma_f32_16x16x32_bf16 v[212:215], a[116:119], v[96:99], v[212:215]
  v_exp_f32 v93, v93
  v_mfma_f32_16x16x32_bf16 v[244:247], a[116:119], v[100:103], v[244:247]
  v_cvt_pk_bf16_f32 v86, v92, v93
  v_mfma_f32_16x16x32_bf16 v[216:219], a[120:123], v[96:99], v[216:219]
  s_sub_u32 s33, s33, 1
  v_exp_f32 v94, v94
  v_mfma_f32_16x16x32_bf16 v[248:251], a[120:123], v[100:103], v[248:251]
  s_cmp_gt_u32 s33, s73
  v_mfma_f32_16x16x32_bf16 v[220:223], a[124:127], v[96:99], v[220:223]
  v_exp_f32 v95, v95
  v_mfma_f32_16x16x32_bf16 v[252:255], a[124:127], v[100:103], v[252:255]
  s_waitcnt lgkmcnt(0)
  v_cvt_pk_bf16_f32 v87, v94, v95
  v_smfmac_f32_16x16x64_bf16 a[132:135], a[144:147], v[96:103], v22
  s_cbranch_scc0 LG1
LF1w1:
  v_mfma_f32_16x16x32_bf16 v[64:67], a[64:67], a[0:3], v[48:51]
  s_add_u32 m0, s28, s31
  ds_read_b64_tr_b16 a[96:97], v2 offset:512
  ds_read_b64_tr_b16 a[98:99], v2 offset:768
  v_mfma_f32_16x16x32_bf16 v[64:67], a[68:71], a[4:7], v[64:67]
  s_mov_b32 s29, s26
  v_exp_f32 v112, v112
  v_mfma_f32_16x16x32_bf16 v[64:67], a[72:75], a[8:11], v[64:67]
  s_mov_b32 s26, s27
  ds_read_b64_tr_b16 a[100:101], v2 offset:528
  ds_read_b64_tr_b16 a[102:103], v2 offset:784
  v_mfma_f32_16x16x32_bf16 v[64:67], a[76:79], a[12:15], v[64:67]
  s_mov_b32 s27, s28
  v_exp_f32 v113, v113
  v_mfma_f32_16x16x32_bf16 v[72:75], a[64:67], a[16:19], v[52:55]
  s_mov_b32 s28, s29
  ds_read_b64_tr_b16 a[104:105], v2 offset:544
  ds_read_b64_tr_b16 a[106:107], v2 offset:800
  v_mfma_f32_16x16x32_bf16 v[72:75], a[68:71], a[20:23], v[72:75]
  v_exp_f32 v114, v114
  v_mfma_f32_16x16x32_bf16 v[72:75], a[72:75], a[24:27], v[72:75]
  ds_read_b64_tr_b16 a[108:109], v2 offset:560
  ds_read_b64_tr_b16 a[110:111], v2 offset:816
  v_mfma_f32_16x16x32_bf16 v[72:75], a[76:79], a[28:31], v[72:75]
  v_exp_f32 v115, v115
  v_mfma_f32_16x16x32_bf16 v[68:71], a[80:83], a[0:3], v[48:51]
  s_and_b32 s74, s79, 1
  ds_read_b64_tr_b16 a[112:113], v2 offset:576
  ds_read_b64_tr_b16 a[114:115], v2 offset:832
  v_mfma_f32_16x16x32_bf16 v[68:71], a[84:87], a[4:7], v[68:71]
  s_lshl_b32 s98, 16326656, s74
  v_exp_f32 v116, v116
  v_mfma_f32_16x16x32_bf16 v[68:71], a[88:91], a[8:11], v[68:71]
  s_and_b32 s74, s79, -2
  ds_read_b64_tr_b16 a[116:117], v2 offset:592
  ds_read_b64_tr_b16 a[118:119], v2 offset:848
  v_mfma_f32_16x16x32_bf16 v[68:71], a[92:95], a[12:15], v[68:71]
  s_bitcmp1_b32 s79, 0
  v_exp_f32 v117, v117
  v_mfma_f32_16x16x32_bf16 v[76:79], a[80:83], a[16:19], v[52:55]
  s_cselect_b64 s[96:97], s[12:13], s[100:101]
  ds_read_b64_tr_b16 a[120:121], v2 offset:608
  ds_read_b64_tr_b16 a[122:123], v2 offset:864
  v_mfma_f32_16x16x32_bf16 v[76:79], a[84:87], a[20:23], v[76:79]
  s_cselect_b32 s75, 8, 11
  v_exp_f32 v118, v118
  v_mfma_f32_16x16x32_bf16 v[76:79], a[88:91], a[24:27], v[76:79]
  ds_read_b64_tr_b16 a[124:125], v2 offset:624
  ds_read_b64_tr_b16 a[126:127], v2 offset:880
  v_mfma_f32_16x16x32_bf16 v[76:79], a[92:95], a[28:31], v[76:79]
  v_exp_f32 v119, v119
  v_mfma_f32_16x16x32_bf16 v[96:99], a[64:67], a[32:35], v[56:59]
  v_cvt_pk_bf16_f32 v112, v112, v113
  v_cvt_pk_bf16_f32 v113, v114, v115
  v_mfma_f32_16x16x32_bf16 v[96:99], a[68:71], a[36:39], v[96:99]
  v_exp_f32 v120, v120
  v_mfma_f32_16x16x32_bf16 v[96:99], a[72:75], a[40:43], v[96:99]
  v_cvt_pk_bf16_f32 v114, v116, v117
  v_cvt_pk_bf16_f32 v115, v118, v119
  v_mfma_f32_16x16x32_bf16 v[96:99], a[76:79], a[44:47], v[96:99]
  v_exp_f32 v121, v121
  v_mfma_f32_16x16x32_bf16 v[104:107], a[64:67], a[48:51], v[60:63]
  v_cvt_pk_bf16_f32 v116, v120, v121
  v_mfma_f32_16x16x32_bf16 v[104:107], a[68:71], a[52:55], v[104:107]
  v_exp_f32 v122, v122
  v_mfma_f32_16x16x32_bf16 v[104:107], a[72:75], a[56:59], v[104:107]
  v_mfma_f32_16x16x32_bf16 v[104:107], a[76:79], a[60:63], v[104:107]
  v_exp_f32 v123, v123
  v_mfma_f32_16x16x32_bf16 v[100:103], a[80:83], a[32:35], v[56:59]
  v_cvt_pk_bf16_f32 v117, v122, v123
  v_mfma_f32_16x16x32_bf16 v[100:103], a[84:87], a[36:39], v[100:103]
  v_exp_f32 v124, v124
  v_mfma_f32_16x16x32_bf16 v[100:103], a[88:91], a[40:43], v[100:103]
  v_mfma_f32_16x16x32_bf16 v[100:103], a[92:95], a[44:47], v[100:103]
  v_exp_f32 v125, v125
  v_mfma_f32_16x16x32_bf16 v[108:111], a[80:83], a[48:51], v[60:63]
  v_cvt_pk_bf16_f32 v118, v124, v125
  v_mfma_f32_16x16x32_bf16 v[108:111], a[84:87], a[52:55], v[108:111]
  v_exp_f32 v126, v126
  v_mfma_f32_16x16x32_bf16 v[108:111], a[88:91], a[56:59], v[108:111]
  v_mfma_f32_16x16x32_bf16 v[108:111], a[92:95], a[60:63], v[108:111]
  s_waitcnt lgkmcnt(0)
  v_exp_f32 v127, v127
  v_mfma_f32_16x16x32_bf16 v[128:131], a[96:99], v[80:83], v[128:131]
  ds_read_b128 a[64:67], v1 offset:512
  ds_read_b128 a[68:71], v1 offset:576
  v_mfma_f32_16x16x32_bf16 v[160:163], a[96:99], v[84:87], v[160:163]
  v_exp_f32 v64, v64
  v_mfma_f32_16x16x32_bf16 v[132:135], a[100:103], v[80:83], v[132:135]
  ds_read_b128 a[72:75], v1 offset:640
  ds_read_b128 a[76:79], v1 offset:704
  v_mfma_f32_16x16x32_bf16 v[164:167], a[100:103], v[84:87], v[164:167]
  v_exp_f32 v65, v65
  v_mfma_f32_16x16x32_bf16 v[136:139], a[104:107], v[80:83], v[136:139]
  ds_read_b128 a[80:83], v1 offset:768
  ds_read_b128 a[84:87], v1 offset:832
  v_mfma_f32_16x16x32_bf16 v[168:171], a[104:107], v[84:87], v[168:171]
  v_exp_f32 v66, v66
  v_mfma_f32_16x16x32_bf16 v[140:143], a[108:111], v[80:83], v[140:143]
  ds_read_b128 a[88:91], v1 offset:896
  ds_read_b128 a[92:95], v1 offset:960
  v_mfma_f32_16x16x32_bf16 v[172:175], a[108:111], v[84:87], v[172:175]
  v_exp_f32 v67, v67
  v_mfma_f32_16x16x32_bf16 v[144:147], a[112:115], v[80:83], v[144:147]
  v_cvt_pk_bf16_f32 v119, v126, v127
  v_cvt_pk_bf16_f32 v64, v64, v65
  v_mfma_f32_16x16x32_bf16 v[176:179], a[112:115], v[84:87], v[176:179]
  v_exp_f32 v68, v68
  v_mfma_f32_16x16x32_bf16 v[148:151], a[116:119], v[80:83], v[148:151]
  buffer_load_dwordx4 v4, s[8:11], s25 offen offset:0  lds
  v_mfma_f32_16x16x32_bf16 v[180:183], a[116:119], v[84:87], v[180:183]
  v_exp_f32 v69, v69
  v_mfma_f32_16x16x32_bf16 v[152:155], a[120:123], v[80:83], v[152:155]
  v_cvt_pk_bf16_f32 v65, v66, v67
  v_cvt_pk_bf16_f32 v66, v68, v69
  v_mfma_f32_16x16x32_bf16 v[184:187], a[120:123], v[84:87], v[184:187]
  v_exp_f32 v70, v70
  v_mfma_f32_16x16x32_bf16 v[156:159], a[124:127], v[80:83], v[156:159]
  buffer_load_dwordx4 v5, s[8:11], s25 offen offset:1040  lds
  v_mfma_f32_16x16x32_bf16 v[188:191], a[124:127], v[84:87], v[188:191]
  v_exp_f32 v71, v71
  v_smfmac_f32_16x16x64_bf16 a[128:131], a[144:147], v[80:87], v22
  v_lshl_add_u32 v35, v19, s75, v17
  v_mfma_f32_16x16x32_bf16 v[192:195], a[96:99], v[112:115], v[192:195]
  v_exp_f32 v72, v72
  v_mfma_f32_16x16x32_bf16 v[224:227], a[96:99], v[116:119], v[224:227]
  v_cvt_pk_bf16_f32 v67, v70, v71
  v_readlane_b32 s78, v20, s32
  v_mfma_f32_16x16x32_bf16 v[196:199], a[100:103], v[112:115], v[196:199]
  v_exp_f32 v73, v73
  v_mfma_f32_16x16x32_bf16 v[228:231], a[100:103], v[116:119], v[228:231]
  buffer_load_dwordx4 v6, s[8:11], s25 offen offset:2080  lds
  v_mfma_f32_16x16x32_bf16 v[200:203], a[104:107], v[112:115], v[200:203]
  v_exp_f32 v74, v74
  v_mfma_f32_16x16x32_bf16 v[232:235], a[104:107], v[116:119], v[232:235]
  v_cvt_pk_bf16_f32 v68, v72, v73
  v_add_u32 v2, s26, v11
  v_mfma_f32_16x16x32_bf16 v[204:207], a[108:111], v[112:115], v[204:207]
  v_exp_f32 v75, v75
  v_mfma_f32_16x16x32_bf16 v[236:239], a[108:111], v[116:119], v[236:239]
  buffer_load_dwordx4 v7, s[8:11], s25 offen offset:3120  lds
  v_mfma_f32_16x16x32_bf16 v[208:211], a[112:115], v[112:115], v[208:211]
  v_exp_f32 v76, v76
  v_mfma_f32_16x16x32_bf16 v[240:243], a[112:115], v[116:119], v[240:243]
  v_cvt_pk_bf16_f32 v69, v74, v75
  v_mfma_f32_16x16x32_bf16 v[212:215], a[116:119], v[112:115], v[212:215]
  v_exp_f32 v77, v77
  v_mfma_f32_16x16x32_bf16 v[244:247], a[116:119], v[116:119], v[244:247]
  buffer_load_dword a152, v35, s[96:99], s74 offen
  v_mfma_f32_16x16x32_bf16 v[216:219], a[120:123], v[112:115], v[216:219]
  s_sub_u32 s33, s33, 1
  v_exp_f32 v78, v78
  v_mfma_f32_16x16x32_bf16 v[248:251], a[120:123], v[116:119], v[248:251]
  s_cmp_gt_u32 s33, s73
  v_cvt_pk_bf16_f32 v70, v76, v77
  v_mfma_f32_16x16x32_bf16 v[220:223], a[124:127], v[112:115], v[220:223]
  v_exp_f32 v79, v79
  v_mfma_f32_16x16x32_bf16 v[252:255], a[124:127], v[116:119], v[252:255]
  s_waitcnt vmcnt(9) lgkmcnt(0)
  v_cvt_pk_bf16_f32 v71, v78, v79
  v_smfmac_f32_16x16x64_bf16 a[132:135], a[144:147], v[112:119], v22
  s_cbranch_scc1 LF0w1
  s_cmp_gt_u32 s33, 1
  s_cbranch_scc0 LG0
  s_branch LE0
Lpad4:
  s_branch Lpad8
  .p2align 5
LU1:
  v_mfma_f32_16x16x32_bf16 v[96:99], a[64:67], a[32:35], v[56:59]
  s_add_u32 m0, s28, s31
  ds_read_b64_tr_b16 a[96:97], v2 offset:512
  ds_read_b64_tr_b16 a[98:99], v2 offset:768
  v_mfma_f32_16x16x32_bf16 v[96:99], a[68:71], a[36:39], v[96:99]
  s_mov_b32 s29, s26
  v_exp_f32 v112, v112
  v_mfma_f32_16x16x32_bf16 v[96:99], a[72:75], a[40:43], v[96:99]
  s_mov_b32 s26, s27
  ds_read_b64_tr_b16 a[100:101], v2 offset:528
  ds_read_b64_tr_b16 a[102:103], v2 offset:784
  v_mfma_f32_16x16x32_bf16 v[96:99], a[76:79], a[44:47], v[96:99]
  s_mov_b32 s27, s28
  v_exp_f32 v113, v113
  v_mfma_f32_16x16x32_bf16 v[100:103], a[80:83], a[32:35], v[56:59]
  s_mov_b32 s28, s29
  ds_read_b64_tr_b16 a[104:105], v2 offset:544
  ds_read_b64_tr_b16 a[106:107], v2 offset:800
  v_mfma_f32_16x16x32_bf16 v[100:103], a[84:87], a[36:39], v[100:103]
  v_exp_f32 v114, v114
  v_mfma_f32_16x16x32_bf16 v[100:103], a[88:91], a[40:43], v[100:103]
  ds_read_b64_tr_b16 a[108:109], v2 offset:560
  ds_read_b64_tr_b16 a[110:111], v2 offset:816
  v_mfma_f32_16x16x32_bf16 v[100:103], a[92:95], a[44:47], v[100:103]
  v_exp_f32 v115, v115
  v_mfma_f32_16x16x32_bf16 v[104:107], a[64:67], a[48:51], v[60:63]
  ds_read_b64_tr_b16 a[112:113], v2 offset:576
  ds_read_b64_tr_b16 a[114:115], v2 offset:832
  v_mfma_f32_16x16x32_bf16 v[104:107], a[68:71], a[52:55], v[104:107]
  v_exp_f32 v116, v116
  v_mfma_f32_16x16x32_bf16 v[104:107], a[72:75], a[56:59], v[104:107]
  ds_read_b64_tr_b16 a[116:117], v2 offset:592
  ds_read_b64_tr_b16 a[118:119], v2 offset:848
  v_mfma_f32_16x16x32_bf16 v[104:107], a[76:79], a[60:63], v[104:107]
  s_bitcmp1_b32 s40, 6
  v_exp_f32 v117, v117
  v_mfma_f32_16x16x32_bf16 v[108:111], a[80:83], a[48:51], v[60:63]
  s_cbranch_scc1 LU1w
LU1w_back:
  ds_read_b64_tr_b16 a[120:121], v2 offset:608
  ds_read_b64_tr_b16 a[122:123], v2 offset:864
  v_mfma_f32_16x16x32_bf16 v[108:111], a[84:87], a[52:55], v[108:111]
  buffer_load_dwordx4 v4, s[8:11], s25 offen offset:0  lds
  v_exp_f32 v118, v118
  v_mfma_f32_16x16x32_bf16 v[108:111], a[88:91], a[56:59], v[108:111]
  ds_read_b64_tr_b16 a[124:125], v2 offset:624
  ds_read_b64_tr_b16 a[126:127], v2 offset:880
  v_mfma_f32_16x16x32_bf16 v[108:111], a[92:95], a[60:63], v[108:111]
  s_waitcnt lgkmcnt(10)
  v_exp_f32 v119, v119
  v_mfma_f32_16x16x32_bf16 v[128:131], a[96:99], v[80:83], v[128:131]
  ds_read_b128 v[72:75], v12 offset:0
  ds_read_b128 v[76:79], v13 offset:0
  v_mfma_f32_16x16x32_bf16 v[160:163], a[96:99], v[84:87], v[160:163]
  buffer_load_dwordx4 v5, s[8:11], s25 offen offset:1040  lds
  v_exp_f32 v120, v120
  v_mfma_f32_16x16x32_bf16 v[132:135], a[100:103], v[80:83], v[132:135]
  ds_read_b128 v[88:91], v14 offset:0
  ds_read_b128 v[92:95], v15 offset:0
  v_mfma_f32_16x16x32_bf16 v[164:167], a[100:103], v[84:87], v[164:167]
  v_exp_f32 v121, v121
  v_mfma_f32_16x16x32_bf16 v[136:139], a[104:107], v[80:83], v[136:139]
  ds_read_b128 v[40:43], v12 offset:4160
  ds_read_b128 v[44:47], v13 offset:4160
  v_mfma_f32_16x16x32_bf16 v[168:171], a[104:107], v[84:87], v[168:171]
  s_waitcnt lgkmcnt(6)
  buffer_load_dwordx4 v6, s[8:11], s25 offen offset:2080  lds
  v_exp_f32 v122, v122
  v_mfma_f32_16x16x32_bf16 v[140:143], a[108:111], v[80:83], v[140:143]
  s_bitcmp1_b32 s40, 1
  ds_read_b128 v[48:51], v14 offset:4160
  ds_read_b128 v[52:55], v15 offset:4160
  v_mfma_f32_16x16x32_bf16 v[172:175], a[108:111], v[84:87], v[172:175]
  s_cselect_b64 vcc, 0, s[42:43]
  v_exp_f32 v123, v123
  v_cndmask_b32 v96, v96, v3, vcc
  v_cndmask_b32 v104, v104, v3, vcc
  v_mfma_f32_16x16x32_bf16 v[144:147], a[112:115], v[80:83], v[144:147]
  s_cselect_b64 vcc, 0, s[44:45]
  v_cvt_pk_bf16_f32 v112, v112, v113
  v_cvt_pk_bf16_f32 v113, v114, v115
  v_cndmask_b32 v97, v97, v3, vcc
  v_cndmask_b32 v105, v105, v3, vcc
  v_mfma_f32_16x16x32_bf16 v[176:179], a[112:115], v[84:87], v[176:179]
  s_cselect_b64 vcc, 0, s[46:47]
  buffer_load_dwordx4 v7, s[8:11], s25 offen offset:3120  lds
  v_exp_f32 v124, v124
  v_cndmask_b32 v98, v98, v3, vcc
  v_cndmask_b32 v106, v106, v3, vcc
  v_mfma_f32_16x16x32_bf16 v[148:151], a[116:119], v[80:83], v[148:151]
  s_cselect_b64 vcc, 0, s[48:49]
  v_cvt_pk_bf16_f32 v114, v116, v117
  v_cvt_pk_bf16_f32 v115, v118, v119
  v_cndmask_b32 v99, v99, v3, vcc
  v_cndmask_b32 v107, v107, v3, vcc
  v_mfma_f32_16x16x32_bf16 v[180:183], a[116:119], v[84:87], v[180:183]
  s_cselect_b64 vcc, s[42:43], -1
  v_exp_f32 v125, v125
  v_cndmask_b32 v100, v100, v3, vcc
  v_cndmask_b32 v108, v108, v3, vcc
  v_mfma_f32_16x16x32_bf16 v[152:155], a[120:123], v[80:83], v[152:155]
  s_cselect_b64 vcc, s[44:45], -1
  v_readlane_b32 s78, v20, s32
  v_cndmask_b32 v101, v101, v3, vcc
  v_cndmask_b32 v109, v109, v3, vcc
  v_mfma_f32_16x16x32_bf16 v[184:187], a[120:123], v[84:87], v[184:187]
  s_cselect_b64 vcc, s[46:47], -1
  v_exp_f32 v126, v126
  v_cndmask_b32 v102, v102, v3, vcc
  v_cndmask_b32 v110, v110, v3, vcc
  v_mfma_f32_16x16x32_bf16 v[156:159], a[124:127], v[80:83], v[156:159]
  s_cselect_b64 vcc, s[48:49], -1
  v_cndmask_b32 v103, v103, v3, vcc
  v_cndmask_b32 v111, v111, v3, vcc
  v_mfma_f32_16x16x32_bf16 v[188:191], a[124:127], v[84:87], v[188:191]
  s_waitcnt lgkmcnt(0)
  v_exp_f32 v127, v127
  v_smfmac_f32_16x16x64_bf16 a[128:131], a[144:147], v[80:87], v22
  s_add_u32 m0, s76, 0
  s_add_u32 s62, s39, 0
  buffer_load_dwordx4 v23, s[12:15], s62 offen offset:0 nt lds
  v_cvt_pk_bf16_f32 v116, v120, v121
  v_mfma_f32_16x16x32_bf16 v[192:195], a[96:99], v[112:115], v[192:195]
  v_exp_f32 v96, v96
  v_mfma_f32_16x16x32_bf16 v[196:199], a[100:103], v[112:115], v[196:199]
  s_add_u32 s62, s39, 15344
  buffer_load_dwordx4 v23, s[12:15], s62 offen offset:1040 nt lds
  v_cvt_pk_bf16_f32 v117, v122, v123
  v_cvt_pk_bf16_f32 v118, v124, v125
  v_mfma_f32_16x16x32_bf16 v[200:203], a[104:107], v[112:115], v[200:203]
  v_exp_f32 v97, v97
  v_mfma_f32_16x16x32_bf16 v[204:207], a[108:111], v[112:115], v[204:207]
  s_add_u32 s62, s39, 47072
  buffer_load_dwordx4 v23, s[12:15], s62 offen offset:2080 nt lds
  v_cvt_pk_bf16_f32 v119, v126, v127
  v_cvt_pk_bf16_f32 v96, v96, v97
  v_mfma_f32_16x16x32_bf16 v[208:211], a[112:115], v[112:115], v[208:211]
  v_exp_f32 v98, v98
  v_mfma_f32_16x16x32_bf16 v[212:215], a[116:119], v[112:115], v[212:215]
  s_add_u32 s62, s39, 29648
  buffer_load_dwordx4 v23, s[12:15], s62 offen offset:3120 nt lds
  v_add_u32 v2, s26, v11
  v_mfma_f32_16x16x32_bf16 v[216:219], a[120:123], v[112:115], v[216:219]
  v_exp_f32 v99, v99
  v_mfma_f32_16x16x32_bf16 v[220:223], a[124:127], v[112:115], v[220:223]
  s_add_u32 m0, s76, 4160
  s_add_u32 s62, s39, 0
  buffer_load_dwordx4 v33, s[12:15], s62 offen offset:0 nt lds
  v_cvt_pk_bf16_f32 v97, v98, v99
  v_mfma_f32_16x16x32_bf16 v[224:227], a[96:99], v[116:119], v[224:227]
  v_exp_f32 v100, v100
  v_mfma_f32_16x16x32_bf16 v[228:231], a[100:103], v[116:119], v[228:231]
  s_add_u32 s62, s39, 15344
  buffer_load_dwordx4 v33, s[12:15], s62 offen offset:1040 nt lds
  v_mfma_f32_16x16x32_bf16 v[232:235], a[104:107], v[116:119], v[232:235]
  v_exp_f32 v101, v101
  v_mfma_f32_16x16x32_bf16 v[236:239], a[108:111], v[116:119], v[236:239]
  s_add_u32 s62, s39, 47072
  buffer_load_dwordx4 v33, s[12:15], s62 offen offset:2080 nt lds
  v_cvt_pk_bf16_f32 v98, v100, v101
  v_mfma_f32_16x16x32_bf16 v[240:243], a[112:115], v[116:119], v[240:243]
  v_exp_f32 v102, v102
  v_mfma_f32_16x16x32_bf16 v[244:247], a[116:119], v[116:119], v[244:247]
  s_add_u32 s62, s39, 29648
  buffer_load_dwordx4 v33, s[12:15], s62 offen offset:3120 nt lds
  v_mfma_f32_16x16x32_bf16 v[248:251], a[120:123], v[116:119], v[248:251]
  s_waitcnt vmcnt(16) lgkmcnt(0)
  v_exp_f32 v103, v103
  v_mfma_f32_16x16x32_bf16 v[252:255], a[124:127], v[116:119], v[252:255]
  s_bitcmp1_b32 s40, 5
  v_cvt_pk_bf16_f32 v99, v102, v103
  v_smfmac_f32_16x16x64_bf16 a[132:135], a[144:147], v[112:119], v22
  s_cbranch_scc1 LepiA
  s_branch LL0
LT0w:
  s_waitcnt vmcnt(0)
  s_branch LT0w_back
LT1w:
  s_waitcnt vmcnt(4)
  s_branch LT1w_back
LU0w:
  s_waitcnt vmcnt(0)
  s_branch LU0w_back
LU1w:
  s_waitcnt vmcnt(4)
  s_branch LU1w_back
LSF0:
  s_cmp_eq_u32 s33, 1
  s_cbranch_scc1 LG0
  s_cmp_eq_u32 s34, 0
  s_cbranch_scc1 LU0
  s_branch LT0
LmP:
  s_bitcmp1_b32 s40, 0
  s_cbranch_scc1 LmP_odd
  v_cndmask_b32 v64, v64, v3, s[42:43]
  v_cndmask_b32 v65, v65, v3, s[44:45]
  v_cndmask_b32 v66, v66, v3, s[46:47]
  v_cndmask_b32 v67, v67, v3, s[48:49]
  v_mov_b32 v68, v3
  v_mov_b32 v69, v3
  v_mov_b32 v70, v3
  v_mov_b32 v71, v3
  v_cndmask_b32 v72, v72, v3, s[42:43]
  v_cndmask_b32 v73, v73, v3, s[44:45]
  v_cndmask_b32 v74, v74, v3, s[46:47]
  v_cndmask_b32 v75, v75, v3, s[48:49]
  v_mov_b32 v76, v3
  v_mov_b32 v77, v3
  v_mov_b32 v78, v3
  v_mov_b32 v79, v3
  s_branch LmP_back
LmP_odd:
  v_cndmask_b32 v68, v68, v3, s[42:43]
  v_cndmask_b32 v69, v69, v3, s[44:45]
  v_cndmask_b32 v70, v70, v3, s[46:47]
  v_cndmask_b32 v71, v71, v3, s[48:49]
  v_cndmask_b32 v76, v76, v3, s[42:43]
  v_cndmask_b32 v77, v77, v3, s[44:45]
  v_cndmask_b32 v78, v78, v3, s[46:47]
  v_cndmask_b32 v79, v79, v3, s[48:49]
  s_branch LmP_back
  .p2align 12
Lpad5:
  s_branch Lpad9
  .p2align 5
LG0:
  v_mfma_f32_16x16x32_bf16 v[80:83], a[64:67], a[0:3], v[48:51]
  s_barrier
  ds_read_b64_tr_b16 a[96:97], v2 offset:0
  ds_read_b64_tr_b16 a[98:99], v2 offset:256
  v_mfma_f32_16x16x32_bf16 v[80:83], a[68:71], a[4:7], v[80:83]
  s_mov_b32 s25, s24
  v_exp_f32 v96, v96
  v_mfma_f32_16x16x32_bf16 v[80:83], a[72:75], a[8:11], v[80:83]
  s_mov_b32 s10, s6
  ds_read_b64_tr_b16 a[100:101], v2 offset:16
  ds_read_b64_tr_b16 a[102:103], v2 offset:272
  v_mfma_f32_16x16x32_bf16 v[80:83], a[76:79], a[12:15], v[80:83]
  s_and_b32 s61, s78, 0xffff
  v_exp_f32 v97, v97
  v_mfma_f32_16x16x32_bf16 v[88:91], a[64:67], a[16:19], v[52:55]
  s_lshl_b32 s24, s61, 8
  ds_read_b64_tr_b16 a[104:105], v2 offset:32
  ds_read_b64_tr_b16 a[106:107], v2 offset:288
  v_mfma_f32_16x16x32_bf16 v[88:91], a[68:71], a[20:23], v[88:91]
  s_lshr_b32 s61, s78, 16
  v_exp_f32 v98, v98
  v_mfma_f32_16x16x32_bf16 v[88:91], a[72:75], a[24:27], v[88:91]
  s_lshl_b32 s6, s61, 11
  ds_read_b64_tr_b16 a[108:109], v2 offset:48
  ds_read_b64_tr_b16 a[110:111], v2 offset:304
  v_mfma_f32_16x16x32_bf16 v[88:91], a[76:79], a[28:31], v[88:91]
  s_add_u32 m0, s26, s30
  v_exp_f32 v99, v99
  v_mfma_f32_16x16x32_bf16 v[84:87], a[80:83], a[0:3], v[48:51]
  s_add_u32 s32, s32, 1
  ds_read_b64_tr_b16 a[112:113], v2 offset:64
  ds_read_b64_tr_b16 a[114:115], v2 offset:320
  v_mfma_f32_16x16x32_bf16 v[84:87], a[84:87], a[4:7], v[84:87]
  v_exp_f32 v100, v100
  v_mfma_f32_16x16x32_bf16 v[84:87], a[88:91], a[8:11], v[84:87]
  ds_read_b64_tr_b16 a[116:117], v2 offset:80
  ds_read_b64_tr_b16 a[118:119], v2 offset:336
  v_mfma_f32_16x16x32_bf16 v[84:87], a[92:95], a[12:15], v[84:87]
  v_exp_f32 v101, v101
  v_mfma_f32_16x16x32_bf16 v[92:95], a[80:83], a[16:19], v[52:55]
  ds_read_b64_tr_b16 a[120:121], v2 offset:96
  ds_read_b64_tr_b16 a[122:123], v2 offset:352
  v_mfma_f32_16x16x32_bf16 v[92:95], a[84:87], a[20:23], v[92:95]
  v_exp_f32 v102, v102
  v_mfma_f32_16x16x32_bf16 v[92:95], a[88:91], a[24:27], v[92:95]
  ds_read_b64_tr_b16 a[124:125], v2 offset:112
  ds_read_b64_tr_b16 a[126:127], v2 offset:368
  v_mfma_f32_16x16x32_bf16 v[92:95], a[92:95], a[28:31], v[92:95]
  s_bitcmp1_b32 s40, 0
  v_exp_f32 v103, v103
  v_mfma_f32_16x16x32_bf16 v[112:115], a[64:67], a[32:35], v[56:59]
  s_cselect_b64 vcc, 0, s[42:43]
  v_cndmask_b32 v80, v80, v3, vcc
  v_cndmask_b32 v88, v88, v3, vcc
  v_mfma_f32_16x16x32_bf16 v[112:115], a[68:71], a[36:39], v[112:115]
  v_exp_f32 v104, v104
  v_mfma_f32_16x16x32_bf16 v[112:115], a[72:75], a[40:43], v[112:115]
  s_cselect_b64 vcc, 0, s[44:45]
  v_cndmask_b32 v81, v81, v3, vcc
  v_cndmask_b32 v89, v89, v3, vcc
  v_mfma_f32_16x16x32_bf16 v[112:115], a[76:79], a[44:47], v[112:115]
  v_exp_f32 v105, v105
  v_mfma_f32_16x16x32_bf16 v[120:123], a[64:67], a[48:51], v[60:63]
  s_cselect_b64 vcc, 0, s[46:47]
  v_cndmask_b32 v82, v82, v3, vcc
  v_cndmask_b32 v90, v90, v3, vcc
  v_mfma_f32_16x16x32_bf16 v[120:123], a[68:71], a[52:55], v[120:123]
  v_exp_f32 v106, v106
  v_mfma_f32_16x16x32_bf16 v[120:123], a[72:75], a[56:59], v[120:123]
  s_cselect_b64 vcc, 0, s[48:49]
  v_cndmask_b32 v83, v83, v3, vcc
  v_cndmask_b32 v91, v91, v3, vcc
  v_mfma_f32_16x16x32_bf16 v[120:123], a[76:79], a[60:63], v[120:123]
  v_exp_f32 v107, v107
  v_mfma_f32_16x16x32_bf16 v[116:119], a[80:83], a[32:35], v[56:59]
  s_cselect_b64 vcc, s[42:43], -1
  v_cndmask_b32 v84, v84, v3, vcc
  v_cndmask_b32 v92, v92, v3, vcc
  v_mfma_f32_16x16x32_bf16 v[116:119], a[84:87], a[36:39], v[116:119]
  v_exp_f32 v108, v108
  v_mfma_f32_16x16x32_bf16 v[116:119], a[88:91], a[40:43], v[116:119]
  s_cselect_b64 vcc, s[44:45], -1
  v_cndmask_b32 v85, v85, v3, vcc
  v_cndmask_b32 v93, v93, v3, vcc
  v_mfma_f32_16x16x32_bf16 v[116:119], a[92:95], a[44:47], v[116:119]
  v_exp_f32 v109, v109
  v_mfma_f32_16x16x32_bf16 v[124:127], a[80:83], a[48:51], v[60:63]
  s_cselect_b64 vcc, s[46:47], -1
  v_cndmask_b32 v86, v86, v3, vcc
  v_cndmask_b32 v94, v94, v3, vcc
  v_mfma_f32_16x16x32_bf16 v[124:127], a[84:87], a[52:55], v[124:127]
  v_exp_f32 v110, v110
  v_mfma_f32_16x16x32_bf16 v[124:127], a[88:91], a[56:59], v[124:127]
  s_cselect_b64 vcc, s[48:49], -1
  v_cndmask_b32 v87, v87, v3, vcc
  v_cndmask_b32 v95, v95, v3, vcc
  v_mfma_f32_16x16x32_bf16 v[124:127], a[92:95], a[60:63], v[124:127]
  s_waitcnt lgkmcnt(0)
  v_exp_f32 v111, v111
  v_mfma_f32_16x16x32_bf16 v[128:131], a[96:99], v[64:67], v[128:131]
  v_add_u32 v1, s27, v10
  v_cvt_pk_bf16_f32 v96, v96, v97
  v_mfma_f32_16x16x32_bf16 v[160:163], a[96:99], v[68:71], v[160:163]
  v_exp_f32 v80, v80
  v_mfma_f32_16x16x32_bf16 v[132:135], a[100:103], v[64:67], v[132:135]
  v_cvt_pk_bf16_f32 v97, v98, v99
  v_cvt_pk_bf16_f32 v98, v100, v101
  v_mfma_f32_16x16x32_bf16 v[164:167], a[100:103], v[68:71], v[164:167]
  v_exp_f32 v81, v81
  v_mfma_f32_16x16x32_bf16 v[136:139], a[104:107], v[64:67], v[136:139]
  v_cvt_pk_bf16_f32 v99, v102, v103
  v_cvt_pk_bf16_f32 v100, v104, v105
  v_mfma_f32_16x16x32_bf16 v[168:171], a[104:107], v[68:71], v[168:171]
  v_exp_f32 v82, v82
  v_mfma_f32_16x16x32_bf16 v[140:143], a[108:111], v[64:67], v[140:143]
  v_cvt_pk_bf16_f32 v101, v106, v107
  v_cvt_pk_bf16_f32 v102, v108, v109
  v_mfma_f32_16x16x32_bf16 v[172:175], a[108:111], v[68:71], v[172:175]
  v_exp_f32 v83, v83
  v_mfma_f32_16x16x32_bf16 v[144:147], a[112:115], v[64:67], v[144:147]
  ds_read_b128 a[64:67], v1 offset:0
  v_cvt_pk_bf16_f32 v103, v110, v111
  v_mfma_f32_16x16x32_bf16 v[176:179], a[112:115], v[68:71], v[176:179]
  v_exp_f32 v84, v84
  v_mfma_f32_16x16x32_bf16 v[148:151], a[116:119], v[64:67], v[148:151]
  ds_read_b128 a[68:71], v1 offset:64
  ds_read_b128 a[72:75], v1 offset:128
  v_mfma_f32_16x16x32_bf16 v[180:183], a[116:119], v[68:71], v[180:183]
  v_exp_f32 v85, v85
  v_mfma_f32_16x16x32_bf16 v[152:155], a[120:123], v[64:67], v[152:155]
  ds_read_b128 a[76:79], v1 offset:192
  ds_read_b128 a[80:83], v1 offset:256
  v_mfma_f32_16x16x32_bf16 v[184:187], a[120:123], v[68:71], v[184:187]
  v_exp_f32 v86, v86
  v_mfma_f32_16x16x32_bf16 v[156:159], a[124:127], v[64:67], v[156:159]
  ds_read_b128 a[84:87], v1 offset:320
  ds_read_b128 a[88:91], v1 offset:384
  v_mfma_f32_16x16x32_bf16 v[188:191], a[124:127], v[68:71], v[188:191]
  v_exp_f32 v87, v87
  v_smfmac_f32_16x16x64_bf16 a[128:131], a[144:147], v[64:71], v22
  ds_read_b128 a[92:95], v1 offset:448
  v_mfma_f32_16x16x32_bf16 v[192:195], a[96:99], v[96:99], v[192:195]
  v_exp_f32 v88, v88
  v_mfma_f32_16x16x32_bf16 v[224:227], a[96:99], v[100:103], v[224:227]
  buffer_load_dwordx4 v4, s[4:7], s24 offen offset:0  lds
  v_mfma_f32_16x16x32_bf16 v[196:199], a[100:103], v[96:99], v[196:199]
  v_exp_f32 v89, v89
  v_mfma_f32_16x16x32_bf16 v[228:231], a[100:103], v[100:103], v[228:231]
  v_cvt_pk_bf16_f32 v80, v80, v81
  v_cvt_pk_bf16_f32 v81, v82, v83
  v_mfma_f32_16x16x32_bf16 v[200:203], a[104:107], v[96:99], v[200:203]
  v_exp_f32 v90, v90
  v_mfma_f32_16x16x32_bf16 v[232:235], a[104:107], v[100:103], v[232:235]
  buffer_load_dwordx4 v5, s[4:7], s24 offen offset:1040  lds
  v_mfma_f32_16x16x32_bf16 v[204:207], a[108:111], v[96:99], v[204:207]
  v_exp_f32 v91, v91
  v_mfma_f32_16x16x32_bf16 v[236:239], a[108:111], v[100:103], v[236:239]
  v_cvt_pk_bf16_f32 v82, v84, v85
  v_cvt_pk_bf16_f32 v83, v86, v87
  v_mfma_f32_16x16x32_bf16 v[208:211], a[112:115], v[96:99], v[208:211]
  v_exp_f32 v92, v92
  v_mfma_f32_16x16x32_bf16 v[240:243], a[112:115], v[100:103], v[240:243]
  buffer_load_dwordx4 v6, s[4:7], s24 offen offset:2080  lds
  v_mfma_f32_16x16x32_bf16 v[212:215], a[116:119], v[96:99], v[212:215]
  v_exp_f32 v93, v93
  v_mfma_f32_16x16x32_bf16 v[244:247], a[116:119], v[100:103], v[244:247]
  v_cvt_pk_bf16_f32 v84, v88, v89
  v_cvt_pk_bf16_f32 v85, v90, v91
  v_mfma_f32_16x16x32_bf16 v[216:219], a[120:123], v[96:99], v[216:219]
  v_exp_f32 v94, v94
  v_mfma_f32_16x16x32_bf16 v[248:251], a[120:123], v[100:103], v[248:251]
  buffer_load_dwordx4 v7, s[4:7], s24 offen offset:3120  lds
  v_mfma_f32_16x16x32_bf16 v[220:223], a[124:127], v[96:99], v[220:223]
  s_cmp_eq_u32 s34, 0
  v_exp_f32 v95, v95
  v_mfma_f32_16x16x32_bf16 v[252:255], a[124:127], v[100:103], v[252:255]
  s_waitcnt lgkmcnt(0)
  v_cvt_pk_bf16_f32 v86, v92, v93
  v_cvt_pk_bf16_f32 v87, v94, v95
  v_smfmac_f32_16x16x64_bf16 a[132:135], a[144:147], v[96:103], v22
  s_cbranch_scc1 LU1
LT1:
  v_mfma_f32_16x16x32_bf16 v[96:99], a[64:67], a[32:35], v[56:59]
  s_add_u32 m0, s28, s31
  ds_read_b64_tr_b16 a[96:97], v2 offset:512
  ds_read_b64_tr_b16 a[98:99], v2 offset:768
  v_mfma_f32_16x16x32_bf16 v[96:99], a[68:71], a[36:39], v[96:99]
  s_mov_b32 s29, s26
  v_exp_f32 v112, v112
  v_mfma_f32_16x16x32_bf16 v[96:99], a[72:75], a[40:43], v[96:99]
  s_mov_b32 s26, s27
  ds_read_b64_tr_b16 a[100:101], v2 offset:528
  ds_read_b64_tr_b16 a[102:103], v2 offset:784
  v_mfma_f32_16x16x32_bf16 v[96:99], a[76:79], a[44:47], v[96:99]
  s_mov_b32 s27, s28
  v_exp_f32 v113, v113
  v_mfma_f32_16x16x32_bf16 v[100:103], a[80:83], a[32:35], v[56:59]
  s_mov_b32 s28, s29
  ds_read_b64_tr_b16 a[104:105], v2 offset:544
  ds_read_b64_tr_b16 a[106:107], v2 offset:800
  v_mfma_f32_16x16x32_bf16 v[100:103], a[84:87], a[36:39], v[100:103]
  v_exp_f32 v114, v114
  v_mfma_f32_16x16x32_bf16 v[100:103], a[88:91], a[40:43], v[100:103]
  ds_read_b64_tr_b16 a[108:109], v2 offset:560
  ds_read_b64_tr_b16 a[110:111], v2 offset:816
  v_mfma_f32_16x16x32_bf16 v[100:103], a[92:95], a[44:47], v[100:103]
  v_exp_f32 v115, v115
  v_mfma_f32_16x16x32_bf16 v[104:107], a[64:67], a[48:51], v[60:63]
  ds_read_b64_tr_b16 a[112:113], v2 offset:576
  ds_read_b64_tr_b16 a[114:115], v2 offset:832
  v_mfma_f32_16x16x32_bf16 v[104:107], a[68:71], a[52:55], v[104:107]
  v_exp_f32 v116, v116
  v_mfma_f32_16x16x32_bf16 v[104:107], a[72:75], a[56:59], v[104:107]
  ds_read_b64_tr_b16 a[116:117], v2 offset:592
  ds_read_b64_tr_b16 a[118:119], v2 offset:848
  v_mfma_f32_16x16x32_bf16 v[104:107], a[76:79], a[60:63], v[104:107]
  s_bitcmp1_b32 s40, 6
  v_exp_f32 v117, v117
  v_mfma_f32_16x16x32_bf16 v[108:111], a[80:83], a[48:51], v[60:63]
  s_cbranch_scc1 LT1w
LT1w_back:
  ds_read_b64_tr_b16 a[120:121], v2 offset:608
  ds_read_b64_tr_b16 a[122:123], v2 offset:864
  v_mfma_f32_16x16x32_bf16 v[108:111], a[84:87], a[52:55], v[108:111]
  buffer_load_dwordx4 v4, s[8:11], s25 offen offset:0  lds
  v_exp_f32 v118, v118
  v_mfma_f32_16x16x32_bf16 v[108:111], a[88:91], a[56:59], v[108:111]
  ds_read_b64_tr_b16 a[124:125], v2 offset:624
  ds_read_b64_tr_b16 a[126:127], v2 offset:880
  v_mfma_f32_16x16x32_bf16 v[108:111], a[92:95], a[60:63], v[108:111]
  s_waitcnt lgkmcnt(10)
  v_exp_f32 v119, v119
  v_mfma_f32_16x16x32_bf16 v[128:131], a[96:99], v[80:83], v[128:131]
  ds_read_b128 v[72:75], v12 offset:0
  ds_read_b128 v[76:79], v13 offset:0
  v_mfma_f32_16x16x32_bf16 v[160:163], a[96:99], v[84:87], v[160:163]
  buffer_load_dwordx4 v5, s[8:11], s25 offen offset:1040  lds
  v_exp_f32 v120, v120
  v_mfma_f32_16x16x32_bf16 v[132:135], a[100:103], v[80:83], v[132:135]
  ds_read_b128 v[88:91], v14 offset:0
  ds_read_b128 v[92:95], v15 offset:0
  v_mfma_f32_16x16x32_bf16 v[164:167], a[100:103], v[84:87], v[164:167]
  v_exp_f32 v121, v121
  v_mfma_f32_16x16x32_bf16 v[136:139], a[104:107], v[80:83], v[136:139]
  ds_read_b128 v[40:43], v12 offset:4160
  ds_read_b128 v[44:47], v13 offset:4160
  v_mfma_f32_16x16x32_bf16 v[168:171], a[104:107], v[84:87], v[168:171]
  s_waitcnt lgkmcnt(6)
  buffer_load_dwordx4 v6, s[8:11], s25 offen offset:2080  lds
  v_exp_f32 v122, v122
  v_mfma_f32_16x16x32_bf16 v[140:143], a[108:111], v[80:83], v[140:143]
  ds_read_b128 v[48:51], v14 offset:4160
  ds_read_b128 v[52:55], v15 offset:4160
  v_mfma_f32_16x16x32_bf16 v[172:175], a[108:111], v[84:87], v[172:175]
  v_exp_f32 v123, v123
  v_mfma_f32_16x16x32_bf16 v[144:147], a[112:115], v[80:83], v[144:147]
  v_cvt_pk_bf16_f32 v112, v112, v113
  v_cvt_pk_bf16_f32 v113, v114, v115
  v_mfma_f32_16x16x32_bf16 v[176:179], a[112:115], v[84:87], v[176:179]
  buffer_load_dwordx4 v7, s[8:11], s25 offen offset:3120  lds
  v_exp_f32 v124, v124
  v_mfma_f32_16x16x32_bf16 v[148:151], a[116:119], v[80:83], v[148:151]
  v_cvt_pk_bf16_f32 v114, v116, v117
  v_cvt_pk_bf16_f32 v115, v118, v119
  v_mfma_f32_16x16x32_bf16 v[180:183], a[116:119], v[84:87], v[180:183]
  v_exp_f32 v125, v125
  v_mfma_f32_16x16x32_bf16 v[152:155], a[120:123], v[80:83], v[152:155]
  s_waitcnt lgkmcnt(0)
  ds_read_b128 a[64:67], v1 offset:512
  v_cvt_pk_bf16_f32 v116, v120, v121
  v_mfma_f32_16x16x32_bf16 v[184:187], a[120:123], v[84:87], v[184:187]
  s_add_u32 m0, s76, 0
  s_add_u32 s62, s39, 0
  buffer_load_dwordx4 v23, s[12:15], s62 offen offset:0 nt lds
  v_exp_f32 v126, v126
  v_mfma_f32_16x16x32_bf16 v[156:159], a[124:127], v[80:83], v[156:159]
  ds_read_b128 a[68:71], v1 offset:576
  v_cvt_pk_bf16_f32 v117, v122, v123
  v_mfma_f32_16x16x32_bf16 v[188:191], a[124:127], v[84:87], v[188:191]
  v_exp_f32 v127, v127
  v_smfmac_f32_16x16x64_bf16 a[128:131], a[144:147], v[80:87], v22
  s_add_u32 s62, s39, 15344
  ds_read_b128 a[72:75], v1 offset:640
  buffer_load_dwordx4 v23, s[12:15], s62 offen offset:1040 nt lds
  v_mfma_f32_16x16x32_bf16 v[192:195], a[96:99], v[112:115], v[192:195]
  v_exp_f32 v96, v96
  v_mfma_f32_16x16x32_bf16 v[196:199], a[100:103], v[112:115], v[196:199]
  ds_read_b128 a[76:79], v1 offset:704
  v_cvt_pk_bf16_f32 v118, v124, v125
  v_mfma_f32_16x16x32_bf16 v[200:203], a[104:107], v[112:115], v[200:203]
  s_add_u32 s62, s39, 47072
  buffer_load_dwordx4 v23, s[12:15], s62 offen offset:2080 nt lds
  v_exp_f32 v97, v97
  v_mfma_f32_16x16x32_bf16 v[204:207], a[108:111], v[112:115], v[204:207]
  ds_read_b128 a[80:83], v1 offset:768
  v_cvt_pk_bf16_f32 v119, v126, v127
  v_mfma_f32_16x16x32_bf16 v[208:211], a[112:115], v[112:115], v[208:211]
  s_add_u32 s62, s39, 29648
  buffer_load_dwordx4 v23, s[12:15], s62 offen offset:3120 nt lds
  v_exp_f32 v98, v98
  v_mfma_f32_16x16x32_bf16 v[212:215], a[116:119], v[112:115], v[212:215]
  ds_read_b128 a[84:87], v1 offset:832
  ds_read_b128 a[88:91], v1 offset:896
  v_mfma_f32_16x16x32_bf16 v[216:219], a[120:123], v[112:115], v[216:219]
  s_add_u32 m0, s76, 4160
  s_add_u32 s62, s39, 0
  buffer_load_dwordx4 v33, s[12:15], s62 offen offset:0 nt lds
  v_exp_f32 v99, v99
  v_mfma_f32_16x16x32_bf16 v[220:223], a[124:127], v[112:115], v[220:223]
  ds_read_b128 a[92:95], v1 offset:960
  v_cvt_pk_bf16_f32 v96, v96, v97
  v_mfma_f32_16x16x32_bf16 v[224:227], a[96:99], v[116:119], v[224:227]
  s_add_u32 s62, s39, 15344
  buffer_load_dwordx4 v33, s[12:15], s62 offen offset:1040 nt lds
  v_exp_f32 v100, v100
  v_mfma_f32_16x16x32_bf16 v[228:231], a[100:103], v[116:119], v[228:231]
  v_cvt_pk_bf16_f32 v97, v98, v99
  v_readlane_b32 s78, v20, s32
  v_mfma_f32_16x16x32_bf16 v[232:235], a[104:107], v[116:119], v[232:235]
  s_add_u32 s62, s39, 47072
  buffer_load_dwordx4 v33, s[12:15], s62 offen offset:2080 nt lds
  v_exp_f32 v101, v101
  v_mfma_f32_16x16x32_bf16 v[236:239], a[108:111], v[116:119], v[236:239]
  s_mov_b32 s59, s34
  v_cvt_pk_bf16_f32 v98, v100, v101
  v_add_u32 v2, s26, v11
  v_mfma_f32_16x16x32_bf16 v[240:243], a[112:115], v[116:119], v[240:243]
  v_exp_f32 v102, v102
  v_mfma_f32_16x16x32_bf16 v[244:247], a[116:119], v[116:119], v[244:247]
  s_add_u32 s62, s39, 29648
  buffer_load_dwordx4 v33, s[12:15], s62 offen offset:3120 nt lds
  v_mfma_f32_16x16x32_bf16 v[248:251], a[120:123], v[116:119], v[248:251]
  s_waitcnt vmcnt(16) lgkmcnt(0)
  v_exp_f32 v103, v103
  v_mfma_f32_16x16x32_bf16 v[252:255], a[124:127], v[116:119], v[252:255]
  s_bitcmp1_b32 s40, 5
  v_cvt_pk_bf16_f32 v99, v102, v103
  v_smfmac_f32_16x16x64_bf16 a[132:135], a[144:147], v[112:119], v22
  s_cbranch_scc1 LepiA
LT1_back:
  s_cmp_eq_u32 s34, 1
  s_cbranch_scc1 LJ0
  s_branch LH0
Lpad6:
  s_branch Lpad10
  .p2align 5
  .p2align 6
LH0:
  v_mfma_f32_16x16x32_bf16 v[112:115], a[64:67], a[32:35], v[56:59]
  s_barrier
  v_exp_f32 v104, v104
  v_mfma_f32_16x16x32_bf16 v[112:115], a[68:71], a[36:39], v[112:115]
  s_mov_b32 s25, s24
  ds_read_b64_tr_b16 a[96:97], v2 offset:0
  ds_read_b64_tr_b16 a[98:99], v2 offset:256
  ds_read_b64_tr_b16 a[100:101], v2 offset:16
  v_mfma_f32_16x16x32_bf16 v[112:115], a[72:75], a[40:43], v[112:115]
  s_mov_b32 s10, s6
  v_exp_f32 v105, v105
  v_mfma_f32_16x16x32_bf16 v[112:115], a[76:79], a[44:47], v[112:115]
  s_and_b32 s61, s78, 0xffff
  ds_read_b64_tr_b16 a[102:103], v2 offset:272
  ds_read_b64_tr_b16 a[104:105], v2 offset:32
  ds_read_b64_tr_b16 a[106:107], v2 offset:288
  v_mfma_f32_16x16x32_bf16 v[116:119], a[80:83], a[32:35], v[56:59]
  s_lshl_b32 s24, s61, 8
  v_exp_f32 v106, v106
  v_mfma_f32_16x16x32_bf16 v[116:119], a[84:87], a[36:39], v[116:119]
  s_lshr_b32 s61, s78, 16
  ds_read_b64_tr_b16 a[108:109], v2 offset:48
  ds_read_b64_tr_b16 a[110:111], v2 offset:304
  ds_read_b64_tr_b16 a[112:113], v2 offset:64
  v_mfma_f32_16x16x32_bf16 v[116:119], a[88:91], a[40:43], v[116:119]
  s_lshl_b32 s6, s61, 11
  v_exp_f32 v107, v107
  v_mfma_f32_16x16x32_bf16 v[116:119], a[92:95], a[44:47], v[116:119]
  s_add_u32 m0, s26, s30
  ds_read_b64_tr_b16 a[114:115], v2 offset:320
  ds_read_b64_tr_b16 a[116:117], v2 offset:80
  ds_read_b64_tr_b16 a[118:119], v2 offset:336
  v_mfma_f32_16x16x32_bf16 v[120:123], a[64:67], a[48:51], v[60:63]
  s_add_u32 s32, s32, 1
  v_exp_f32 v108, v108
  v_mfma_f32_16x16x32_bf16 v[120:123], a[68:71], a[52:55], v[120:123]
  ds_read_b64_tr_b16 a[120:121], v2 offset:96
  ds_read_b64_tr_b16 a[122:123], v2 offset:352
  ds_read_b64_tr_b16 a[124:125], v2 offset:112
  ds_read_b64_tr_b16 a[126:127], v2 offset:368
  v_add_u32 v1, s27, v10
  v_mfma_f32_16x16x32_bf16 v[120:123], a[72:75], a[56:59], v[120:123]
  v_exp_f32 v109, v109
  v_mfma_f32_16x16x32_bf16 v[120:123], a[76:79], a[60:63], v[120:123]
  v_cvt_pk_bf16_f32 v100, v104, v105
  v_cvt_pk_bf16_f32 v101, v106, v107
  v_mfma_f32_16x16x32_bf16 v[124:127], a[80:83], a[48:51], v[60:63]
  ds_read_b128 a[64:67], v1 offset:0
  ds_read_b128 a[68:71], v1 offset:64
  v_mfma_f32_16x16x32_bf16 v[124:127], a[84:87], a[52:55], v[124:127]
  v_exp_f32 v110, v110
  v_mfma_f32_16x16x32_bf16 v[124:127], a[88:91], a[56:59], v[124:127]
  ds_read_b128 a[72:75], v1 offset:128
  ds_read_b128 a[76:79], v1 offset:192
  v_mfma_f32_16x16x32_bf16 v[124:127], a[92:95], a[60:63], v[124:127]
  s_waitcnt lgkmcnt(12)
  v_exp_f32 v111, v111
  v_mfma_f32_16x16x32_bf16 v[192:195], a[96:99], v[96:99], v[192:195]
  ds_read_b128 a[80:83], v1 offset:256
  ds_read_b128 a[84:87], v1 offset:320
  v_mfma_f32_16x16x32_bf16 v[196:199], a[100:103], v[96:99], v[196:199]
  v_cvt_pk_bf16_f32 v102, v108, v109
  v_cvt_pk_bf16_f32 v103, v110, v111
  v_mfma_f32_16x16x32_bf16 v[200:203], a[104:107], v[96:99], v[200:203]
  s_waitcnt lgkmcnt(6)
  ds_read_b128 a[88:91], v1 offset:384
  ds_read_b128 a[92:95], v1 offset:448
  v_mfma_f32_16x16x32_bf16 v[204:207], a[108:111], v[96:99], v[204:207]
  buffer_load_dwordx4 v4, s[4:7], s24 offen offset:0  lds
  v_mfma_f32_16x16x32_bf16 v[208:211], a[112:115], v[96:99], v[208:211]
  v_exp_f32 v112, v112
  v_mfma_f32_16x16x32_bf16 v[212:215], a[116:119], v[96:99], v[212:215]
  v_exp_f32 v113, v113
  v_mfma_f32_16x16x32_bf16 v[216:219], a[120:123], v[96:99], v[216:219]
  buffer_load_dwordx4 v5, s[4:7], s24 offen offset:1040  lds
  v_cvt_pk_bf16_f32 v112, v112, v113
  v_mfma_f32_16x16x32_bf16 v[220:223], a[124:127], v[96:99], v[220:223]
  v_exp_f32 v114, v114
  v_mfma_f32_16x16x32_bf16 v[224:227], a[96:99], v[100:103], v[224:227]
  v_exp_f32 v115, v115
  v_mfma_f32_16x16x32_bf16 v[228:231], a[100:103], v[100:103], v[228:231]
  buffer_load_dwordx4 v6, s[4:7], s24 offen offset:2080  lds
  v_cvt_pk_bf16_f32 v113, v114, v115
  v_mfma_f32_16x16x32_bf16 v[232:235], a[104:107], v[100:103], v[232:235]
  s_waitcnt lgkmcnt(0)
  v_exp_f32 v116, v116
  v_mfma_f32_16x16x32_bf16 v[236:239], a[108:111], v[100:103], v[236:239]
  v_exp_f32 v117, v117
  v_mfma_f32_16x16x32_bf16 v[240:243], a[112:115], v[100:103], v[240:243]
  buffer_load_dwordx4 v7, s[4:7], s24 offen offset:3120  lds
  v_cvt_pk_bf16_f32 v114, v116, v117
  v_mfma_f32_16x16x32_bf16 v[244:247], a[116:119], v[100:103], v[244:247]
  v_exp_f32 v118, v118
  v_mfma_f32_16x16x32_bf16 v[248:251], a[120:123], v[100:103], v[248:251]
  s_sub_u32 s34, s34, 1
  v_exp_f32 v119, v119
  v_mfma_f32_16x16x32_bf16 v[252:255], a[124:127], v[100:103], v[252:255]
  s_cmp_gt_u32 s34, 1
  v_cvt_pk_bf16_f32 v115, v118, v119
  v_smfmac_f32_16x16x64_bf16 a[132:135], a[144:147], v[96:103], v22
  s_cbranch_scc0 LJ1
LH1:
  v_mfma_f32_16x16x32_bf16 v[96:99], a[64:67], a[32:35], v[56:59]
  s_add_u32 m0, s28, s31
  v_exp_f32 v120, v120
  v_mfma_f32_16x16x32_bf16 v[96:99], a[68:71], a[36:39], v[96:99]
  s_mov_b32 s29, s26
  ds_read_b64_tr_b16 a[96:97], v2 offset:512
  ds_read_b64_tr_b16 a[98:99], v2 offset:768
  ds_read_b64_tr_b16 a[100:101], v2 offset:528
  v_mfma_f32_16x16x32_bf16 v[96:99], a[72:75], a[40:43], v[96:99]
  s_mov_b32 s26, s27
  v_exp_f32 v121, v121
  v_mfma_f32_16x16x32_bf16 v[96:99], a[76:79], a[44:47], v[96:99]
  s_mov_b32 s27, s28
  ds_read_b64_tr_b16 a[102:103], v2 offset:784
  ds_read_b64_tr_b16 a[104:105], v2 offset:544
  ds_read_b64_tr_b16 a[106:107], v2 offset:800
  v_mfma_f32_16x16x32_bf16 v[100:103], a[80:83], a[32:35], v[56:59]
  s_mov_b32 s28, s29
  v_exp_f32 v122, v122
  v_mfma_f32_16x16x32_bf16 v[100:103], a[84:87], a[36:39], v[100:103]
  ds_read_b64_tr_b16 a[108:109], v2 offset:560
  ds_read_b64_tr_b16 a[110:111], v2 offset:816
  ds_read_b64_tr_b16 a[112:113], v2 offset:576
  v_mfma_f32_16x16x32_bf16 v[100:103], a[88:91], a[40:43], v[100:103]
  v_exp_f32 v123, v123
  v_mfma_f32_16x16x32_bf16 v[100:103], a[92:95], a[44:47], v[100:103]
  ds_read_b64_tr_b16 a[114:115], v2 offset:832
  ds_read_b64_tr_b16 a[116:117], v2 offset:592
  ds_read_b64_tr_b16 a[118:119], v2 offset:848
  v_mfma_f32_16x16x32_bf16 v[104:107], a[64:67], a[48:51], v[60:63]
  v_exp_f32 v124, v124
  v_mfma_f32_16x16x32_bf16 v[104:107], a[68:71], a[52:55], v[104:107]
  ds_read_b64_tr_b16 a[120:121], v2 offset:608
  ds_read_b64_tr_b16 a[122:123], v2 offset:864
  ds_read_b64_tr_b16 a[124:125], v2 offset:624
  ds_read_b64_tr_b16 a[126:127], v2 offset:880
  v_add_u32 v2, s26, v11
  v_mfma_f32_16x16x32_bf16 v[104:107], a[72:75], a[56:59], v[104:107]
  v_exp_f32 v125, v125
  v_mfma_f32_16x16x32_bf16 v[104:107], a[76:79], a[60:63], v[104:107]
  v_cvt_pk_bf16_f32 v116, v120, v121
  v_cvt_pk_bf16_f32 v117, v122, v123
  v_mfma_f32_16x16x32_bf16 v[108:111], a[80:83], a[48:51], v[60:63]
  ds_read_b128 a[64:67], v1 offset:512
  ds_read_b128 a[68:71], v1 offset:576
  v_mfma_f32_16x16x32_bf16 v[108:111], a[84:87], a[52:55], v[108:111]
  v_exp_f32 v126, v126
  v_mfma_f32_16x16x32_bf16 v[108:111], a[88:91], a[56:59], v[108:111]
  ds_read_b128 a[72:75], v1 offset:640
  ds_read_b128 a[76:79], v1 offset:704
  v_mfma_f32_16x16x32_bf16 v[108:111], a[92:95], a[60:63], v[108:111]
  s_waitcnt lgkmcnt(12)
  v_exp_f32 v127, v127
  v_mfma_f32_16x16x32_bf16 v[192:195], a[96:99], v[112:115], v[192:195]
  ds_read_b128 a[80:83], v1 offset:768
  ds_read_b128 a[84:87], v1 offset:832
  v_mfma_f32_16x16x32_bf16 v[196:199], a[100:103], v[112:115], v[196:199]
  v_cvt_pk_bf16_f32 v118, v124, v125
  v_cvt_pk_bf16_f32 v119, v126, v127
  v_mfma_f32_16x16x32_bf16 v[200:203], a[104:107], v[112:115], v[200:203]
  s_waitcnt lgkmcnt(6)
  ds_read_b128 a[88:91], v1 offset:896
  ds_read_b128 a[92:95], v1 offset:960
  v_mfma_f32_16x16x32_bf16 v[204:207], a[108:111], v[112:115], v[204:207]
  buffer_load_dwordx4 v4, s[8:11], s25 offen offset:0  lds
  v_mfma_f32_16x16x32_bf16 v[208:211], a[112:115], v[112:115], v[208:211]
  v_exp_f32 v96, v96
  v_mfma_f32_16x16x32_bf16 v[212:215], a[116:119], v[112:115], v[212:215]
  v_exp_f32 v97, v97
  v_mfma_f32_16x16x32_bf16 v[216:219], a[120:123], v[112:115], v[216:219]
  buffer_load_dwordx4 v5, s[8:11], s25 offen offset:1040  lds
  v_cvt_pk_bf16_f32 v96, v96, v97
  v_readlane_b32 s78, v20, s32
  v_mfma_f32_16x16x32_bf16 v[220:223], a[124:127], v[112:115], v[220:223]
  v_exp_f32 v98, v98
  v_mfma_f32_16x16x32_bf16 v[224:227], a[96:99], v[116:119], v[224:227]
  v_exp_f32 v99, v99
  v_mfma_f32_16x16x32_bf16 v[228:231], a[100:103], v[116:119], v[228:231]
  buffer_load_dwordx4 v6, s[8:11], s25 offen offset:2080  lds
  v_cvt_pk_bf16_f32 v97, v98, v99
  v_mfma_f32_16x16x32_bf16 v[232:235], a[104:107], v[116:119], v[232:235]
  s_waitcnt lgkmcnt(0)
  v_exp_f32 v100, v100
  v_mfma_f32_16x16x32_bf16 v[236:239], a[108:111], v[116:119], v[236:239]
  s_waitcnt vmcnt(15)
  v_exp_f32 v101, v101
  v_mfma_f32_16x16x32_bf16 v[240:243], a[112:115], v[116:119], v[240:243]
  s_cmp_eq_u32 s59, s34
  buffer_load_dwordx4 v7, s[8:11], s25 offen offset:3120  lds
  v_cvt_pk_bf16_f32 v98, v100, v101
  v_mfma_f32_16x16x32_bf16 v[244:247], a[116:119], v[116:119], v[244:247]
  s_cbranch_scc1 LH1_rlx
  s_waitcnt vmcnt(8)
LH1_rlx:
  v_exp_f32 v102, v102
  v_mfma_f32_16x16x32_bf16 v[248:251], a[120:123], v[116:119], v[248:251]
  s_sub_u32 s34, s34, 1
  v_exp_f32 v103, v103
  v_mfma_f32_16x16x32_bf16 v[252:255], a[124:127], v[116:119], v[252:255]
  s_cmp_gt_u32 s34, 1
  v_cvt_pk_bf16_f32 v99, v102, v103
  v_smfmac_f32_16x16x64_bf16 a[132:135], a[144:147], v[112:119], v22
  s_cbranch_scc1 LH0
  s_branch LJ0
  .p2align 12
Lpad7:
  s_branch Lpad11
  .p2align 5
LG1:
  v_mfma_f32_16x16x32_bf16 v[64:67], a[64:67], a[0:3], v[48:51]
  s_add_u32 m0, s28, s31
  ds_read_b64_tr_b16 a[96:97], v2 offset:512
  ds_read_b64_tr_b16 a[98:99], v2 offset:768
  v_mfma_f32_16x16x32_bf16 v[64:67], a[68:71], a[4:7], v[64:67]
  s_mov_b32 s29, s26
  v_exp_f32 v112, v112
  v_mfma_f32_16x16x32_bf16 v[64:67], a[72:75], a[8:11], v[64:67]
  s_mov_b32 s26, s27
  ds_read_b64_tr_b16 a[100:101], v2 offset:528
  ds_read_b64_tr_b16 a[102:103], v2 offset:784
  v_mfma_f32_16x16x32_bf16 v[64:67], a[76:79], a[12:15], v[64:67]
  s_mov_b32 s27, s28
  v_exp_f32 v113, v113
  v_mfma_f32_16x16x32_bf16 v[72:75], a[64:67], a[16:19], v[52:55]
  s_mov_b32 s28, s29
  ds_read_b64_tr_b16 a[104:105], v2 offset:544
  ds_read_b64_tr_b16 a[106:107], v2 offset:800
  v_mfma_f32_16x16x32_bf16 v[72:75], a[68:71], a[20:23], v[72:75]
  v_exp_f32 v114, v114
  v_mfma_f32_16x16x32_bf16 v[72:75], a[72:75], a[24:27], v[72:75]
  ds_read_b64_tr_b16 a[108:109], v2 offset:560
  ds_read_b64_tr_b16 a[110:111], v2 offset:816
  v_mfma_f32_16x16x32_bf16 v[72:75], a[76:79], a[28:31], v[72:75]
  v_exp_f32 v115, v115
  v_mfma_f32_16x16x32_bf16 v[68:71], a[80:83], a[0:3], v[48:51]
  ds_read_b64_tr_b16 a[112:113], v2 offset:576
  ds_read_b64_tr_b16 a[114:115], v2 offset:832
  v_mfma_f32_16x16x32_bf16 v[68:71], a[84:87], a[4:7], v[68:71]
  v_exp_f32 v116, v116
  v_mfma_f32_16x16x32_bf16 v[68:71], a[88:91], a[8:11], v[68:71]
  ds_read_b64_tr_b16 a[116:117], v2 offset:592
  ds_read_b64_tr_b16 a[118:119], v2 offset:848
  v_mfma_f32_16x16x32_bf16 v[68:71], a[92:95], a[12:15], v[68:71]
  v_exp_f32 v117, v117
  v_mfma_f32_16x16x32_bf16 v[76:79], a[80:83], a[16:19], v[52:55]
  ds_read_b64_tr_b16 a[120:121], v2 offset:608
  ds_read_b64_tr_b16 a[122:123], v2 offset:864
  v_mfma_f32_16x16x32_bf16 v[76:79], a[84:87], a[20:23], v[76:79]
  v_exp_f32 v118, v118
  v_mfma_f32_16x16x32_bf16 v[76:79], a[88:91], a[24:27], v[76:79]
  ds_read_b64_tr_b16 a[124:125], v2 offset:624
  ds_read_b64_tr_b16 a[126:127], v2 offset:880
  v_mfma_f32_16x16x32_bf16 v[76:79], a[92:95], a[28:31], v[76:79]
  s_bitcmp1_b32 s40, 0
  v_exp_f32 v119, v119
  v_mfma_f32_16x16x32_bf16 v[96:99], a[64:67], a[32:35], v[56:59]
  s_cselect_b64 vcc, 0, s[42:43]
  v_cndmask_b32 v64, v64, v3, vcc
  v_cndmask_b32 v72, v72, v3, vcc
  v_mfma_f32_16x16x32_bf16 v[96:99], a[68:71], a[36:39], v[96:99]
  v_exp_f32 v120, v120
  v_mfma_f32_16x16x32_bf16 v[96:99], a[72:75], a[40:43], v[96:99]
  s_cselect_b64 vcc, 0, s[44:45]
  v_cndmask_b32 v65, v65, v3, vcc
  v_cndmask_b32 v73, v73, v3, vcc
  v_mfma_f32_16x16x32_bf16 v[96:99], a[76:79], a[44:47], v[96:99]
  v_exp_f32 v121, v121
  v_mfma_f32_16x16x32_bf16 v[104:107], a[64:67], a[48:51], v[60:63]
  s_cselect_b64 vcc, 0, s[46:47]
  v_cndmask_b32 v66, v66, v3, vcc
  v_cndmask_b32 v74, v74, v3, vcc
  v_mfma_f32_16x16x32_bf16 v[104:107], a[68:71], a[52:55], v[104:107]
  v_exp_f32 v122, v122
  v_mfma_f32_16x16x32_bf16 v[104:107], a[72:75], a[56:59], v[104:107]
  s_cselect_b64 vcc, 0, s[48:49]
  v_cndmask_b32 v67, v67, v3, vcc
  v_cndmask_b32 v75, v75, v3, vcc
  v_mfma_f32_16x16x32_bf16 v[104:107], a[76:79], a[60:63], v[104:107]
  v_exp_f32 v123, v123
  v_mfma_f32_16x16x32_bf16 v[100:103], a[80:83], a[32:35], v[56:59]
  s_cselect_b64 vcc, s[42:43], -1
  v_cndmask_b32 v68, v68, v3, vcc
  v_cndmask_b32 v76, v76, v3, vcc
  v_mfma_f32_16x16x32_bf16 v[100:103], a[84:87], a[36:39], v[100:103]
  v_exp_f32 v124, v124
  v_mfma_f32_16x16x32_bf16 v[100:103], a[88:91], a[40:43], v[100:103]
  s_cselect_b64 vcc, s[44:45], -1
  v_cndmask_b32 v69, v69, v3, vcc
  v_cndmask_b32 v77, v77, v3, vcc
  v_mfma_f32_16x16x32_bf16 v[100:103], a[92:95], a[44:47], v[100:103]
  v_exp_f32 v125, v125
  v_mfma_f32_16x16x32_bf16 v[108:111], a[80:83], a[48:51], v[60:63]
  s_cselect_b64 vcc, s[46:47], -1
  v_cndmask_b32 v70, v70, v3, vcc
  v_cndmask_b32 v78, v78, v3, vcc
  v_mfma_f32_16x16x32_bf16 v[108:111], a[84:87], a[52:55], v[108:111]
  v_exp_f32 v126, v126
  v_mfma_f32_16x16x32_bf16 v[108:111], a[88:91], a[56:59], v[108:111]
  s_cselect_b64 vcc, s[48:49], -1
  v_cndmask_b32 v71, v71, v3, vcc
  v_cndmask_b32 v79, v79, v3, vcc
  v_mfma_f32_16x16x32_bf16 v[108:111], a[92:95], a[60:63], v[108:111]
  s_waitcnt lgkmcnt(0)
  v_exp_f32 v127, v127
  v_mfma_f32_16x16x32_bf16 v[128:131], a[96:99], v[80:83], v[128:131]
  v_cvt_pk_bf16_f32 v112, v112, v113
  v_cvt_pk_bf16_f32 v113, v114, v115
  v_mfma_f32_16x16x32_bf16 v[160:163], a[96:99], v[84:87], v[160:163]
  v_exp_f32 v64, v64
  v_mfma_f32_16x16x32_bf16 v[132:135], a[100:103], v[80:83], v[132:135]
  v_cvt_pk_bf16_f32 v114, v116, v117
  v_cvt_pk_bf16_f32 v115, v118, v119
  v_mfma_f32_16x16x32_bf16 v[164:167], a[100:103], v[84:87], v[164:167]
  v_exp_f32 v65, v65
  v_mfma_f32_16x16x32_bf16 v[136:139], a[104:107], v[80:83], v[136:139]
  v_cvt_pk_bf16_f32 v116, v120, v121
  v_cvt_pk_bf16_f32 v117, v122, v123
  v_mfma_f32_16x16x32_bf16 v[168:171], a[104:107], v[84:87], v[168:171]
  v_exp_f32 v66, v66
  v_mfma_f32_16x16x32_bf16 v[140:143], a[108:111], v[80:83], v[140:143]
  v_cvt_pk_bf16_f32 v118, v124, v125
  v_cvt_pk_bf16_f32 v119, v126, v127
  v_mfma_f32_16x16x32_bf16 v[172:175], a[108:111], v[84:87], v[172:175]
  v_exp_f32 v67, v67
  v_mfma_f32_16x16x32_bf16 v[144:147], a[112:115], v[80:83], v[144:147]
  ds_read_b128 a[64:67], v1 offset:512
  ds_read_b128 a[68:71], v1 offset:576
  v_mfma_f32_16x16x32_bf16 v[176:179], a[112:115], v[84:87], v[176:179]
  v_exp_f32 v68, v68
  v_mfma_f32_16x16x32_bf16 v[148:151], a[116:119], v[80:83], v[148:151]
  ds_read_b128 a[72:75], v1 offset:640
  ds_read_b128 a[76:79], v1 offset:704
  v_mfma_f32_16x16x32_bf16 v[180:183], a[116:119], v[84:87], v[180:183]
  v_exp_f32 v69, v69
  v_mfma_f32_16x16x32_bf16 v[152:155], a[120:123], v[80:83], v[152:155]
  ds_read_b128 a[80:83], v1 offset:768
  ds_read_b128 a[84:87], v1 offset:832
  v_mfma_f32_16x16x32_bf16 v[184:187], a[120:123], v[84:87], v[184:187]
  v_exp_f32 v70, v70
  v_mfma_f32_16x16x32_bf16 v[156:159], a[124:127], v[80:83], v[156:159]
  ds_read_b128 a[88:91], v1 offset:896
  ds_read_b128 a[92:95], v1 offset:960
  v_mfma_f32_16x16x32_bf16 v[188:191], a[124:127], v[84:87], v[188:191]
  v_exp_f32 v71, v71
  v_smfmac_f32_16x16x64_bf16 a[128:131], a[144:147], v[80:87], v22
  v_cvt_pk_bf16_f32 v64, v64, v65
  v_mfma_f32_16x16x32_bf16 v[192:195], a[96:99], v[112:115], v[192:195]
  v_exp_f32 v72, v72
  v_mfma_f32_16x16x32_bf16 v[224:227], a[96:99], v[116:119], v[224:227]
  buffer_load_dwordx4 v4, s[8:11], s25 offen offset:0  lds
  v_mfma_f32_16x16x32_bf16 v[196:199], a[100:103], v[112:115], v[196:199]
  v_exp_f32 v73, v73
  v_mfma_f32_16x16x32_bf16 v[228:231], a[100:103], v[116:119], v[228:231]
  v_cvt_pk_bf16_f32 v65, v66, v67
  v_cvt_pk_bf16_f32 v66, v68, v69
  v_mfma_f32_16x16x32_bf16 v[200:203], a[104:107], v[112:115], v[200:203]
  v_exp_f32 v74, v74
  v_mfma_f32_16x16x32_bf16 v[232:235], a[104:107], v[116:119], v[232:235]
  buffer_load_dwordx4 v5, s[8:11], s25 offen offset:1040  lds
  v_mfma_f32_16x16x32_bf16 v[204:207], a[108:111], v[112:115], v[204:207]
  v_exp_f32 v75, v75
  v_mfma_f32_16x16x32_bf16 v[236:239], a[108:111], v[116:119], v[236:239]
  v_cvt_pk_bf16_f32 v67, v70, v71
  v_cvt_pk_bf16_f32 v68, v72, v73
  v_mfma_f32_16x16x32_bf16 v[208:211], a[112:115], v[112:115], v[208:211]
  v_exp_f32 v76, v76
  v_mfma_f32_16x16x32_bf16 v[240:243], a[112:115], v[116:119], v[240:243]
  buffer_load_dwordx4 v6, s[8:11], s25 offen offset:2080  lds
  v_mfma_f32_16x16x32_bf16 v[212:215], a[116:119], v[112:115], v[212:215]
  v_exp_f32 v77, v77
  v_mfma_f32_16x16x32_bf16 v[244:247], a[116:119], v[116:119], v[244:247]
  v_cvt_pk_bf16_f32 v69, v74, v75
  v_cvt_pk_bf16_f32 v70, v76, v77
  v_mfma_f32_16x16x32_bf16 v[216:219], a[120:123], v[112:115], v[216:219]
  v_exp_f32 v78, v78
  v_mfma_f32_16x16x32_bf16 v[248:251], a[120:123], v[116:119], v[248:251]
  buffer_load_dwordx4 v7, s[8:11], s25 offen offset:3120  lds
  v_mfma_f32_16x16x32_bf16 v[220:223], a[124:127], v[112:115], v[220:223]
  s_cmp_eq_u32 s34, 0
  v_exp_f32 v79, v79
  v_mfma_f32_16x16x32_bf16 v[252:255], a[124:127], v[116:119], v[252:255]
  s_waitcnt vmcnt(8) lgkmcnt(0)
  v_readlane_b32 s78, v20, s32
  v_cvt_pk_bf16_f32 v71, v78, v79
  v_add_u32 v2, s26, v11
  v_smfmac_f32_16x16x64_bf16 a[132:135], a[144:147], v[112:119], v22
  s_cbranch_scc1 LU0
LT0:
  v_mfma_f32_16x16x32_bf16 v[112:115], a[64:67], a[32:35], v[56:59]
  s_barrier
  ds_read_b64_tr_b16 a[96:97], v2 offset:0
  ds_read_b64_tr_b16 a[98:99], v2 offset:256
  v_mfma_f32_16x16x32_bf16 v[112:115], a[68:71], a[36:39], v[112:115]
  s_mov_b32 s25, s24
  v_exp_f32 v96, v96
  v_mfma_f32_16x16x32_bf16 v[112:115], a[72:75], a[40:43], v[112:115]
  s_mov_b32 s10, s6
  ds_read_b64_tr_b16 a[100:101], v2 offset:16
  ds_read_b64_tr_b16 a[102:103], v2 offset:272
  v_mfma_f32_16x16x32_bf16 v[112:115], a[76:79], a[44:47], v[112:115]
  s_and_b32 s61, s78, 0xffff
  v_exp_f32 v97, v97
  v_mfma_f32_16x16x32_bf16 v[116:119], a[80:83], a[32:35], v[56:59]
  s_lshl_b32 s24, s61, 8
  ds_read_b64_tr_b16 a[104:105], v2 offset:32
  ds_read_b64_tr_b16 a[106:107], v2 offset:288
  v_mfma_f32_16x16x32_bf16 v[116:119], a[84:87], a[36:39], v[116:119]
  s_lshr_b32 s61, s78, 16
  v_exp_f32 v98, v98
  v_mfma_f32_16x16x32_bf16 v[116:119], a[88:91], a[40:43], v[116:119]
  s_lshl_b32 s6, s61, 11
  ds_read_b64_tr_b16 a[108:109], v2 offset:48
  ds_read_b64_tr_b16 a[110:111], v2 offset:304
  v_mfma_f32_16x16x32_bf16 v[116:119], a[92:95], a[44:47], v[116:119]
  s_add_u32 m0, s26, s30
  v_exp_f32 v99, v99
  v_mfma_f32_16x16x32_bf16 v[120:123], a[64:67], a[48:51], v[60:63]
  s_add_u32 s32, s32, 1
  ds_read_b64_tr_b16 a[112:113], v2 offset:64
  ds_read_b64_tr_b16 a[114:115], v2 offset:320
  v_mfma_f32_16x16x32_bf16 v[120:123], a[68:71], a[52:55], v[120:123]
  v_exp_f32 v100, v100
  v_mfma_f32_16x16x32_bf16 v[120:123], a[72:75], a[56:59], v[120:123]
  ds_read_b64_tr_b16 a[116:117], v2 offset:80
  ds_read_b64_tr_b16 a[118:119], v2 offset:336
  v_mfma_f32_16x16x32_bf16 v[120:123], a[76:79], a[60:63], v[120:123]
  s_bitcmp1_b32 s40, 6
  v_exp_f32 v101, v101
  v_mfma_f32_16x16x32_bf16 v[124:127], a[80:83], a[48:51], v[60:63]
  s_cbranch_scc1 LT0w
LT0w_back:
  ds_read_b64_tr_b16 a[120:121], v2 offset:96
  ds_read_b64_tr_b16 a[122:123], v2 offset:352
  v_mfma_f32_16x16x32_bf16 v[124:127], a[84:87], a[52:55], v[124:127]
  buffer_load_dwordx4 v4, s[4:7], s24 offen offset:0  lds
  v_exp_f32 v102, v102
  v_mfma_f32_16x16x32_bf16 v[124:127], a[88:91], a[56:59], v[124:127]
  ds_read_b64_tr_b16 a[124:125], v2 offset:112
  ds_read_b64_tr_b16 a[126:127], v2 offset:368
  v_mfma_f32_16x16x32_bf16 v[124:127], a[92:95], a[60:63], v[124:127]
  s_waitcnt lgkmcnt(10)
  v_exp_f32 v103, v103
  v_mfma_f32_16x16x32_bf16 v[128:131], a[96:99], v[64:67], v[128:131]
  ds_read_b128 v[72:75], v12 offset:0
  ds_read_b128 v[76:79], v13 offset:0
  v_mfma_f32_16x16x32_bf16 v[160:163], a[96:99], v[68:71], v[160:163]
  buffer_load_dwordx4 v5, s[4:7], s24 offen offset:1040  lds
  v_exp_f32 v104, v104
  v_add_u32 v1, s27, v10
  v_mfma_f32_16x16x32_bf16 v[132:135], a[100:103], v[64:67], v[132:135]
  ds_read_b128 v[88:91], v14 offset:0
  ds_read_b128 v[92:95], v15 offset:0
  v_mfma_f32_16x16x32_bf16 v[164:167], a[100:103], v[68:71], v[164:167]
  v_exp_f32 v105, v105
  v_mfma_f32_16x16x32_bf16 v[136:139], a[104:107], v[64:67], v[136:139]
  ds_read_b128 v[40:43], v12 offset:4160
  ds_read_b128 v[44:47], v13 offset:4160
  v_mfma_f32_16x16x32_bf16 v[168:171], a[104:107], v[68:71], v[168:171]
  s_waitcnt lgkmcnt(6)
  buffer_load_dwordx4 v6, s[4:7], s24 offen offset:2080  lds
  v_exp_f32 v106, v106
  v_mfma_f32_16x16x32_bf16 v[140:143], a[108:111], v[64:67], v[140:143]
  ds_read_b128 v[48:51], v14 offset:4160
  ds_read_b128 v[52:55], v15 offset:4160
  v_mfma_f32_16x16x32_bf16 v[172:175], a[108:111], v[68:71], v[172:175]
  v_exp_f32 v107, v107
  v_mfma_f32_16x16x32_bf16 v[144:147], a[112:115], v[64:67], v[144:147]
  v_cvt_pk_bf16_f32 v96, v96, v97
  v_cvt_pk_bf16_f32 v97, v98, v99
  v_mfma_f32_16x16x32_bf16 v[176:179], a[112:115], v[68:71], v[176:179]
  buffer_load_dwordx4 v7, s[4:7], s24 offen offset:3120  lds
  v_exp_f32 v108, v108
  v_mfma_f32_16x16x32_bf16 v[148:151], a[116:119], v[64:67], v[148:151]
  v_cvt_pk_bf16_f32 v98, v100, v101
  v_cvt_pk_bf16_f32 v99, v102, v103
  v_mfma_f32_16x16x32_bf16 v[180:183], a[116:119], v[68:71], v[180:183]
  v_exp_f32 v109, v109
  v_mfma_f32_16x16x32_bf16 v[152:155], a[120:123], v[64:67], v[152:155]
  s_waitcnt lgkmcnt(0)
  ds_read_b128 a[64:67], v1 offset:0
  v_cvt_pk_bf16_f32 v100, v104, v105
  v_mfma_f32_16x16x32_bf16 v[184:187], a[120:123], v[68:71], v[184:187]
  s_add_u32 m0, s76, 0
  s_add_u32 s62, s39, 0
  buffer_load_dwordx4 v23, s[12:15], s62 offen offset:0 nt lds
  v_exp_f32 v110, v110
  v_mfma_f32_16x16x32_bf16 v[156:159], a[124:127], v[64:67], v[156:159]
  ds_read_b128 a[68:71], v1 offset:64
  v_cvt_pk_bf16_f32 v101, v106, v107
  v_mfma_f32_16x16x32_bf16 v[188:191], a[124:127], v[68:71], v[188:191]
  v_exp_f32 v111, v111
  v_smfmac_f32_16x16x64_bf16 a[128:131], a[144:147], v[64:71], v22
  s_add_u32 s62, s39, 15344
  ds_read_b128 a[72:75], v1 offset:128
  buffer_load_dwordx4 v23, s[12:15], s62 offen offset:1040 nt lds
  v_mfma_f32_16x16x32_bf16 v[192:195], a[96:99], v[96:99], v[192:195]
  v_exp_f32 v112, v112
  v_mfma_f32_16x16x32_bf16 v[196:199], a[100:103], v[96:99], v[196:199]
  ds_read_b128 a[76:79], v1 offset:192
  v_cvt_pk_bf16_f32 v102, v108, v109
  v_mfma_f32_16x16x32_bf16 v[200:203], a[104:107], v[96:99], v[200:203]
  s_add_u32 s62, s39, 47072
  buffer_load_dwordx4 v23, s[12:15], s62 offen offset:2080 nt lds
  v_exp_f32 v113, v113
  v_mfma_f32_16x16x32_bf16 v[204:207], a[108:111], v[96:99], v[204:207]
  ds_read_b128 a[80:83], v1 offset:256
  v_cvt_pk_bf16_f32 v103, v110, v111
  v_mfma_f32_16x16x32_bf16 v[208:211], a[112:115], v[96:99], v[208:211]
  s_add_u32 s62, s39, 29648
  buffer_load_dwordx4 v23, s[12:15], s62 offen offset:3120 nt lds
  v_exp_f32 v114, v114
  v_mfma_f32_16x16x32_bf16 v[212:215], a[116:119], v[96:99], v[212:215]
  ds_read_b128 a[84:87], v1 offset:320
  ds_read_b128 a[88:91], v1 offset:384
  v_mfma_f32_16x16x32_bf16 v[216:219], a[120:123], v[96:99], v[216:219]
  s_add_u32 m0, s76, 4160
  s_add_u32 s62, s39, 0
  buffer_load_dwordx4 v33, s[12:15], s62 offen offset:0 nt lds
  v_exp_f32 v115, v115
  v_mfma_f32_16x16x32_bf16 v[220:223], a[124:127], v[96:99], v[220:223]
  ds_read_b128 a[92:95], v1 offset:448
  v_cvt_pk_bf16_f32 v112, v112, v113
  v_mfma_f32_16x16x32_bf16 v[224:227], a[96:99], v[100:103], v[224:227]
  s_add_u32 s62, s39, 15344
  buffer_load_dwordx4 v33, s[12:15], s62 offen offset:1040 nt lds
  v_exp_f32 v116, v116
  v_mfma_f32_16x16x32_bf16 v[228:231], a[100:103], v[100:103], v[228:231]
  v_cvt_pk_bf16_f32 v113, v114, v115
  v_mfma_f32_16x16x32_bf16 v[232:235], a[104:107], v[100:103], v[232:235]
  s_add_u32 s62, s39, 47072
  buffer_load_dwordx4 v33, s[12:15], s62 offen offset:2080 nt lds
  v_exp_f32 v117, v117
  v_mfma_f32_16x16x32_bf16 v[236:239], a[108:111], v[100:103], v[236:239]
  s_mov_b32 s59, s34
  v_cvt_pk_bf16_f32 v114, v116, v117
  v_mfma_f32_16x16x32_bf16 v[240:243], a[112:115], v[100:103], v[240:243]
  v_exp_f32 v118, v118
  v_mfma_f32_16x16x32_bf16 v[244:247], a[116:119], v[100:103], v[244:247]
  s_add_u32 s62, s39, 29648
  buffer_load_dwordx4 v33, s[12:15], s62 offen offset:3120 nt lds
  v_mfma_f32_16x16x32_bf16 v[248:251], a[120:123], v[100:103], v[248:251]
  s_waitcnt lgkmcnt(0)
  v_exp_f32 v119, v119
  v_mfma_f32_16x16x32_bf16 v[252:255], a[124:127], v[100:103], v[252:255]
  s_bitcmp1_b32 s40, 5
  v_cvt_pk_bf16_f32 v115, v118, v119
  v_smfmac_f32_16x16x64_bf16 a[132:135], a[144:147], v[96:103], v22
  s_cbranch_scc1 LepiA
LT0_back:
  s_cmp_eq_u32 s34, 1
  s_cbranch_scc1 LJ1
  s_branch LH1
Lpad8:
  s_branch Lpad12
  .p2align 5
LU0:
  v_mfma_f32_16x16x32_bf16 v[112:115], a[64:67], a[32:35], v[56:59]
  s_barrier
  ds_read_b64_tr_b16 a[96:97], v2 offset:0
  ds_read_b64_tr_b16 a[98:99], v2 offset:256
  v_mfma_f32_16x16x32_bf16 v[112:115], a[68:71], a[36:39], v[112:115]
  s_mov_b32 s25, s24
  v_exp_f32 v96, v96
  v_mfma_f32_16x16x32_bf16 v[112:115], a[72:75], a[40:43], v[112:115]
  s_mov_b32 s10, s6
  ds_read_b64_tr_b16 a[100:101], v2 offset:16
  ds_read_b64_tr_b16 a[102:103], v2 offset:272
  v_mfma_f32_16x16x32_bf16 v[112:115], a[76:79], a[44:47], v[112:115]
  s_and_b32 s61, s78, 0xffff
  v_exp_f32 v97, v97
  v_mfma_f32_16x16x32_bf16 v[116:119], a[80:83], a[32:35], v[56:59]
  s_lshl_b32 s24, s61, 8
  ds_read_b64_tr_b16 a[104:105], v2 offset:32
  ds_read_b64_tr_b16 a[106:107], v2 offset:288
  v_mfma_f32_16x16x32_bf16 v[116:119], a[84:87], a[36:39], v[116:119]
  s_lshr_b32 s61, s78, 16
  v_exp_f32 v98, v98
  v_mfma_f32_16x16x32_bf16 v[116:119], a[88:91], a[40:43], v[116:119]
  s_lshl_b32 s6, s61, 11
  ds_read_b64_tr_b16 a[108:109], v2 offset:48
  ds_read_b64_tr_b16 a[110:111], v2 offset:304
  v_mfma_f32_16x16x32_bf16 v[116:119], a[92:95], a[44:47], v[116:119]
  s_add_u32 m0, s26, s30
  v_exp_f32 v99, v99
  v_mfma_f32_16x16x32_bf16 v[120:123], a[64:67], a[48:51], v[60:63]
  s_add_u32 s32, s32, 1
  ds_read_b64_tr_b16 a[112:113], v2 offset:64
  ds_read_b64_tr_b16 a[114:115], v2 offset:320
  v_mfma_f32_16x16x32_bf16 v[120:123], a[68:71], a[52:55], v[120:123]
  v_exp_f32 v100, v100
  v_mfma_f32_16x16x32_bf16 v[120:123], a[72:75], a[56:59], v[120:123]
  ds_read_b64_tr_b16 a[116:117], v2 offset:80
  ds_read_b64_tr_b16 a[118:119], v2 offset:336
  v_mfma_f32_16x16x32_bf16 v[120:123], a[76:79], a[60:63], v[120:123]
  s_bitcmp1_b32 s40, 6
  v_exp_f32 v101, v101
  v_mfma_f32_16x16x32_bf16 v[124:127], a[80:83], a[48:51], v[60:63]
  s_cbranch_scc1 LU0w
LU0w_back:
  ds_read_b64_tr_b16 a[120:121], v2 offset:96
  ds_read_b64_tr_b16 a[122:123], v2 offset:352
  v_mfma_f32_16x16x32_bf16 v[124:127], a[84:87], a[52:55], v[124:127]
  buffer_load_dwordx4 v4, s[4:7], s24 offen offset:0  lds
  v_exp_f32 v102, v102
  v_mfma_f32_16x16x32_bf16 v[124:127], a[88:91], a[56:59], v[124:127]
  ds_read_b64_tr_b16 a[124:125], v2 offset:112
  ds_read_b64_tr_b16 a[126:127], v2 offset:368
  v_mfma_f32_16x16x32_bf16 v[124:127], a[92:95], a[60:63], v[124:127]
  s_waitcnt lgkmcnt(10)
  v_exp_f32 v103, v103
  v_mfma_f32_16x16x32_bf16 v[128:131], a[96:99], v[64:67], v[128:131]
  ds_read_b128 v[72:75], v12 offset:0
  ds_read_b128 v[76:79], v13 offset:0
  v_mfma_f32_16x16x32_bf16 v[160:163], a[96:99], v[68:71], v[160:163]
  buffer_load_dwordx4 v5, s[4:7], s24 offen offset:1040  lds
  v_exp_f32 v104, v104
  v_add_u32 v1, s27, v10
  v_mfma_f32_16x16x32_bf16 v[132:135], a[100:103], v[64:67], v[132:135]
  ds_read_b128 v[88:91], v14 offset:0
  ds_read_b128 v[92:95], v15 offset:0
  v_mfma_f32_16x16x32_bf16 v[164:167], a[100:103], v[68:71], v[164:167]
  v_exp_f32 v105, v105
  v_mfma_f32_16x16x32_bf16 v[136:139], a[104:107], v[64:67], v[136:139]
  ds_read_b128 v[40:43], v12 offset:4160
  ds_read_b128 v[44:47], v13 offset:4160
  v_mfma_f32_16x16x32_bf16 v[168:171], a[104:107], v[68:71], v[168:171]
  s_waitcnt lgkmcnt(6)
  buffer_load_dwordx4 v6, s[4:7], s24 offen offset:2080  lds
  v_exp_f32 v106, v106
  v_mfma_f32_16x16x32_bf16 v[140:143], a[108:111], v[64:67], v[140:143]
  s_bitcmp1_b32 s40, 1
  ds_read_b128 v[48:51], v14 offset:4160
  ds_read_b128 v[52:55], v15 offset:4160
  v_mfma_f32_16x16x32_bf16 v[172:175], a[108:111], v[68:71], v[172:175]
  s_cselect_b64 vcc, 0, s[42:43]
  v_exp_f32 v107, v107
  v_cndmask_b32 v112, v112, v3, vcc
  v_cndmask_b32 v120, v120, v3, vcc
  v_mfma_f32_16x16x32_bf16 v[144:147], a[112:115], v[64:67], v[144:147]
  s_cselect_b64 vcc, 0, s[44:45]
  v_cvt_pk_bf16_f32 v96, v96, v97
  v_cvt_pk_bf16_f32 v97, v98, v99
  v_cndmask_b32 v113, v113, v3, vcc
  v_cndmask_b32 v121, v121, v3, vcc
  v_mfma_f32_16x16x32_bf16 v[176:179], a[112:115], v[68:71], v[176:179]
  s_cselect_b64 vcc, 0, s[46:47]
  buffer_load_dwordx4 v7, s[4:7], s24 offen offset:3120  lds
  v_exp_f32 v108, v108
  v_cndmask_b32 v114, v114, v3, vcc
  v_cndmask_b32 v122, v122, v3, vcc
  v_mfma_f32_16x16x32_bf16 v[148:151], a[116:119], v[64:67], v[148:151]
  s_cselect_b64 vcc, 0, s[48:49]
  v_cvt_pk_bf16_f32 v98, v100, v101
  v_cvt_pk_bf16_f32 v99, v102, v103
  v_cndmask_b32 v115, v115, v3, vcc
  v_cndmask_b32 v123, v123, v3, vcc
  v_mfma_f32_16x16x32_bf16 v[180:183], a[116:119], v[68:71], v[180:183]
  s_cselect_b64 vcc, s[42:43], -1
  v_exp_f32 v109, v109
  v_cndmask_b32 v116, v116, v3, vcc
  v_cndmask_b32 v124, v124, v3, vcc
  v_mfma_f32_16x16x32_bf16 v[152:155], a[120:123], v[64:67], v[152:155]
  s_cselect_b64 vcc, s[44:45], -1
  v_cndmask_b32 v117, v117, v3, vcc
  v_cndmask_b32 v125, v125, v3, vcc
  v_mfma_f32_16x16x32_bf16 v[184:187], a[120:123], v[68:71], v[184:187]
  s_cselect_b64 vcc, s[46:47], -1
  v_exp_f32 v110, v110
  v_cndmask_b32 v118, v118, v3, vcc
  v_cndmask_b32 v126, v126, v3, vcc
  v_mfma_f32_16x16x32_bf16 v[156:159], a[124:127], v[64:67], v[156:159]
  s_cselect_b64 vcc, s[48:49], -1
  v_cndmask_b32 v119, v119, v3, vcc
  v_cndmask_b32 v127, v127, v3, vcc
  v_mfma_f32_16x16x32_bf16 v[188:191], a[124:127], v[68:71], v[188:191]
  s_waitcnt lgkmcnt(0)
  v_exp_f32 v111, v111
  v_smfmac_f32_16x16x64_bf16 a[128:131], a[144:147], v[64:71], v22
  s_add_u32 m0, s76, 0
  s_add_u32 s62, s39, 0
  buffer_load_dwordx4 v23, s[12:15], s62 offen offset:0 nt lds
  v_cvt_pk_bf16_f32 v100, v104, v105
  v_mfma_f32_16x16x32_bf16 v[192:195], a[96:99], v[96:99], v[192:195]
  v_exp_f32 v112, v112
  v_mfma_f32_16x16x32_bf16 v[196:199], a[100:103], v[96:99], v[196:199]
  s_add_u32 s62, s39, 15344
  buffer_load_dwordx4 v23, s[12:15], s62 offen offset:1040 nt lds
  v_cvt_pk_bf16_f32 v101, v106, v107
  v_cvt_pk_bf16_f32 v102, v108, v109
  v_mfma_f32_16x16x32_bf16 v[200:203], a[104:107], v[96:99], v[200:203]
  v_exp_f32 v113, v113
  v_mfma_f32_16x16x32_bf16 v[204:207], a[108:111], v[96:99], v[204:207]
  s_add_u32 s62, s39, 47072
  buffer_load_dwordx4 v23, s[12:15], s62 offen offset:2080 nt lds
  v_cvt_pk_bf16_f32 v103, v110, v111
  v_cvt_pk_bf16_f32 v112, v112, v113
  v_mfma_f32_16x16x32_bf16 v[208:211], a[112:115], v[96:99], v[208:211]
  v_exp_f32 v114, v114
  v_mfma_f32_16x16x32_bf16 v[212:215], a[116:119], v[96:99], v[212:215]
  s_add_u32 s62, s39, 29648
  buffer_load_dwordx4 v23, s[12:15], s62 offen offset:3120 nt lds
  v_mfma_f32_16x16x32_bf16 v[216:219], a[120:123], v[96:99], v[216:219]
  v_exp_f32 v115, v115
  v_mfma_f32_16x16x32_bf16 v[220:223], a[124:127], v[96:99], v[220:223]
  s_add_u32 m0, s76, 4160
  s_add_u32 s62, s39, 0
  buffer_load_dwordx4 v33, s[12:15], s62 offen offset:0 nt lds
  v_cvt_pk_bf16_f32 v113, v114, v115
  v_mfma_f32_16x16x32_bf16 v[224:227], a[96:99], v[100:103], v[224:227]
  v_exp_f32 v116, v116
  v_mfma_f32_16x16x32_bf16 v[228:231], a[100:103], v[100:103], v[228:231]
  s_add_u32 s62, s39, 15344
  buffer_load_dwordx4 v33, s[12:15], s62 offen offset:1040 nt lds
  v_mfma_f32_16x16x32_bf16 v[232:235], a[104:107], v[100:103], v[232:235]
  v_exp_f32 v117, v117
  v_mfma_f32_16x16x32_bf16 v[236:239], a[108:111], v[100:103], v[236:239]
  s_add_u32 s62, s39, 47072
  buffer_load_dwordx4 v33, s[12:15], s62 offen offset:2080 nt lds
  v_cvt_pk_bf16_f32 v114, v116, v117
  v_mfma_f32_16x16x32_bf16 v[240:243], a[112:115], v[100:103], v[240:243]
  v_exp_f32 v118, v118
  v_mfma_f32_16x16x32_bf16 v[244:247], a[116:119], v[100:103], v[244:247]
  s_add_u32 s62, s39, 29648
  buffer_load_dwordx4 v33, s[12:15], s62 offen offset:3120 nt lds
  v_mfma_f32_16x16x32_bf16 v[248:251], a[120:123], v[100:103], v[248:251]
  s_waitcnt lgkmcnt(0)
  v_exp_f32 v119, v119
  v_mfma_f32_16x16x32_bf16 v[252:255], a[124:127], v[100:103], v[252:255]
  s_bitcmp1_b32 s40, 5
  v_cvt_pk_bf16_f32 v115, v118, v119
  v_smfmac_f32_16x16x64_bf16 a[132:135], a[144:147], v[96:103], v22
  s_cbranch_scc1 LepiA
  s_branch LL1
Lpad9:
  s_branch Lpads_back
  .p2align 5
Lidle0:
  s_bitset0_b32 s40, 11
  s_mov_b32 m0, s70
  s_nop 0
  buffer_load_dwordx4 v4, s[4:7], s24 offen offset:0  lds
  buffer_load_dwordx4 v5, s[4:7], s24 offen offset:1040  lds
  buffer_load_dwordx4 v6, s[4:7], s24 offen offset:2080  lds
  buffer_load_dwordx4 v7, s[4:7], s24 offen offset:3120  lds
Lidle1:
  s_mov_b32 m0, s71
  s_bitcmp1_b32 s40, 11
  buffer_load_dwordx4 v4, s[8:11], s25 offen offset:0  lds
  buffer_load_dwordx4 v5, s[8:11], s25 offen offset:1040  lds
  buffer_load_dwordx4 v6, s[8:11], s25 offen offset:2080  lds
  buffer_load_dwordx4 v7, s[8:11], s25 offen offset:3120  lds
  s_waitcnt vmcnt(16)
  s_cbranch_scc1 Lidle2
  s_waitcnt vmcnt(8)
Lidle2:
  s_barrier
  s_mov_b32 s25, s24
  s_mov_b32 s10, s6
  s_and_b32 s61, s78, 0xffff
  s_lshl_b32 s24, s61, 8
  s_lshr_b32 s61, s78, 16
  s_lshl_b32 s6, s61, 11
  s_add_u32 s32, s32, 1
  s_add_u32 s70, s26, s30
  s_add_u32 s71, s28, s31
  v_add_u32 v1, s27, v10
  v_readlane_b32 s78, v20, s32
  s_mov_b32 s29, s26
  s_mov_b32 s26, s27
  s_mov_b32 s27, s28
  s_mov_b32 s28, s29
  v_add_u32 v2, s26, v11
  s_sub_u32 s35, s35, 1
  s_cmp_eq_u32 s35, 0
  s_cbranch_scc1 Ltail
  s_branch Lidle0
LepiA_ret:
  s_bitcmp1_b32 s40, 8
  s_cbranch_scc0 LepiA_ret1
  s_waitcnt lgkmcnt(0)
  buffer_store_dwordx4 v[160:163], v18, s[16:19], s36 offen sc0 sc1
  buffer_store_dwordx4 v[164:167], v18, s[16:19], s64 offen sc0 sc1
  buffer_store_dwordx4 v[168:171], v18, s[16:19], s65 offen sc0 sc1
  buffer_store_dwordx4 v[172:175], v18, s[16:19], s66 offen sc0 sc1
  s_mov_b32 s36, s18
  s_mov_b32 s64, s18
  s_mov_b32 s65, s18
  s_mov_b32 s66, s18
LepiA_ret1:
  s_cmp_eq_u32 s34, 0
  s_cbranch_scc1 LepiA_ret2
  s_bitcmp1_b32 s40, 7
  s_cbranch_scc0 LT0_back
  s_branch LT1_back
LepiA_ret2:
  s_bitcmp1_b32 s40, 7
  s_cbranch_scc0 LL1
  s_branch LL0
  .p2align 12
Lpad10:
  s_branch Lpads_back
  .p2align 5
LepiA:
  v_accvgpr_read_b32 v24, a128
  v_accvgpr_read_b32 v25, a129
  v_accvgpr_read_b32 v26, a130
  v_accvgpr_read_b32 v27, a131
  v_add_f32 v24, v24, v25
  v_add_f32 v26, v26, v27
  v_add_f32 v25, v24, v26
  v_rcp_f32 v24, v24
  v_cmp_ngt_f32 vcc, s58, v25
  v_rcp_f32 v26, v26
  s_add_u32 s64, s36, 16384
  s_add_u32 s65, s36, 32768
  s_add_u32 s66, s36, 49152
  s_or_b64 s[52:53], s[52:53], vcc
  s_branch LepiA2
Ltail_e:
  s_bitcmp1_b32 s40, 13
  s_cbranch_scc0 LepiB
  s_mov_b32 m0, s41
  s_branch LepiA3
  .p2align 5
LJ0:
  v_mfma_f32_16x16x32_bf16 v[112:115], a[64:67], a[32:35], v[56:59]
  s_barrier
  v_exp_f32 v104, v104
  v_mfma_f32_16x16x32_bf16 v[112:115], a[68:71], a[36:39], v[112:115]
  s_mov_b32 s25, s24
  ds_read_b64_tr_b16 a[96:97], v2 offset:0
  ds_read_b64_tr_b16 a[98:99], v2 offset:256
  ds_read_b64_tr_b16 a[100:101], v2 offset:16
  v_mfma_f32_16x16x32_bf16 v[112:115], a[72:75], a[40:43], v[112:115]
  s_mov_b32 s10, s6
  v_exp_f32 v105, v105
  v_mfma_f32_16x16x32_bf16 v[112:115], a[76:79], a[44:47], v[112:115]
  s_and_b32 s61, s78, 0xffff
  ds_read_b64_tr_b16 a[102:103], v2 offset:272
  ds_read_b64_tr_b16 a[104:105], v2 offset:32
  ds_read_b64_tr_b16 a[106:107], v2 offset:288
  v_mfma_f32_16x16x32_bf16 v[116:119], a[80:83], a[32:35], v[56:59]
  s_lshl_b32 s24, s61, 8
  v_exp_f32 v106, v106
  v_mfma_f32_16x16x32_bf16 v[116:119], a[84:87], a[36:39], v[116:119]
  s_lshr_b32 s61, s78, 16
  ds_read_b64_tr_b16 a[108:109], v2 offset:48
  ds_read_b64_tr_b16 a[110:111], v2 offset:304
  ds_read_b64_tr_b16 a[112:113], v2 offset:64
  v_mfma_f32_16x16x32_bf16 v[116:119], a[88:91], a[40:43], v[116:119]
  s_lshl_b32 s6, s61, 11
  v_exp_f32 v107, v107
  v_mfma_f32_16x16x32_bf16 v[116:119], a[92:95], a[44:47], v[116:119]
  s_add_u32 m0, s26, s30
  ds_read_b64_tr_b16 a[114:115], v2 offset:320
  ds_read_b64_tr_b16 a[116:117], v2 offset:80
  ds_read_b64_tr_b16 a[118:119], v2 offset:336
  v_mfma_f32_16x16x32_bf16 v[120:123], a[64:67], a[48:51], v[60:63]
  s_add_u32 s32, s32, 1
  v_exp_f32 v108, v108
  v_mfma_f32_16x16x32_bf16 v[120:123], a[68:71], a[52:55], v[120:123]
  ds_read_b64_tr_b16 a[120:121], v2 offset:96
  ds_read_b64_tr_b16 a[122:123], v2 offset:352
  ds_read_b64_tr_b16 a[124:125], v2 offset:112
  ds_read_b64_tr_b16 a[126:127], v2 offset:368
  v_add_u32 v1, s27, v10
  v_mfma_f32_16x16x32_bf16 v[120:123], a[72:75], a[56:59], v[120:123]
  v_exp_f32 v109, v109
  v_mfma_f32_16x16x32_bf16 v[120:123], a[76:79], a[60:63], v[120:123]
  v_cvt_pk_bf16_f32 v100, v104, v105
  v_cvt_pk_bf16_f32 v101, v106, v107
  v_mfma_f32_16x16x32_bf16 v[124:127], a[80:83], a[48:51], v[60:63]
  buffer_load_dwordx4 v4, s[4:7], s24 offen offset:0  lds
  v_mfma_f32_16x16x32_bf16 v[124:127], a[84:87], a[52:55], v[124:127]
  v_exp_f32 v110, v110
  v_mfma_f32_16x16x32_bf16 v[124:127], a[88:91], a[56:59], v[124:127]
  buffer_load_dwordx4 v5, s[4:7], s24 offen offset:1040  lds
  v_mfma_f32_16x16x32_bf16 v[124:127], a[92:95], a[60:63], v[124:127]
  s_waitcnt lgkmcnt(0)
  v_exp_f32 v111, v111
  v_mfma_f32_16x16x32_bf16 v[192:195], a[96:99], v[96:99], v[192:195]
  s_bitcmp1_b32 s40, 1
  v_cvt_pk_bf16_f32 v102, v108, v109
  v_cvt_pk_bf16_f32 v103, v110, v111
  v_mfma_f32_16x16x32_bf16 v[196:199], a[100:103], v[96:99], v[196:199]
  s_cselect_b64 vcc, 0, s[42:43]
  v_cndmask_b32 v112, v112, v3, vcc
  v_cndmask_b32 v120, v120, v3, vcc
  v_mfma_f32_16x16x32_bf16 v[200:203], a[104:107], v[96:99], v[200:203]
  s_cselect_b64 vcc, 0, s[44:45]
  v_cndmask_b32 v113, v113, v3, vcc
  v_cndmask_b32 v121, v121, v3, vcc
  v_mfma_f32_16x16x32_bf16 v[204:207], a[108:111], v[96:99], v[204:207]
  s_cselect_b64 vcc, 0, s[46:47]
  v_cndmask_b32 v114, v114, v3, vcc
  v_cndmask_b32 v122, v122, v3, vcc
  v_mfma_f32_16x16x32_bf16 v[208:211], a[112:115], v[96:99], v[208:211]
  s_cselect_b64 vcc, 0, s[48:49]
  v_cndmask_b32 v115, v115, v3, vcc
  v_cndmask_b32 v123, v123, v3, vcc
  v_mfma_f32_16x16x32_bf16 v[212:215], a[116:119], v[96:99], v[212:215]
  s_cselect_b64 vcc, s[42:43], -1
  v_cndmask_b32 v116, v116, v3, vcc
  v_cndmask_b32 v124, v124, v3, vcc
  v_exp_f32 v112, v112
  v_mfma_f32_16x16x32_bf16 v[216:219], a[120:123], v[96:99], v[216:219]
  s_cselect_b64 vcc, s[44:45], -1
  v_cndmask_b32 v117, v117, v3, vcc
  v_cndmask_b32 v125, v125, v3, vcc
  v_exp_f32 v113, v113
  v_mfma_f32_16x16x32_bf16 v[220:223], a[124:127], v[96:99], v[220:223]
  s_cselect_b64 vcc, s[46:47], -1
  v_cndmask_b32 v118, v118, v3, vcc
  v_cndmask_b32 v126, v126, v3, vcc
  v_exp_f32 v114, v114
  v_mfma_f32_16x16x32_bf16 v[224:227], a[96:99], v[100:103], v[224:227]
  s_cselect_b64 vcc, s[48:49], -1
  v_cndmask_b32 v119, v119, v3, vcc
  v_cndmask_b32 v127, v127, v3, vcc
  v_exp_f32 v115, v115
  v_mfma_f32_16x16x32_bf16 v[228:231], a[100:103], v[100:103], v[228:231]
  buffer_load_dwordx4 v6, s[4:7], s24 offen offset:2080  lds
  v_cvt_pk_bf16_f32 v112, v112, v113
  v_mfma_f32_16x16x32_bf16 v[232:235], a[104:107], v[100:103], v[232:235]
  v_exp_f32 v116, v116
  v_mfma_f32_16x16x32_bf16 v[236:239], a[108:111], v[100:103], v[236:239]
  v_exp_f32 v117, v117
  v_mfma_f32_16x16x32_bf16 v[240:243], a[112:115], v[100:103], v[240:243]
  buffer_load_dwordx4 v7, s[4:7], s24 offen offset:3120  lds
  v_cvt_pk_bf16_f32 v113, v114, v115
  v_mfma_f32_16x16x32_bf16 v[244:247], a[116:119], v[100:103], v[244:247]
  v_exp_f32 v118, v118
  v_mfma_f32_16x16x32_bf16 v[248:251], a[120:123], v[100:103], v[248:251]
  v_exp_f32 v119, v119
  v_mfma_f32_16x16x32_bf16 v[252:255], a[124:127], v[100:103], v[252:255]
  v_cvt_pk_bf16_f32 v114, v116, v117
  v_cvt_pk_bf16_f32 v115, v118, v119
  v_smfmac_f32_16x16x64_bf16 a[132:135], a[144:147], v[96:103], v22
LL1:
  ds_read_b64_tr_b16 a[96:97], v2 offset:512
  ds_read_b64_tr_b16 a[98:99], v2 offset:768
  ds_read_b64_tr_b16 a[100:101], v2 offset:528
  ds_read_b64_tr_b16 a[102:103], v2 offset:784
  ds_read_b64_tr_b16 a[104:105], v2 offset:544
  ds_read_b64_tr_b16 a[106:107], v2 offset:800
  ds_read_b64_tr_b16 a[108:109], v2 offset:560
  ds_read_b64_tr_b16 a[110:111], v2 offset:816
  ds_read_b64_tr_b16 a[112:113], v2 offset:576
  ds_read_b64_tr_b16 a[114:115], v2 offset:832
  ds_read_b64_tr_b16 a[116:117], v2 offset:592
  ds_read_b64_tr_b16 a[118:119], v2 offset:848
  ds_read_b64_tr_b16 a[120:121], v2 offset:608
  ds_read_b64_tr_b16 a[122:123], v2 offset:864
  ds_read_b64_tr_b16 a[124:125], v2 offset:624
  ds_read_b64_tr_b16 a[126:127], v2 offset:880
  s_add_u32 s71, s28, s31
  v_exp_f32 v120, v120
  v_exp_f32 v121, v121
  v_exp_f32 v122, v122
  s_waitcnt lgkmcnt(12)
  v_mfma_f32_16x16x32_bf16 v[192:195], a[96:99], v[112:115], v[192:195]
  s_mov_b32 s29, s26
  v_exp_f32 v123, v123
  v_mfma_f32_16x16x32_bf16 v[196:199], a[100:103], v[112:115], v[196:199]
  s_waitcnt lgkmcnt(6)
  v_exp_f32 v124, v124
  v_mfma_f32_16x16x32_bf16 v[200:203], a[104:107], v[112:115], v[200:203]
  s_mov_b32 s26, s27
  v_exp_f32 v125, v125
  v_mfma_f32_16x16x32_bf16 v[204:207], a[108:111], v[112:115], v[204:207]
  s_mov_b32 s27, s28
  v_exp_f32 v126, v126
  v_mfma_f32_16x16x32_bf16 v[208:211], a[112:115], v[112:115], v[208:211]
  s_waitcnt lgkmcnt(0)
  v_exp_f32 v127, v127
  v_mfma_f32_16x16x32_bf16 v[212:215], a[116:119], v[112:115], v[212:215]
  s_mov_b32 s28, s29
  v_cvt_pk_bf16_f32 v116, v120, v121
  v_cvt_pk_bf16_f32 v117, v122, v123
  v_mfma_f32_16x16x32_bf16 v[216:219], a[120:123], v[112:115], v[216:219]
  s_add_u32 s64, s36, 16384
  v_cvt_pk_bf16_f32 v118, v124, v125
  v_cvt_pk_bf16_f32 v119, v126, v127
  v_mfma_f32_16x16x32_bf16 v[220:223], a[124:127], v[112:115], v[220:223]
  s_add_u32 s65, s36, 32768
  v_accvgpr_read_b32 v24, a128
  v_accvgpr_read_b32 v25, a129
  v_smfmac_f32_16x16x64_bf16 a[132:135], a[144:147], v[112:119], v22
  s_add_u32 s66, s36, 49152
  v_accvgpr_read_b32 v26, a130
  v_readlane_b32 s78, v20, s32
  v_mfma_f32_16x16x32_bf16 v[224:227], a[96:99], v[116:119], v[224:227]
  s_add_u32 s67, s37, 16384
  v_accvgpr_read_b32 v27, a131
  v_add_f32 v24, v24, v25
  v_mfma_f32_16x16x32_bf16 v[228:231], a[100:103], v[116:119], v[228:231]
  s_add_u32 s68, s37, 32768
  v_add_f32 v26, v26, v27
  v_add_f32 v25, v24, v26
  v_mfma_f32_16x16x32_bf16 v[232:235], a[104:107], v[116:119], v[232:235]
  s_add_u32 s69, s37, 49152
  v_rcp_f32 v24, v24
  v_mfma_f32_16x16x32_bf16 v[236:239], a[108:111], v[116:119], v[236:239]
  v_cmp_ngt_f32 vcc, s58, v25
  v_rcp_f32 v26, v26
  v_mfma_f32_16x16x32_bf16 v[240:243], a[112:115], v[116:119], v[240:243]
  s_or_b64 s[52:53], s[52:53], vcc
  v_accvgpr_read_b32 v28, a132
  v_accvgpr_read_b32 v29, a133
  v_mfma_f32_16x16x32_bf16 v[244:247], a[116:119], v[116:119], v[244:247]
  v_accvgpr_read_b32 v30, a134
  v_accvgpr_read_b32 v31, a135
  v_mfma_f32_16x16x32_bf16 v[248:251], a[120:123], v[116:119], v[248:251]
  v_add_f32 v28, v28, v29
  v_add_f32 v30, v30, v31
  v_mfma_f32_16x16x32_bf16 v[252:255], a[124:127], v[116:119], v[252:255]
  v_add_f32 v29, v28, v30
  v_rcp_f32 v28, v28
  v_cmp_ngt_f32 vcc, s58, v29
  v_rcp_f32 v30, v30
  v_add_u32 v2, s26, v11
  s_or_b64 s[52:53], s[52:53], vcc
  s_cmp_eq_u32 s35, 0
  s_cbranch_scc0 Lidle1
Ltail:
  s_bitcmp1_b32 s40, 5
  s_cbranch_scc1 Ltail_e
LepiA2:
  s_mov_b32 m0, s41
  s_bitcmp1_b32 s40, 13
  v_pk_mul_f32 v[128:129], v[128:129], v[24:25] op_sel_hi:[1,0]
  v_pk_mul_f32 v[130:131], v[130:131], v[24:25] op_sel_hi:[1,0]
  v_pk_mul_f32 v[132:133], v[132:133], v[24:25] op_sel_hi:[1,0]
  v_pk_mul_f32 v[134:135], v[134:135], v[24:25] op_sel_hi:[1,0]
  v_pk_mul_f32 v[136:137], v[136:137], v[24:25] op_sel_hi:[1,0]
  v_pk_mul_f32 v[138:139], v[138:139], v[24:25] op_sel_hi:[1,0]
  v_pk_mul_f32 v[140:141], v[140:141], v[24:25] op_sel_hi:[1,0]
  v_pk_mul_f32 v[142:143], v[142:143], v[24:25] op_sel_hi:[1,0]
  v_pk_mul_f32 v[144:145], v[144:145], v[24:25] op_sel_hi:[1,0]
  v_pk_mul_f32 v[146:147], v[146:147], v[24:25] op_sel_hi:[1,0]
  v_pk_mul_f32 v[148:149], v[148:149], v[24:25] op_sel_hi:[1,0]
  v_pk_mul_f32 v[150:151], v[150:151], v[24:25] op_sel_hi:[1,0]
  v_pk_mul_f32 v[152:153], v[152:153], v[24:25] op_sel_hi:[1,0]
  v_pk_mul_f32 v[154:155], v[154:155], v[24:25] op_sel_hi:[1,0]
  v_pk_mul_f32 v[156:157], v[156:157], v[24:25] op_sel_hi:[1,0]
  v_pk_mul_f32 v[158:159], v[158:159], v[24:25] op_sel_hi:[1,0]
  v_cvt_pk_bf16_f32 v128, v128, v129
  v_cvt_pk_bf16_f32 v129, v130, v131
  v_cvt_pk_bf16_f32 v132, v132, v133
  v_cvt_pk_bf16_f32 v133, v134, v135
  v_cvt_pk_bf16_f32 v136, v136, v137
  v_cvt_pk_bf16_f32 v137, v138, v139
  v_cvt_pk_bf16_f32 v140, v140, v141
  v_cvt_pk_bf16_f32 v141, v142, v143
  v_cvt_pk_bf16_f32 v144, v144, v145
  v_cvt_pk_bf16_f32 v145, v146, v147
  v_cvt_pk_bf16_f32 v148, v148, v149
  v_cvt_pk_bf16_f32 v149, v150, v151
  v_cvt_pk_bf16_f32 v152, v152, v153
  v_cvt_pk_bf16_f32 v153, v154, v155
  v_cvt_pk_bf16_f32 v156, v156, v157
  v_cvt_pk_bf16_f32 v157, v158, v159
  ds_write_addtid_b32 v128 offset:49152
  ds_write_addtid_b32 v129 offset:49416
  ds_write_addtid_b32 v132 offset:49680
  ds_write_addtid_b32 v133 offset:49944
  ds_write_addtid_b32 v136 offset:50208
  ds_write_addtid_b32 v137 offset:50472
  ds_write_addtid_b32 v140 offset:50736
  ds_write_addtid_b32 v141 offset:51000
  ds_write_addtid_b32 v144 offset:51264
  ds_write_addtid_b32 v145 offset:51528
  ds_write_addtid_b32 v148 offset:51792
  ds_write_addtid_b32 v149 offset:52056
  ds_write_addtid_b32 v152 offset:52320
  ds_write_addtid_b32 v153 offset:52584
  ds_write_addtid_b32 v156 offset:52848
  ds_write_addtid_b32 v157 offset:53112
  ds_read2_b32 v[128:129], v16 offset0:0 offset1:66
  ds_read2_b32 v[130:131], v16 offset0:16 offset1:82
  ds_read2_b32 v[132:133], v16 offset0:4 offset1:70
  ds_read2_b32 v[134:135], v16 offset0:20 offset1:86
  ds_read2_b32 v[136:137], v16 offset0:8 offset1:74
  ds_read2_b32 v[138:139], v16 offset0:24 offset1:90
  ds_read2_b32 v[140:141], v16 offset0:12 offset1:78
  ds_read2_b32 v[142:143], v16 offset0:28 offset1:94
  s_cbranch_scc1 LepiA_ret1
LepiA3:
  v_pk_mul_f32 v[160:161], v[160:161], v[26:27] op_sel_hi:[1,0]
  v_pk_mul_f32 v[162:163], v[162:163], v[26:27] op_sel_hi:[1,0]
  v_pk_mul_f32 v[164:165], v[164:165], v[26:27] op_sel_hi:[1,0]
  v_pk_mul_f32 v[166:167], v[166:167], v[26:27] op_sel_hi:[1,0]
  v_pk_mul_f32 v[168:169], v[168:169], v[26:27] op_sel_hi:[1,0]
  v_pk_mul_f32 v[170:171], v[170:171], v[26:27] op_sel_hi:[1,0]
  v_pk_mul_f32 v[172:173], v[172:173], v[26:27] op_sel_hi:[1,0]
  v_pk_mul_f32 v[174:175], v[174:175], v[26:27] op_sel_hi:[1,0]
  v_pk_mul_f32 v[176:177], v[176:177], v[26:27] op_sel_hi:[1,0]
  v_pk_mul_f32 v[178:179], v[178:179], v[26:27] op_sel_hi:[1,0]
  v_pk_mul_f32 v[180:181], v[180:181], v[26:27] op_sel_hi:[1,0]
  v_pk_mul_f32 v[182:183], v[182:183], v[26:27] op_sel_hi:[1,0]
  v_pk_mul_f32 v[184:185], v[184:185], v[26:27] op_sel_hi:[1,0]
  v_pk_mul_f32 v[186:187], v[186:187], v[26:27] op_sel_hi:[1,0]
  v_pk_mul_f32 v[188:189], v[188:189], v[26:27] op_sel_hi:[1,0]
  v_pk_mul_f32 v[190:191], v[190:191], v[26:27] op_sel_hi:[1,0]
  v_mfma_f32_32x32x16_bf16 v[144:159], a[148:151], a[148:151], 0
  v_cvt_pk_bf16_f32 v160, v160, v161
  s_waitcnt lgkmcnt(0)
  buffer_store_dwordx4 v[128:131], v8, s[16:19], s36 offen sc0 sc1
  v_cvt_pk_bf16_f32 v161, v162, v163
  v_cvt_pk_bf16_f32 v164, v164, v165
  v_cvt_pk_bf16_f32 v165, v166, v167
  v_cvt_pk_bf16_f32 v168, v168, v169
  v_cvt_pk_bf16_f32 v169, v170, v171
  v_cvt_pk_bf16_f32 v172, v172, v173
  v_cvt_pk_bf16_f32 v173, v174, v175
  v_cvt_pk_bf16_f32 v176, v176, v177
  v_cvt_pk_bf16_f32 v177, v178, v179
  v_cvt_pk_bf16_f32 v180, v180, v181
  v_cvt_pk_bf16_f32 v181, v182, v183
  v_cvt_pk_bf16_f32 v184, v184, v185
  v_cvt_pk_bf16_f32 v185, v186, v187
  v_cvt_pk_bf16_f32 v188, v188, v189
  v_cvt_pk_bf16_f32 v189, v190, v191
  buffer_store_dwordx4 v[132:135], v8, s[16:19], s64 offen sc0 sc1
  ds_write_addtid_b32 v160 offset:49152
  ds_write_addtid_b32 v161 offset:49416
  ds_write_addtid_b32 v164 offset:49680
  ds_write_addtid_b32 v165 offset:49944
  ds_write_addtid_b32 v168 offset:50208
  ds_write_addtid_b32 v169 offset:50472
  ds_write_addtid_b32 v172 offset:50736
  ds_write_addtid_b32 v173 offset:51000
  ds_write_addtid_b32 v176 offset:51264
  ds_write_addtid_b32 v177 offset:51528
  ds_write_addtid_b32 v180 offset:51792
  ds_write_addtid_b32 v181 offset:52056
  buffer_store_dwordx4 v[136:139], v8, s[16:19], s65 offen sc0 sc1
  ds_write_addtid_b32 v184 offset:52320
  ds_write_addtid_b32 v185 offset:52584
  ds_write_addtid_b32 v188 offset:52848
  ds_write_addtid_b32 v189 offset:53112
  ds_read2_b32 v[160:161], v16 offset0:0 offset1:66
  ds_read2_b32 v[162:163], v16 offset0:16 offset1:82
  ds_read2_b32 v[164:165], v16 offset0:4 offset1:70
  ds_read2_b32 v[166:167], v16 offset0:20 offset1:86
  ds_read2_b32 v[168:169], v16 offset0:8 offset1:74
  ds_read2_b32 v[170:171], v16 offset0:24 offset1:90
  ds_read2_b32 v[172:173], v16 offset0:12 offset1:78
  ds_read2_b32 v[174:175], v16 offset0:28 offset1:94
  buffer_store_dwordx4 v[140:143], v8, s[16:19], s66 offen sc0 sc1
  s_bitcmp1_b32 s40, 14
  s_cbranch_scc1 LepiA_ret
LepiB:
  s_mov_b32 m0, s41
  v_pk_mul_f32 v[192:193], v[192:193], v[28:29] op_sel_hi:[1,0]
  v_pk_mul_f32 v[194:195], v[194:195], v[28:29] op_sel_hi:[1,0]
  v_pk_mul_f32 v[196:197], v[196:197], v[28:29] op_sel_hi:[1,0]
  v_pk_mul_f32 v[198:199], v[198:199], v[28:29] op_sel_hi:[1,0]
  v_pk_mul_f32 v[200:201], v[200:201], v[28:29] op_sel_hi:[1,0]
  v_pk_mul_f32 v[202:203], v[202:203], v[28:29] op_sel_hi:[1,0]
  v_pk_mul_f32 v[204:205], v[204:205], v[28:29] op_sel_hi:[1,0]
  v_pk_mul_f32 v[206:207], v[206:207], v[28:29] op_sel_hi:[1,0]
  v_pk_mul_f32 v[208:209], v[208:209], v[28:29] op_sel_hi:[1,0]
  v_pk_mul_f32 v[210:211], v[210:211], v[28:29] op_sel_hi:[1,0]
  v_pk_mul_f32 v[212:213], v[212:213], v[28:29] op_sel_hi:[1,0]
  v_pk_mul_f32 v[214:215], v[214:215], v[28:29] op_sel_hi:[1,0]
  v_pk_mul_f32 v[216:217], v[216:217], v[28:29] op_sel_hi:[1,0]
  v_pk_mul_f32 v[218:219], v[218:219], v[28:29] op_sel_hi:[1,0]
  v_pk_mul_f32 v[220:221], v[220:221], v[28:29] op_sel_hi:[1,0]
  v_pk_mul_f32 v[222:223], v[222:223], v[28:29] op_sel_hi:[1,0]
  v_mfma_f32_32x32x16_bf16 v[176:191], a[148:151], a[148:151], 0
  v_cvt_pk_bf16_f32 v192, v192, v193
  s_waitcnt lgkmcnt(0)
  buffer_store_dwordx4 v[160:163], v18, s[16:19], s36 offen sc0 sc1
  v_cvt_pk_bf16_f32 v193, v194, v195
  v_cvt_pk_bf16_f32 v196, v196, v197
  v_cvt_pk_bf16_f32 v197, v198, v199
  v_cvt_pk_bf16_f32 v200, v200, v201
  v_cvt_pk_bf16_f32 v201, v202, v203
  v_mfma_f32_32x32x16_bf16 v[128:143], a[148:151], a[148:151], 0
  v_cvt_pk_bf16_f32 v204, v204, v205
  v_cvt_pk_bf16_f32 v205, v206, v207
  v_cvt_pk_bf16_f32 v208, v208, v209
  v_cvt_pk_bf16_f32 v209, v210, v211
  v_cvt_pk_bf16_f32 v212, v212, v213
  v_cvt_pk_bf16_f32 v213, v214, v215
  v_cvt_pk_bf16_f32 v216, v216, v217
  v_cvt_pk_bf16_f32 v217, v218, v219
  v_cvt_pk_bf16_f32 v220, v220, v221
  v_cvt_pk_bf16_f32 v221, v222, v223
  buffer_store_dwordx4 v[164:167], v18, s[16:19], s64 offen sc0 sc1
  ds_write_addtid_b32 v192 offset:49152
  ds_write_addtid_b32 v193 offset:49416
  ds_write_addtid_b32 v196 offset:49680
  ds_write_addtid_b32 v197 offset:49944
  ds_write_addtid_b32 v200 offset:50208
  ds_write_addtid_b32 v201 offset:50472
  ds_write_addtid_b32 v204 offset:50736
  ds_write_addtid_b32 v205 offset:51000
  ds_write_addtid_b32 v208 offset:51264
  ds_write_addtid_b32 v209 offset:51528
  ds_write_addtid_b32 v212 offset:51792
  ds_write_addtid_b32 v213 offset:52056
  buffer_store_dwordx4 v[168:171], v18, s[16:19], s65 offen sc0 sc1
  ds_write_addtid_b32 v216 offset:52320
  ds_write_addtid_b32 v217 offset:52584
  ds_write_addtid_b32 v220 offset:52848
  ds_write_addtid_b32 v221 offset:53112
  ds_read2_b32 v[192:193], v16 offset0:0 offset1:66
  ds_read2_b32 v[194:195], v16 offset0:16 offset1:82
  ds_read2_b32 v[196:197], v16 offset0:4 offset1:70
  ds_read2_b32 v[198:199], v16 offset0:20 offset1:86
  ds_read2_b32 v[200:201], v16 offset0:8 offset1:74
  ds_read2_b32 v[202:203], v16 offset0:24 offset1:90
  ds_read2_b32 v[204:205], v16 offset0:12 offset1:78
  ds_read2_b32 v[206:207], v16 offset0:28 offset1:94
  buffer_store_dwordx4 v[172:175], v18, s[16:19], s66 offen sc0 sc1
  v_pk_mul_f32 v[224:225], v[224:225], v[30:31] op_sel_hi:[1,0]
  v_pk_mul_f32 v[226:227], v[226:227], v[30:31] op_sel_hi:[1,0]
  v_pk_mul_f32 v[228:229], v[228:229], v[30:31] op_sel_hi:[1,0]
  v_pk_mul_f32 v[230:231], v[230:231], v[30:31] op_sel_hi:[1,0]
  v_pk_mul_f32 v[232:233], v[232:233], v[30:31] op_sel_hi:[1,0]
  v_pk_mul_f32 v[234:235], v[234:235], v[30:31] op_sel_hi:[1,0]
  v_pk_mul_f32 v[236:237], v[236:237], v[30:31] op_sel_hi:[1,0]
  v_pk_mul_f32 v[238:239], v[238:239], v[30:31] op_sel_hi:[1,0]
  v_pk_mul_f32 v[240:241], v[240:241], v[30:31] op_sel_hi:[1,0]
  v_pk_mul_f32 v[242:243], v[242:243], v[30:31] op_sel_hi:[1,0]
  v_pk_mul_f32 v[244:245], v[244:245], v[30:31] op_sel_hi:[1,0]
  v_pk_mul_f32 v[246:247], v[246:247], v[30:31] op_sel_hi:[1,0]
  v_pk_mul_f32 v[248:249], v[248:249], v[30:31] op_sel_hi:[1,0]
  v_pk_mul_f32 v[250:251], v[250:251], v[30:31] op_sel_hi:[1,0]
  v_pk_mul_f32 v[252:253], v[252:253], v[30:31] op_sel_hi:[1,0]
  v_pk_mul_f32 v[254:255], v[254:255], v[30:31] op_sel_hi:[1,0]
  v_mfma_f32_32x32x16_bf16 v[208:223], a[148:151], a[148:151], 0
  v_cvt_pk_bf16_f32 v224, v224, v225
  s_waitcnt lgkmcnt(0)
  buffer_store_dwordx4 v[192:195], v8, s[16:19], s37 offen sc0 sc1
  v_cvt_pk_bf16_f32 v225, v226, v227
  v_cvt_pk_bf16_f32 v228, v228, v229
  v_cvt_pk_bf16_f32 v229, v230, v231
  v_cvt_pk_bf16_f32 v232, v232, v233
  v_cvt_pk_bf16_f32 v233, v234, v235
  v_mfma_f32_32x32x16_bf16 v[160:175], a[148:151], a[148:151], 0
  v_cvt_pk_bf16_f32 v236, v236, v237
  v_cvt_pk_bf16_f32 v237, v238, v239
  v_cvt_pk_bf16_f32 v240, v240, v241
  v_cvt_pk_bf16_f32 v241, v242, v243
  v_cvt_pk_bf16_f32 v244, v244, v245
  v_cvt_pk_bf16_f32 v245, v246, v247
  v_cvt_pk_bf16_f32 v248, v248, v249
  v_cvt_pk_bf16_f32 v249, v250, v251
  v_cvt_pk_bf16_f32 v252, v252, v253
  v_cvt_pk_bf16_f32 v253, v254, v255
  buffer_store_dwordx4 v[196:199], v8, s[16:19], s67 offen sc0 sc1
  ds_write_addtid_b32 v224 offset:49152
  ds_write_addtid_b32 v225 offset:49416
  ds_write_addtid_b32 v228 offset:49680
  ds_write_addtid_b32 v229 offset:49944
  ds_write_addtid_b32 v232 offset:50208
  ds_write_addtid_b32 v233 offset:50472
  ds_write_addtid_b32 v236 offset:50736
  ds_write_addtid_b32 v237 offset:51000
  ds_write_addtid_b32 v240 offset:51264
  ds_write_addtid_b32 v241 offset:51528
  ds_write_addtid_b32 v244 offset:51792
  ds_write_addtid_b32 v245 offset:52056
  buffer_store_dwordx4 v[200:203], v8, s[16:19], s68 offen sc0 sc1
  ds_write_addtid_b32 v248 offset:52320
  ds_write_addtid_b32 v249 offset:52584
  ds_write_addtid_b32 v252 offset:52848
  ds_write_addtid_b32 v253 offset:53112
  ds_read2_b32 v[224:225], v16 offset0:0 offset1:66
  ds_read2_b32 v[226:227], v16 offset0:16 offset1:82
  ds_read2_b32 v[228:229], v16 offset0:4 offset1:70
  ds_read2_b32 v[230:231], v16 offset0:20 offset1:86
  ds_read2_b32 v[232:233], v16 offset0:8 offset1:74
  ds_read2_b32 v[234:235], v16 offset0:24 offset1:90
  ds_read2_b32 v[236:237], v16 offset0:12 offset1:78
  ds_read2_b32 v[238:239], v16 offset0:28 offset1:94
  buffer_store_dwordx4 v[204:207], v8, s[16:19], s69 offen sc0 sc1
  s_bitcmp1_b32 s40, 4
  s_cbranch_scc0 Litem
  s_waitcnt lgkmcnt(0)
  buffer_store_dwordx4 v[224:227], v18, s[16:19], s37 offen sc0 sc1
  buffer_store_dwordx4 v[228:231], v18, s[16:19], s67 offen sc0 sc1
  buffer_store_dwordx4 v[232:235], v18, s[16:19], s68 offen sc0 sc1
  buffer_store_dwordx4 v[236:239], v18, s[16:19], s69 offen sc0 sc1
  s_cmp_lg_u32 s56, 0
  s_cbranch_scc1 Lend
  s_or_b32 s52, s52, s53
  v_mov_b32 v24, s52
  s_lshl_b32 s60, s55, 2
  s_add_u32 s60, s60, 150528
  v_mov_b32 v25, s60
  v_mov_b32 v26, 150528
  ds_write_b32 v25, v24
  s_waitcnt lgkmcnt(0)
  s_barrier
  ds_read_b128 v[28:31], v26
  s_waitcnt lgkmcnt(0)
  v_or_b32 v28, v28, v29
  v_or3_b32 v28, v28, v30, v31
  s_nop 1
  v_readfirstlane_b32 s60, v28
  s_nop 1
  s_cmp_eq_u32 s60, 0
  s_cbranch_scc1 Lend
  s_mov_b32 s56, 1
  s_waitcnt vmcnt(0)
  s_barrier
  s_branch Lcold
Lend:
Lend2:
  s_endpgm
  .p2align 12
Lpad11:
  s_branch Lpads_back
  .p2align 5
Litem:
  v_mfma_f32_32x32x16_bf16 v[240:255], a[148:151], a[148:151], 0
  ds_read_b128 a[64:67], v1 offset:0
  ds_read_b128 a[68:71], v1 offset:64
  ds_read_b128 a[72:75], v1 offset:128
  ds_read_b128 a[76:79], v1 offset:192
  ds_read_b128 a[80:83], v1 offset:256
  ds_read_b128 a[84:87], v1 offset:320
  v_smfmac_f32_16x16x32_bf16 v[144:147], a[154:155], v[72:75], v32
  ds_read_b128 a[88:91], v1 offset:384
  ds_read_b128 a[92:95], v1 offset:448
  v_smfmac_f32_16x16x32_bf16 v[148:151], a[156:157], v[72:75], v32
  s_add_u32 s62, s54, 6
  v_readlane_b32 s40, v21, s62
  v_smfmac_f32_16x16x32_bf16 v[152:155], a[154:155], v[76:79], v32
  s_waitcnt lgkmcnt(8)
  buffer_store_dwordx4 v[224:227], v18, s[16:19], s37 offen sc0 sc1
  v_smfmac_f32_16x16x32_bf16 v[156:159], a[156:157], v[76:79], v32
  s_nop 2
  v_smfmac_f32_16x16x32_bf16 v[176:179], a[154:155], v[88:91], v32
  s_add_u32 s62, s54, 3
  v_readlane_b32 s33, v21, s62
  v_cvt_pk_bf16_f32 v144, v144, v145
  v_smfmac_f32_16x16x32_bf16 v[180:183], a[156:157], v[88:91], v32
  v_cvt_pk_bf16_f32 v145, v146, v147
  v_cvt_pk_bf16_f32 v146, v148, v149
  v_smfmac_f32_16x16x32_bf16 v[184:187], a[154:155], v[92:95], v32
  buffer_store_dwordx4 v[228:231], v18, s[16:19], s67 offen sc0 sc1
  v_smfmac_f32_16x16x32_bf16 v[188:191], a[156:157], v[92:95], v32
  s_add_u32 s62, s54, 4
  v_readlane_b32 s34, v21, s62
  v_cvt_pk_bf16_f32 v147, v150, v151
  v_smfmac_f32_16x16x32_bf16 v[208:211], a[154:155], v[40:43], v32
  v_accvgpr_write_b32 a0, v144
  v_accvgpr_write_b32 a1, v145
  v_smfmac_f32_16x16x32_bf16 v[212:215], a[156:157], v[40:43], v32
  v_accvgpr_write_b32 a2, v146
  v_accvgpr_write_b32 a3, v147
  v_smfmac_f32_16x16x32_bf16 v[216:219], a[154:155], v[44:47], v32
  buffer_store_dwordx4 v[232:235], v18, s[16:19], s68 offen sc0 sc1
  s_add_u32 s62, s54, 5
  v_readlane_b32 s35, v21, s62
  v_smfmac_f32_16x16x32_bf16 v[220:223], a[156:157], v[44:47], v32
  v_cvt_pk_bf16_f32 v152, v152, v153
  v_cvt_pk_bf16_f32 v153, v154, v155
  v_smfmac_f32_16x16x32_bf16 v[240:243], a[154:155], v[48:51], v32
  v_cvt_pk_bf16_f32 v154, v156, v157
  v_cvt_pk_bf16_f32 v155, v158, v159
  v_smfmac_f32_16x16x32_bf16 v[244:247], a[156:157], v[48:51], v32
  s_add_u32 s62, s54, 7
  v_readlane_b32 s57, v21, s62
  v_accvgpr_write_b32 a4, v152
  v_smfmac_f32_16x16x32_bf16 v[248:251], a[154:155], v[52:55], v32
  s_waitcnt lgkmcnt(0)
  buffer_store_dwordx4 v[236:239], v18, s[16:19], s69 offen sc0 sc1
  v_smfmac_f32_16x16x32_bf16 v[252:255], a[156:157], v[52:55], v32
  s_mov_b32 m0, s71
  v_accvgpr_write_b32 a5, v153
  v_accvgpr_write_b32 a6, v154
  v_mfma_f32_16x16x32_bf16 v[64:67], a[64:67], a[0:3], 0
  s_add_u32 s54, s54, 8
  v_accvgpr_write_b32 a7, v155
  v_cvt_pk_bf16_f32 v176, v176, v177
  v_mfma_f32_16x16x32_bf16 v[68:71], a[80:83], a[0:3], 0
  s_mov_b32 s18, s14
  v_cvt_pk_bf16_f32 v177, v178, v179
  v_cvt_pk_bf16_f32 v178, v180, v181
  v_mfma_f32_16x16x32_bf16 v[64:67], a[68:71], a[4:7], v[64:67]
  s_mov_b64 s[36:37], s[38:39]
  buffer_load_dwordx4 v4, s[8:11], s25 offen offset:0  lds
  v_mfma_f32_16x16x32_bf16 v[68:71], a[84:87], a[4:7], v[68:71]
  v_cvt_pk_bf16_f32 v179, v182, v183
  v_accvgpr_write_b32 a8, v176
  v_accvgpr_write_b32 a9, v177
  v_accvgpr_write_b32 a10, v178
  v_accvgpr_write_b32 a11, v179
  v_cvt_pk_bf16_f32 v184, v184, v185
  v_cvt_pk_bf16_f32 v185, v186, v187
  v_mfma_f32_16x16x32_bf16 v[64:67], a[72:75], a[8:11], v[64:67]
  v_cvt_pk_bf16_f32 v186, v188, v189
  v_cvt_pk_bf16_f32 v187, v190, v191
  v_mfma_f32_16x16x32_bf16 v[68:71], a[88:91], a[8:11], v[68:71]
  v_accvgpr_write_b32 a12, v184
  v_accvgpr_write_b32 a13, v185
  v_accvgpr_write_b32 a14, v186
  v_accvgpr_write_b32 a15, v187
  v_cvt_pk_bf16_f32 v208, v208, v209
  v_cvt_pk_bf16_f32 v209, v210, v211
  v_mfma_f32_16x16x32_bf16 v[64:67], a[76:79], a[12:15], v[64:67]
  buffer_load_dwordx4 v5, s[8:11], s25 offen offset:1040  lds
  v_mfma_f32_16x16x32_bf16 v[68:71], a[92:95], a[12:15], v[68:71]
  v_readlane_b32 s38, v21, s54
  v_cvt_pk_bf16_f32 v210, v212, v213
  v_cvt_pk_bf16_f32 v211, v214, v215
  v_accvgpr_write_b32 a16, v208
  v_accvgpr_write_b32 a17, v209
  v_accvgpr_write_b32 a18, v210
  v_accvgpr_write_b32 a19, v211
  v_cvt_pk_bf16_f32 v216, v216, v217
  v_cvt_pk_bf16_f32 v217, v218, v219
  v_mfma_f32_16x16x32_bf16 v[72:75], a[64:67], a[16:19], 0
  v_cvt_pk_bf16_f32 v218, v220, v221
  v_cvt_pk_bf16_f32 v219, v222, v223
  v_mfma_f32_16x16x32_bf16 v[76:79], a[80:83], a[16:19], 0
  s_add_u32 s62, s54, 1
  v_readlane_b32 s39, v21, s62
  v_accvgpr_write_b32 a20, v216
  v_mfma_f32_32x32x16_bf16 v[144:159], a[148:151], a[148:151], 0
  v_accvgpr_write_b32 a21, v217
  v_accvgpr_write_b32 a22, v218
  v_accvgpr_write_b32 a23, v219
  v_cvt_pk_bf16_f32 v240, v240, v241
  v_cvt_pk_bf16_f32 v241, v242, v243
  v_mfma_f32_16x16x32_bf16 v[72:75], a[68:71], a[20:23], v[72:75]
  buffer_load_dwordx4 v6, s[8:11], s25 offen offset:2080  lds
  v_mfma_f32_16x16x32_bf16 v[76:79], a[84:87], a[20:23], v[76:79]
  s_add_u32 s62, s54, 2
  v_readlane_b32 s14, v21, s62
  v_cvt_pk_bf16_f32 v242, v244, v245
  v_cvt_pk_bf16_f32 v243, v246, v247
  v_accvgpr_write_b32 a24, v240
  v_accvgpr_write_b32 a25, v241
  v_accvgpr_write_b32 a26, v242
  v_accvgpr_write_b32 a27, v243
  v_cvt_pk_bf16_f32 v248, v248, v249
  v_cvt_pk_bf16_f32 v249, v250, v251
  v_mfma_f32_16x16x32_bf16 v[72:75], a[72:75], a[24:27], v[72:75]
  v_cvt_pk_bf16_f32 v250, v252, v253
  v_cvt_pk_bf16_f32 v251, v254, v255
  v_mfma_f32_16x16x32_bf16 v[76:79], a[88:91], a[24:27], v[76:79]
  v_accvgpr_write_b32 a28, v248
  v_accvgpr_write_b32 a29, v249
  v_accvgpr_write_b32 a30, v250
  v_accvgpr_write_b32 a31, v251
  s_nop 1
  v_mfma_f32_16x16x32_bf16 v[72:75], a[76:79], a[28:31], v[72:75]
  buffer_load_dwordx4 v7, s[8:11], s25 offen offset:3120  lds
  v_mfma_f32_16x16x32_bf16 v[76:79], a[92:95], a[28:31], v[76:79]
  s_cmp_eq_u32 s33, 0
  s_cbranch_scc1 LmP
LmP_back:
  s_nop 0
  v_max3_f32 v28, v64, v65, v66
  v_max3_f32 v28, v28, v67, v68
  v_max3_f32 v28, v28, v69, v70
  v_max_f32 v28, v28, v71
  v_max3_f32 v30, v72, v73, v74
  v_max3_f32 v30, v30, v75, v76
  v_max3_f32 v30, v30, v77, v78
  v_max_f32 v30, v30, v79
  s_cmp_lg_u32 s56, 0
  s_cbranch_scc1 LsafeA
LsafeA_back:
  v_permlane32_swap_b32 v28, v30
  v_max_f32 v28, v28, v30
  v_mov_b32 v30, v28
  s_nop 1
  v_permlane16_swap_b32 v28, v30
  v_max_f32 v28, v28, v30
  v_mov_b32 v30, v28
  s_nop 1
  v_permlane32_swap_b32 v28, v30
  v_pk_mul_f32 v[48:49], v[28:29], -1.0 op_sel_hi:[0,0]
  v_pk_mul_f32 v[50:51], v[28:29], -1.0 op_sel_hi:[0,0]
  v_pk_mul_f32 v[52:53], v[30:31], -1.0 op_sel_hi:[0,0]
  v_pk_mul_f32 v[54:55], v[30:31], -1.0 op_sel_hi:[0,0]
  v_pk_add_f32 v[64:65], v[64:65], v[48:49]
  v_pk_add_f32 v[66:67], v[66:67], v[48:49]
  v_pk_add_f32 v[68:69], v[68:69], v[48:49]
  v_pk_add_f32 v[70:71], v[70:71], v[48:49]
  v_pk_add_f32 v[72:73], v[72:73], v[52:53]
  v_pk_add_f32 v[74:75], v[74:75], v[52:53]
  v_pk_add_f32 v[76:77], v[76:77], v[52:53]
  v_pk_add_f32 v[78:79], v[78:79], v[52:53]
  s_bitcmp1_b32 s40, 10
  s_waitcnt vmcnt(20)
  ds_read_b128 v[96:99], v12 offset:0
  ds_read_b128 v[100:103], v13 offset:0
  ds_read_b128 v[104:107], v14 offset:0
  ds_read_b128 v[108:111], v15 offset:0
  ds_read_b128 v[112:115], v12 offset:4160
  ds_read_b128 v[116:119], v13 offset:4160
  ds_read_b128 v[120:123], v14 offset:4160
  ds_read_b128 v[124:127], v15 offset:4160
  s_cbranch_scc1 LpayK
  v_mfma_f32_32x32x16_bf16 v[192:207], a[148:151], a[148:151], 0
  v_exp_f32 v64, v64
  v_exp_f32 v65, v65
  v_exp_f32 v66, v66
  v_mfma_f32_32x32x16_bf16 v[224:239], a[148:151], a[148:151], 0
  v_exp_f32 v67, v67
  v_exp_f32 v68, v68
  v_exp_f32 v69, v69
  v_mfma_f32_32x32x16_bf16 v[176:191], a[148:151], a[148:151], 0
  v_exp_f32 v70, v70
  v_exp_f32 v71, v71
  v_exp_f32 v72, v72
  v_mfma_f32_32x32x16_bf16 v[208:223], a[148:151], a[148:151], 0
  v_exp_f32 v73, v73
  v_exp_f32 v74, v74
  v_exp_f32 v75, v75
  v_mfma_f32_32x32x16_bf16 v[240:255], a[148:151], a[148:151], 0
  v_exp_f32 v76, v76
  v_exp_f32 v77, v77
  v_exp_f32 v78, v78
  v_exp_f32 v79, v79
LpayK_back:
  v_mfma_f32_16x16x32_bf16 a[128:131], a[148:151], a[148:151], 0
  v_cvt_pk_bf16_f32 v64, v64, v65
  v_mfma_f32_16x16x32_bf16 a[132:135], a[148:151], a[148:151], 0
  v_cvt_pk_bf16_f32 v65, v66, v67
  s_waitcnt lgkmcnt(0)
  v_smfmac_f32_16x16x32_bf16 v[128:131], a[154:155], v[96:99], v32
  s_add_u32 m0, s76, 0
  s_add_u32 s62, s38, 0
  buffer_load_dwordx4 v23, s[12:15], s62 offen offset:0 nt lds
  v_smfmac_f32_16x16x32_bf16 v[132:135], a[156:157], v[96:99], v32
  v_cvt_pk_bf16_f32 v66, v68, v69
  v_cvt_pk_bf16_f32 v67, v70, v71
  v_smfmac_f32_16x16x32_bf16 v[136:139], a[154:155], v[100:103], v32
  v_cvt_pk_bf16_f32 v68, v72, v73
  v_cvt_pk_bf16_f32 v69, v74, v75
  v_smfmac_f32_16x16x32_bf16 v[140:143], a[156:157], v[100:103], v32
  v_cvt_pk_bf16_f32 v70, v76, v77
  v_cvt_pk_bf16_f32 v71, v78, v79
  v_smfmac_f32_16x16x32_bf16 v[160:163], a[154:155], v[104:107], v32
  s_add_u32 s62, s38, 15344
  buffer_load_dwordx4 v23, s[12:15], s62 offen offset:1040 nt lds
  v_smfmac_f32_16x16x32_bf16 v[164:167], a[156:157], v[104:107], v32
  v_cvt_pk_bf16_f32 v128, v128, v129
  v_cvt_pk_bf16_f32 v129, v130, v131
  v_smfmac_f32_16x16x32_bf16 v[168:171], a[154:155], v[108:111], v32
  v_cvt_pk_bf16_f32 v130, v132, v133
  v_cvt_pk_bf16_f32 v131, v134, v135
  v_smfmac_f32_16x16x32_bf16 v[172:175], a[156:157], v[108:111], v32
  v_accvgpr_write_b32 a32, v128
  v_accvgpr_write_b32 a33, v129
  v_smfmac_f32_16x16x32_bf16 v[192:195], a[154:155], v[112:115], v32
  s_add_u32 s62, s38, 47072
  buffer_load_dwordx4 v23, s[12:15], s62 offen offset:2080 nt lds
  v_smfmac_f32_16x16x32_bf16 v[196:199], a[156:157], v[112:115], v32
  v_accvgpr_write_b32 a34, v130
  v_accvgpr_write_b32 a35, v131
  v_smfmac_f32_16x16x32_bf16 v[200:203], a[154:155], v[116:119], v32
  v_cvt_pk_bf16_f32 v136, v136, v137
  v_cvt_pk_bf16_f32 v137, v138, v139
  v_smfmac_f32_16x16x32_bf16 v[204:207], a[156:157], v[116:119], v32
  v_cvt_pk_bf16_f32 v138, v140, v141
  v_cvt_pk_bf16_f32 v139, v142, v143
  v_smfmac_f32_16x16x32_bf16 v[224:227], a[154:155], v[120:123], v32
  s_add_u32 s62, s38, 29648
  buffer_load_dwordx4 v23, s[12:15], s62 offen offset:3120 nt lds
  v_smfmac_f32_16x16x32_bf16 v[228:231], a[156:157], v[120:123], v32
  v_accvgpr_write_b32 a36, v136
  v_accvgpr_write_b32 a37, v137
  v_smfmac_f32_16x16x32_bf16 v[232:235], a[154:155], v[124:127], v32
  v_accvgpr_write_b32 a38, v138
  v_accvgpr_write_b32 a39, v139
  v_smfmac_f32_16x16x32_bf16 v[236:239], a[156:157], v[124:127], v32
  v_cvt_pk_bf16_f32 v160, v160, v161
  v_cvt_pk_bf16_f32 v161, v162, v163
  v_mfma_f32_16x16x32_bf16 v[96:99], a[64:67], a[32:35], 0
  s_add_u32 m0, s76, 4160
  s_add_u32 s62, s38, 0
  buffer_load_dwordx4 v33, s[12:15], s62 offen offset:0 nt lds
  v_mfma_f32_16x16x32_bf16 v[100:103], a[80:83], a[32:35], 0
  v_cvt_pk_bf16_f32 v162, v164, v165
  v_cvt_pk_bf16_f32 v163, v166, v167
  v_mfma_f32_16x16x32_bf16 v[96:99], a[68:71], a[36:39], v[96:99]
  v_accvgpr_write_b32 a40, v160
  v_accvgpr_write_b32 a41, v161
  v_mfma_f32_16x16x32_bf16 v[100:103], a[84:87], a[36:39], v[100:103]
  v_accvgpr_write_b32 a42, v162
  v_accvgpr_write_b32 a43, v163
  v_cvt_pk_bf16_f32 v168, v168, v169
  v_cvt_pk_bf16_f32 v169, v170, v171
  v_mfma_f32_16x16x32_bf16 v[96:99], a[72:75], a[40:43], v[96:99]
  s_add_u32 s62, s38, 15344
  buffer_load_dwordx4 v33, s[12:15], s62 offen offset:1040 nt lds
  v_mfma_f32_16x16x32_bf16 v[100:103], a[88:91], a[40:43], v[100:103]
  v_cvt_pk_bf16_f32 v170, v172, v173
  v_cvt_pk_bf16_f32 v171, v174, v175
  v_accvgpr_write_b32 a44, v168
  v_accvgpr_write_b32 a45, v169
  v_accvgpr_write_b32 a46, v170
  v_accvgpr_write_b32 a47, v171
  v_cvt_pk_bf16_f32 v192, v192, v193
  v_cvt_pk_bf16_f32 v193, v194, v195
  v_mfma_f32_16x16x32_bf16 v[96:99], a[76:79], a[44:47], v[96:99]
  v_cvt_pk_bf16_f32 v194, v196, v197
  v_cvt_pk_bf16_f32 v195, v198, v199
  v_mfma_f32_16x16x32_bf16 v[100:103], a[92:95], a[44:47], v[100:103]
  v_accvgpr_write_b32 a48, v192
  v_accvgpr_write_b32 a49, v193
  v_accvgpr_write_b32 a50, v194
  v_accvgpr_write_b32 a51, v195
  v_cvt_pk_bf16_f32 v200, v200, v201
  v_cvt_pk_bf16_f32 v201, v202, v203
  v_mfma_f32_16x16x32_bf16 v[104:107], a[64:67], a[48:51], 0
  s_add_u32 s62, s38, 47072
  buffer_load_dwordx4 v33, s[12:15], s62 offen offset:2080 nt lds
  v_mfma_f32_16x16x32_bf16 v[108:111], a[80:83], a[48:51], 0
  v_cvt_pk_bf16_f32 v202, v204, v205
  v_cvt_pk_bf16_f32 v203, v206, v207
  v_mfma_f32_32x32x16_bf16 v[128:143], a[148:151], a[148:151], 0
  v_accvgpr_write_b32 a52, v200
  v_accvgpr_write_b32 a53, v201
  v_accvgpr_write_b32 a54, v202
  v_accvgpr_write_b32 a55, v203
  v_cvt_pk_bf16_f32 v224, v224, v225
  v_cvt_pk_bf16_f32 v225, v226, v227
  v_mfma_f32_16x16x32_bf16 v[104:107], a[68:71], a[52:55], v[104:107]
  v_cvt_pk_bf16_f32 v226, v228, v229
  v_cvt_pk_bf16_f32 v227, v230, v231
  v_mfma_f32_16x16x32_bf16 v[108:111], a[84:87], a[52:55], v[108:111]
  v_accvgpr_write_b32 a56, v224
  v_accvgpr_write_b32 a57, v225
  v_mfma_f32_32x32x16_bf16 v[160:175], a[148:151], a[148:151], 0
  v_accvgpr_write_b32 a58, v226
  v_accvgpr_write_b32 a59, v227
  v_cvt_pk_bf16_f32 v232, v232, v233
  v_cvt_pk_bf16_f32 v233, v234, v235
  v_mfma_f32_16x16x32_bf16 v[104:107], a[72:75], a[56:59], v[104:107]
  s_add_u32 s62, s38, 29648
  buffer_load_dwordx4 v33, s[12:15], s62 offen offset:3120 nt lds
  v_mfma_f32_16x16x32_bf16 v[108:111], a[88:91], a[56:59], v[108:111]
  v_cvt_pk_bf16_f32 v234, v236, v237
  v_cvt_pk_bf16_f32 v235, v238, v239
  v_mfma_f32_32x32x16_bf16 v[192:207], a[148:151], a[148:151], 0
  v_accvgpr_write_b32 a60, v232
  v_accvgpr_write_b32 a61, v233
  v_accvgpr_write_b32 a62, v234
  v_accvgpr_write_b32 a63, v235
  v_max3_f32 v28, v96, v97, v98
  v_max3_f32 v28, v28, v99, v100
  v_mfma_f32_16x16x32_bf16 v[104:107], a[76:79], a[60:63], v[104:107]
  v_max3_f32 v28, v28, v101, v102
  v_max_f32 v28, v28, v103
  v_mfma_f32_16x16x32_bf16 v[108:111], a[92:95], a[60:63], v[108:111]
  v_mfma_f32_32x32x16_bf16 v[224:239], a[148:151], a[148:151], 0
  ds_read_b128 a[64:67], v1 offset:512
  ds_read_b128 a[68:71], v1 offset:576
  ds_read_b128 a[72:75], v1 offset:640
  ds_read_b128 a[76:79], v1 offset:704
  ds_read_b128 a[80:83], v1 offset:768
  ds_read_b128 a[84:87], v1 offset:832
  ds_read_b128 a[88:91], v1 offset:896
  ds_read_b128 a[92:95], v1 offset:960
  v_max3_f32 v30, v104, v105, v106
  v_max3_f32 v30, v30, v107, v108
  v_max3_f32 v30, v30, v109, v110
  v_max_f32 v30, v30, v111
  s_cmp_lg_u32 s56, 0
  s_cbranch_scc1 LsafeB
LsafeB_back:
  v_permlane32_swap_b32 v28, v30
  v_max_f32 v28, v28, v30
  v_mov_b32 v30, v28
  s_nop 1
  v_permlane16_swap_b32 v28, v30
  v_max_f32 v28, v28, v30
  v_mov_b32 v30, v28
  s_nop 1
  v_permlane32_swap_b32 v28, v30
  v_pk_mul_f32 v[56:57], v[28:29], -1.0 op_sel_hi:[0,0]
  v_pk_mul_f32 v[58:59], v[28:29], -1.0 op_sel_hi:[0,0]
  v_pk_mul_f32 v[60:61], v[30:31], -1.0 op_sel_hi:[0,0]
  v_pk_mul_f32 v[62:63], v[30:31], -1.0 op_sel_hi:[0,0]
  v_pk_add_f32 v[96:97], v[96:97], v[56:57]
  v_pk_add_f32 v[98:99], v[98:99], v[56:57]
  v_pk_add_f32 v[100:101], v[100:101], v[56:57]
  v_pk_add_f32 v[102:103], v[102:103], v[56:57]
  v_pk_add_f32 v[104:105], v[104:105], v[60:61]
  v_pk_add_f32 v[106:107], v[106:107], v[60:61]
  v_pk_add_f32 v[108:109], v[108:109], v[60:61]
  v_pk_add_f32 v[110:111], v[110:111], v[60:61]
  s_waitcnt vmcnt(28) lgkmcnt(0)
  s_cmp_gt_u32 s33, 1
  s_cbranch_scc0 LSF0
  s_bitcmp1_b32 s55, 0
  s_cbranch_scc0 LF0w0
  s_branch LF0w1
Lpad12:
  s_branch Lpads_back
  .p2align 5
LpayK:
  s_mov_b32 m0, s70
  v_mfma_f32_32x32x16_bf16 v[192:207], a[148:151], a[148:151], 0
  buffer_load_dwordx4 v4, s[4:7], s24 offen offset:0  lds
  v_exp_f32 v64, v64
  v_exp_f32 v65, v65
  v_exp_f32 v66, v66
  v_mfma_f32_32x32x16_bf16 v[224:239], a[148:151], a[148:151], 0
  buffer_load_dwordx4 v5, s[4:7], s24 offen offset:1040  lds
  v_exp_f32 v67, v67
  v_exp_f32 v68, v68
  v_exp_f32 v69, v69
  v_mfma_f32_32x32x16_bf16 v[176:191], a[148:151], a[148:151], 0
  buffer_load_dwordx4 v6, s[4:7], s24 offen offset:2080  lds
  v_exp_f32 v70, v70
  v_exp_f32 v71, v71
  v_exp_f32 v72, v72
  v_mfma_f32_32x32x16_bf16 v[208:223], a[148:151], a[148:151], 0
  buffer_load_dwordx4 v7, s[4:7], s24 offen offset:3120  lds
  v_exp_f32 v73, v73
  v_exp_f32 v74, v74
  v_exp_f32 v75, v75
  v_mfma_f32_32x32x16_bf16 v[240:255], a[148:151], a[148:151], 0
  v_exp_f32 v76, v76
  v_exp_f32 v77, v77
  v_exp_f32 v78, v78
  v_exp_f32 v79, v79
  s_branch LpayK_back
LsafeAc:
  s_add_u32 s66, s33, 1
  v_and_b32 v35, 15, v0
  v_lshlrev_b32 v35, 11, v35
  v_bfe_u32 v29, v0, 4, 1
  v_lshl_add_u32 v35, v29, 5, v35
  v_bfe_u32 v29, v0, 5, 1
  v_lshl_add_u32 v35, v29, 4, v35
  s_lshr_b32 s22, s18, 1
  s_mov_b32 s64, 1
  s_add_u32 s65, s57, 65536
LsafeAc_loop:
  s_cmp_ge_u32 s64, s66
  s_cbranch_scc1 LsafeAc_back
  buffer_load_dwordx4 a[96:99], v35, s[20:23], s65 offen offset:0
  buffer_load_dwordx4 a[100:103], v35, s[20:23], s65 offen offset:64
  buffer_load_dwordx4 a[104:107], v35, s[20:23], s65 offen offset:128
  buffer_load_dwordx4 a[108:111], v35, s[20:23], s65 offen offset:192
  s_add_u32 s65, s65, 32768
  buffer_load_dwordx4 a[112:115], v35, s[20:23], s65 offen offset:0
  buffer_load_dwordx4 a[116:119], v35, s[20:23], s65 offen offset:64
  buffer_load_dwordx4 a[120:123], v35, s[20:23], s65 offen offset:128
  buffer_load_dwordx4 a[124:127], v35, s[20:23], s65 offen offset:192
  s_add_u32 s65, s65, 32768
  s_waitcnt vmcnt(0)
  v_mfma_f32_16x16x32_bf16 v[80:83], a[96:99], a[0:3], 0
  v_mfma_f32_16x16x32_bf16 v[80:83], a[100:103], a[4:7], v[80:83]
  v_mfma_f32_16x16x32_bf16 v[80:83], a[104:107], a[8:11], v[80:83]
  v_mfma_f32_16x16x32_bf16 v[80:83], a[108:111], a[12:15], v[80:83]
  v_mfma_f32_16x16x32_bf16 v[88:91], a[96:99], a[16:19], 0
  v_mfma_f32_16x16x32_bf16 v[88:91], a[100:103], a[20:23], v[88:91]
  v_mfma_f32_16x16x32_bf16 v[88:91], a[104:107], a[24:27], v[88:91]
  v_mfma_f32_16x16x32_bf16 v[88:91], a[108:111], a[28:31], v[88:91]
  v_mfma_f32_16x16x32_bf16 v[84:87], a[112:115], a[0:3], 0
  v_mfma_f32_16x16x32_bf16 v[84:87], a[116:119], a[4:7], v[84:87]
  v_mfma_f32_16x16x32_bf16 v[84:87], a[120:123], a[8:11], v[84:87]
  v_mfma_f32_16x16x32_bf16 v[84:87], a[124:127], a[12:15], v[84:87]
  v_mfma_f32_16x16x32_bf16 v[92:95], a[112:115], a[16:19], 0
  v_mfma_f32_16x16x32_bf16 v[92:95], a[116:119], a[20:23], v[92:95]
  v_mfma_f32_16x16x32_bf16 v[92:95], a[120:123], a[24:27], v[92:95]
  v_mfma_f32_16x16x32_bf16 v[92:95], a[124:127], a[28:31], v[92:95]
  s_nop 7
  s_add_u32 s64, s64, 1
  s_cmp_eq_u32 s64, s66
  s_cbranch_scc1 LmSAc
LmSAc_back:
  v_max3_f32 v28, v28, v80, v81
  v_max3_f32 v28, v28, v82, v83
  v_max3_f32 v28, v28, v84, v85
  v_max3_f32 v28, v28, v86, v87
  v_max3_f32 v30, v30, v88, v89
  v_max3_f32 v30, v30, v90, v91
  v_max3_f32 v30, v30, v92, v93
  v_max3_f32 v30, v30, v94, v95
  s_branch LsafeAc_loop
LmSAc:
  s_bitcmp1_b32 s40, 0
  s_cbranch_scc1 LmSAc_odd
  v_cndmask_b32 v80, v80, v3, s[42:43]
  v_cndmask_b32 v81, v81, v3, s[44:45]
  v_cndmask_b32 v82, v82, v3, s[46:47]
  v_cndmask_b32 v83, v83, v3, s[48:49]
  v_mov_b32 v84, v3
  v_mov_b32 v85, v3
  v_mov_b32 v86, v3
  v_mov_b32 v87, v3
  v_cndmask_b32 v88, v88, v3, s[42:43]
  v_cndmask_b32 v89, v89, v3, s[44:45]
  v_cndmask_b32 v90, v90, v3, s[46:47]
  v_cndmask_b32 v91, v91, v3, s[48:49]
  v_mov_b32 v92, v3
  v_mov_b32 v93, v3
  v_mov_b32 v94, v3
  v_mov_b32 v95, v3
  s_branch LmSAc_back
LmSAc_odd:
  v_cndmask_b32 v84, v84, v3, s[42:43]
  v_cndmask_b32 v85, v85, v3, s[44:45]
  v_cndmask_b32 v86, v86, v3, s[46:47]
  v_cndmask_b32 v87, v87, v3, s[48:49]
  v_cndmask_b32 v92, v92, v3, s[42:43]
  v_cndmask_b32 v93, v93, v3, s[44:45]
  v_cndmask_b32 v94, v94, v3, s[46:47]
  v_cndmask_b32 v95, v95, v3, s[48:49]
  s_branch LmSAc_back
LsafeBc:
  s_add_u32 s66, s33, 1
  v_and_b32 v35, 15, v0
  v_lshlrev_b32 v35, 11, v35
  v_bfe_u32 v29, v0, 4, 1
  v_lshl_add_u32 v35, v29, 5, v35
  v_bfe_u32 v29, v0, 5, 1
  v_lshl_add_u32 v35, v29, 4, v35
  s_add_u32 s66, s66, s34
  s_add_u32 s66, s66, 1
  s_lshr_b32 s22, s18, 1
  s_mov_b32 s64, 1
  s_add_u32 s65, s57, 65536
LsafeBc_loop:
  s_cmp_ge_u32 s64, s66
  s_cbranch_scc1 LsafeBc_back
  buffer_load_dwordx4 a[96:99], v35, s[20:23], s65 offen offset:0
  buffer_load_dwordx4 a[100:103], v35, s[20:23], s65 offen offset:64
  buffer_load_dwordx4 a[104:107], v35, s[20:23], s65 offen offset:128
  buffer_load_dwordx4 a[108:111], v35, s[20:23], s65 offen offset:192
  s_add_u32 s65, s65, 32768
  buffer_load_dwordx4 a[112:115], v35, s[20:23], s65 offen offset:0
  buffer_load_dwordx4 a[116:119], v35, s[20:23], s65 offen offset:64
  buffer_load_dwordx4 a[120:123], v35, s[20:23], s65 offen offset:128
  buffer_load_dwordx4 a[124:127], v35, s[20:23], s65 offen offset:192
  s_add_u32 s65, s65, 32768
  s_waitcnt vmcnt(0)
  v_mfma_f32_16x16x32_bf16 v[112:115], a[96:99], a[32:35], 0
  v_mfma_f32_16x16x32_bf16 v[112:115], a[100:103], a[36:39], v[112:115]
  v_mfma_f32_16x16x32_bf16 v[112:115], a[104:107], a[40:43], v[112:115]
  v_mfma_f32_16x16x32_bf16 v[112:115], a[108:111], a[44:47], v[112:115]
  v_mfma_f32_16x16x32_bf16 v[120:123], a[96:99], a[48:51], 0
  v_mfma_f32_16x16x32_bf16 v[120:123], a[100:103], a[52:55], v[120:123]
  v_mfma_f32_16x16x32_bf16 v[120:123], a[104:107], a[56:59], v[120:123]
  v_mfma_f32_16x16x32_bf16 v[120:123], a[108:111], a[60:63], v[120:123]
  v_mfma_f32_16x16x32_bf16 v[116:119], a[112:115], a[32:35], 0
  v_mfma_f32_16x16x32_bf16 v[116:119], a[116:119], a[36:39], v[116:119]
  v_mfma_f32_16x16x32_bf16 v[116:119], a[120:123], a[40:43], v[116:119]
  v_mfma_f32_16x16x32_bf16 v[116:119], a[124:127], a[44:47], v[116:119]
  v_mfma_f32_16x16x32_bf16 v[124:127], a[112:115], a[48:51], 0
  v_mfma_f32_16x16x32_bf16 v[124:127], a[116:119], a[52:55], v[124:127]
  v_mfma_f32_16x16x32_bf16 v[124:127], a[120:123], a[56:59], v[124:127]
  v_mfma_f32_16x16x32_bf16 v[124:127], a[124:127], a[60:63], v[124:127]
  s_nop 7
  s_add_u32 s64, s64, 1
  s_cmp_eq_u32 s64, s66
  s_cbranch_scc1 LmSBc
LmSBc_back:
  v_max3_f32 v28, v28, v112, v113
  v_max3_f32 v28, v28, v114, v115
  v_max3_f32 v28, v28, v116, v117
  v_max3_f32 v28, v28, v118, v119
  v_max3_f32 v30, v30, v120, v121
  v_max3_f32 v30, v30, v122, v123
  v_max3_f32 v30, v30, v124, v125
  v_max3_f32 v30, v30, v126, v127
  s_branch LsafeBc_loop
LmSBc:
  s_bitcmp1_b32 s40, 1
  s_cbranch_scc1 LmSBc_odd
  v_cndmask_b32 v112, v112, v3, s[42:43]
  v_cndmask_b32 v113, v113, v3, s[44:45]
  v_cndmask_b32 v114, v114, v3, s[46:47]
  v_cndmask_b32 v115, v115, v3, s[48:49]
  v_mov_b32 v116, v3
  v_mov_b32 v117, v3
  v_mov_b32 v118, v3
  v_mov_b32 v119, v3
  v_cndmask_b32 v120, v120, v3, s[42:43]
  v_cndmask_b32 v121, v121, v3, s[44:45]
  v_cndmask_b32 v122, v122, v3, s[46:47]
  v_cndmask_b32 v123, v123, v3, s[48:49]
  v_mov_b32 v124, v3
  v_mov_b32 v125, v3
  v_mov_b32 v126, v3
  v_mov_b32 v127, v3
  s_branch LmSBc_back
LmSBc_odd:
  v_cndmask_b32 v116, v116, v3, s[42:43]
  v_cndmask_b32 v117, v117, v3, s[44:45]
  v_cndmask_b32 v118, v118, v3, s[46:47]
  v_cndmask_b32 v119, v119, v3, s[48:49]
  v_cndmask_b32 v124, v124, v3, s[42:43]
  v_cndmask_b32 v125, v125, v3, s[44:45]
  v_cndmask_b32 v126, v126, v3, s[46:47]
  v_cndmask_b32 v127, v127, v3, s[48:49]
  s_branch LmSBc_back
LsafeA:
  s_add_u32 s66, s33, 1
  v_and_b32 v35, 15, v0
  v_lshlrev_b32 v35, 11, v35
  v_bfe_u32 v29, v0, 4, 1
  v_lshl_add_u32 v35, v29, 5, v35
  v_bfe_u32 v29, v0, 5, 1
  v_lshl_add_u32 v35, v29, 4, v35
  s_lshr_b32 s22, s18, 1
  s_mov_b32 s64, 1
  s_add_u32 s65, s57, 65536
LsafeA_loop:
  s_cmp_ge_u32 s64, s66
  s_cbranch_scc1 LsafeA_back
  buffer_load_dwordx4 a[96:99], v35, s[20:23], s65 offen offset:0
  buffer_load_dwordx4 a[100:103], v35, s[20:23], s65 offen offset:64
  buffer_load_dwordx4 a[104:107], v35, s[20:23], s65 offen offset:128
  buffer_load_dwordx4 a[108:111], v35, s[20:23], s65 offen offset:192
  s_add_u32 s65, s65, 32768
  buffer_load_dwordx4 a[112:115], v35, s[20:23], s65 offen offset:0
  buffer_load_dwordx4 a[116:119], v35, s[20:23], s65 offen offset:64
  buffer_load_dwordx4 a[120:123], v35, s[20:23], s65 offen offset:128
  buffer_load_dwordx4 a[124:127], v35, s[20:23], s65 offen offset:192
  s_add_u32 s65, s65, 32768
  s_waitcnt vmcnt(0)
  v_mfma_f32_16x16x32_bf16 v[80:83], a[96:99], a[0:3], 0
  v_mfma_f32_16x16x32_bf16 v[80:83], a[100:103], a[4:7], v[80:83]
  v_mfma_f32_16x16x32_bf16 v[80:83], a[104:107], a[8:11], v[80:83]
  v_mfma_f32_16x16x32_bf16 v[80:83], a[108:111], a[12:15], v[80:83]
  v_mfma_f32_16x16x32_bf16 v[88:91], a[96:99], a[16:19], 0
  v_mfma_f32_16x16x32_bf16 v[88:91], a[100:103], a[20:23], v[88:91]
  v_mfma_f32_16x16x32_bf16 v[88:91], a[104:107], a[24:27], v[88:91]
  v_mfma_f32_16x16x32_bf16 v[88:91], a[108:111], a[28:31], v[88:91]
  v_mfma_f32_16x16x32_bf16 v[84:87], a[112:115], a[0:3], 0
  v_mfma_f32_16x16x32_bf16 v[84:87], a[116:119], a[4:7], v[84:87]
  v_mfma_f32_16x16x32_bf16 v[84:87], a[120:123], a[8:11], v[84:87]
  v_mfma_f32_16x16x32_bf16 v[84:87], a[124:127], a[12:15], v[84:87]
  v_mfma_f32_16x16x32_bf16 v[92:95], a[112:115], a[16:19], 0
  v_mfma_f32_16x16x32_bf16 v[92:95], a[116:119], a[20:23], v[92:95]
  v_mfma_f32_16x16x32_bf16 v[92:95], a[120:123], a[24:27], v[92:95]
  v_mfma_f32_16x16x32_bf16 v[92:95], a[124:127], a[28:31], v[92:95]
  s_nop 7
  s_add_u32 s64, s64, 1
  s_cmp_eq_u32 s64, s66
  s_cbranch_scc1 LmSA
LmSA_back:
  v_max3_f32 v28, v28, v80, v81
  v_max3_f32 v28, v28, v82, v83
  v_max3_f32 v28, v28, v84, v85
  v_max3_f32 v28, v28, v86, v87
  v_max3_f32 v30, v30, v88, v89
  v_max3_f32 v30, v30, v90, v91
  v_max3_f32 v30, v30, v92, v93
  v_max3_f32 v30, v30, v94, v95
  s_branch LsafeA_loop
LmSA:
  s_bitcmp1_b32 s40, 0
  s_cbranch_scc1 LmSA_odd
  v_cndmask_b32 v80, v80, v3, s[42:43]
  v_cndmask_b32 v81, v81, v3, s[44:45]
  v_cndmask_b32 v82, v82, v3, s[46:47]
  v_cndmask_b32 v83, v83, v3, s[48:49]
  v_mov_b32 v84, v3
  v_mov_b32 v85, v3
  v_mov_b32 v86, v3
  v_mov_b32 v87, v3
  v_cndmask_b32 v88, v88, v3, s[42:43]
  v_cndmask_b32 v89, v89, v3, s[44:45]
  v_cndmask_b32 v90, v90, v3, s[46:47]
  v_cndmask_b32 v91, v91, v3, s[48:49]
  v_mov_b32 v92, v3
  v_mov_b32 v93, v3
  v_mov_b32 v94, v3
  v_mov_b32 v95, v3
  s_branch LmSA_back
LmSA_odd:
  v_cndmask_b32 v84, v84, v3, s[42:43]
  v_cndmask_b32 v85, v85, v3, s[44:45]
  v_cndmask_b32 v86, v86, v3, s[46:47]
  v_cndmask_b32 v87, v87, v3, s[48:49]
  v_cndmask_b32 v92, v92, v3, s[42:43]
  v_cndmask_b32 v93, v93, v3, s[44:45]
  v_cndmask_b32 v94, v94, v3, s[46:47]
  v_cndmask_b32 v95, v95, v3, s[48:49]
  s_branch LmSA_back
LsafeB:
  s_add_u32 s66, s33, 1
  v_and_b32 v35, 15, v0
  v_lshlrev_b32 v35, 11, v35
  v_bfe_u32 v29, v0, 4, 1
  v_lshl_add_u32 v35, v29, 5, v35
  v_bfe_u32 v29, v0, 5, 1
  v_lshl_add_u32 v35, v29, 4, v35
  s_add_u32 s66, s66, s34
  s_add_u32 s66, s66, 1
  s_lshr_b32 s22, s18, 1
  s_mov_b32 s64, 1
  s_add_u32 s65, s57, 65536
LsafeB_loop:
  s_cmp_ge_u32 s64, s66
  s_cbranch_scc1 LsafeB_back
  buffer_load_dwordx4 a[96:99], v35, s[20:23], s65 offen offset:0
  buffer_load_dwordx4 a[100:103], v35, s[20:23], s65 offen offset:64
  buffer_load_dwordx4 a[104:107], v35, s[20:23], s65 offen offset:128
  buffer_load_dwordx4 a[108:111], v35, s[20:23], s65 offen offset:192
  s_add_u32 s65, s65, 32768
  buffer_load_dwordx4 a[112:115], v35, s[20:23], s65 offen offset:0
  buffer_load_dwordx4 a[116:119], v35, s[20:23], s65 offen offset:64
  buffer_load_dwordx4 a[120:123], v35, s[20:23], s65 offen offset:128
  buffer_load_dwordx4 a[124:127], v35, s[20:23], s65 offen offset:192
  s_add_u32 s65, s65, 32768
  s_waitcnt vmcnt(0)
  v_mfma_f32_16x16x32_bf16 v[112:115], a[96:99], a[32:35], 0
  v_mfma_f32_16x16x32_bf16 v[112:115], a[100:103], a[36:39], v[112:115]
  v_mfma_f32_16x16x32_bf16 v[112:115], a[104:107], a[40:43], v[112:115]
  v_mfma_f32_16x16x32_bf16 v[112:115], a[108:111], a[44:47], v[112:115]
  v_mfma_f32_16x16x32_bf16 v[120:123], a[96:99], a[48:51], 0
  v_mfma_f32_16x16x32_bf16 v[120:123], a[100:103], a[52:55], v[120:123]
  v_mfma_f32_16x16x32_bf16 v[120:123], a[104:107], a[56:59], v[120:123]
  v_mfma_f32_16x16x32_bf16 v[120:123], a[108:111], a[60:63], v[120:123]
  v_mfma_f32_16x16x32_bf16 v[116:119], a[112:115], a[32:35], 0
  v_mfma_f32_16x16x32_bf16 v[116:119], a[116:119], a[36:39], v[116:119]
  v_mfma_f32_16x16x32_bf16 v[116:119], a[120:123], a[40:43], v[116:119]
  v_mfma_f32_16x16x32_bf16 v[116:119], a[124:127], a[44:47], v[116:119]
  v_mfma_f32_16x16x32_bf16 v[124:127], a[112:115], a[48:51], 0
  v_mfma_f32_16x16x32_bf16 v[124:127], a[116:119], a[52:55], v[124:127]
  v_mfma_f32_16x16x32_bf16 v[124:127], a[120:123], a[56:59], v[124:127]
  v_mfma_f32_16x16x32_bf16 v[124:127], a[124:127], a[60:63], v[124:127]
  s_nop 7
  s_add_u32 s64, s64, 1
  s_cmp_eq_u32 s64, s66
  s_cbranch_scc1 LmSB
LmSB_back:
  v_max3_f32 v28, v28, v112, v113
  v_max3_f32 v28, v28, v114, v115
  v_max3_f32 v28, v28, v116, v117
  v_max3_f32 v28, v28, v118, v119
  v_max3_f32 v30, v30, v120, v121
  v_max3_f32 v30, v30, v122, v123
  v_max3_f32 v30, v30, v124, v125
  v_max3_f32 v30, v30, v126, v127
  s_branch LsafeB_loop
LmSB:
  s_bitcmp1_b32 s40, 1
  s_cbranch_scc1 LmSB_odd
  v_cndmask_b32 v112, v112, v3, s[42:43]
  v_cndmask_b32 v113, v113, v3, s[44:45]
  v_cndmask_b32 v114, v114, v3, s[46:47]
  v_cndmask_b32 v115, v115, v3, s[48:49]
  v_mov_b32 v116, v3
  v_mov_b32 v117, v3
  v_mov_b32 v118, v3
  v_mov_b32 v119, v3
  v_cndmask_b32 v120, v120, v3, s[42:43]
  v_cndmask_b32 v121, v121, v3, s[44:45]
  v_cndmask_b32 v122, v122, v3, s[46:47]
  v_cndmask_b32 v123, v123, v3, s[48:49]
  v_mov_b32 v124, v3
  v_mov_b32 v125, v3
  v_mov_b32 v126, v3
  v_mov_b32 v127, v3
  s_branch LmSB_back
LmSB_odd:
  v_cndmask_b32 v116, v116, v3, s[42:43]
  v_cndmask_b32 v117, v117, v3, s[44:45]
  v_cndmask_b32 v118, v118, v3, s[46:47]
  v_cndmask_b32 v119, v119, v3, s[48:49]
  v_cndmask_b32 v124, v124, v3, s[42:43]
  v_cndmask_b32 v125, v125, v3, s[44:45]
  v_cndmask_b32 v126, v126, v3, s[46:47]
  v_cndmask_b32 v127, v127, v3, s[48:49]
  s_branch LmSB_back
.p2align 8
.type Ltab,@object
Ltab:
.long 117248,117312,117376,117440,117568,117504,117696,117632,117888,117952,117760,117824,118208,118144,118080,118016
.long 118288,118352,118416,118480,118608,118544,118736,118672,118928,118992,118800,118864,119248,119184,119120,119056
.long 120368,120432,120496,120560,120688,120624,120816,120752,121008,121072,120880,120944,121328,121264,121200,121136
.long 119328,119392,119456,119520,119648,119584,119776,119712,119968,120032,119840,119904,120288,120224,120160,120096
.long 117280,117344,117408,117472,117600,117536,117728,117664,117920,117984,117792,117856,118240,118176,118112,118048
.long 118320,118384,118448,118512,118640,118576,118768,118704,118960,119024,118832,118896,119280,119216,119152,119088
.long 120400,120464,120528,120592,120720,120656,120848,120784,121040,121104,120912,120976,121360,121296,121232,121168
.long 119360,119424,119488,119552,119680,119616,119808,119744,120000,120064,119872,119936,120320,120256,120192,120128
.long 117264,117328,117392,117456,117584,117520,117712,117648,117904,117968,117776,117840,118224,118160,118096,118032
.long 118304,118368,118432,118496,118624,118560,118752,118688,118944,119008,118816,118880,119264,119200,119136,119072
.long 120384,120448,120512,120576,120704,120640,120832,120768,121024,121088,120896,120960,121344,121280,121216,121152
.long 119344,119408,119472,119536,119664,119600,119792,119728,119984,120048,119856,119920,120304,120240,120176,120112
.long 117296,117360,117424,117488,117616,117552,117744,117680,117936,118000,117808,117872,118256,118192,118128,118064
.long 118336,118400,118464,118528,118656,118592,118784,118720,118976,119040,118848,118912,119296,119232,119168,119104
.long 120416,120480,120544,120608,120736,120672,120864,120800,121056,121120,120928,120992,121376,121312,121248,121184
.long 119376,119440,119504,119568,119696,119632,119824,119760,120016,120080,119888,119952,120336,120272,120208,120144
.long 125568,125632,125696,125760,125888,125824,126016,125952,126208,126272,126080,126144,126528,126464,126400,126336
.long 126608,126672,126736,126800,126928,126864,127056,126992,127248,127312,127120,127184,127568,127504,127440,127376
.long 128688,128752,128816,128880,129008,128944,129136,129072,129328,129392,129200,129264,129648,129584,129520,129456
.long 127648,127712,127776,127840,127968,127904,128096,128032,128288,128352,128160,128224,128608,128544,128480,128416
.long 125600,125664,125728,125792,125920,125856,126048,125984,126240,126304,126112,126176,126560,126496,126432,126368
.long 126640,126704,126768,126832,126960,126896,127088,127024,127280,127344,127152,127216,127600,127536,127472,127408
.long 128720,128784,128848,128912,129040,128976,129168,129104,129360,129424,129232,129296,129680,129616,129552,129488
.long 127680,127744,127808,127872,128000,127936,128128,128064,128320,128384,128192,128256,128640,128576,128512,128448
.long 125584,125648,125712,125776,125904,125840,126032,125968,126224,126288,126096,126160,126544,126480,126416,126352
.long 126624,126688,126752,126816,126944,126880,127072,127008,127264,127328,127136,127200,127584,127520,127456,127392
.long 128704,128768,128832,128896,129024,128960,129152,129088,129344,129408,129216,129280,129664,129600,129536,129472
.long 127664,127728,127792,127856,127984,127920,128112,128048,128304,128368,128176,128240,128624,128560,128496,128432
.long 125616,125680,125744,125808,125936,125872,126064,126000,126256,126320,126128,126192,126576,126512,126448,126384
.long 126656,126720,126784,126848,126976,126912,127104,127040,127296,127360,127168,127232,127616,127552,127488,127424
.long 128736,128800,128864,128928,129056,128992,129184,129120,129376,129440,129248,129312,129696,129632,129568,129504
.long 127696,127760,127824,127888,128016,127952,128144,128080,128336,128400,128208,128272,128656,128592,128528,128464
.long 133888,133952,134016,134080,134208,134144,134336,134272,134528,134592,134400,134464,134848,134784,134720,134656
.long 134928,134992,135056,135120,135248,135184,135376,135312,135568,135632,135440,135504,135888,135824,135760,135696
.long 137008,137072,137136,137200,137328,137264,137456,137392,137648,137712,137520,137584,137968,137904,137840,137776
.long 135968,136032,136096,136160,136288,136224,136416,136352,136608,136672,136480,136544,136928,136864,136800,136736
.long 133920,133984,134048,134112,134240,134176,134368,134304,134560,134624,134432,134496,134880,134816,134752,134688
.long 134960,135024,135088,135152,135280,135216,135408,135344,135600,135664,135472,135536,135920,135856,135792,135728
.long 137040,137104,137168,137232,137360,137296,137488,137424,137680,137744,137552,137616,138000,137936,137872,137808
.long 136000,136064,136128,136192,136320,136256,136448,136384,136640,136704,136512,136576,136960,136896,136832,136768
.long 133904,133968,134032,134096,134224,134160,134352,134288,134544,134608,134416,134480,134864,134800,134736,134672
.long 134944,135008,135072,135136,135264,135200,135392,135328,135584,135648,135456,135520,135904,135840,135776,135712
.long 137024,137088,137152,137216,137344,137280,137472,137408,137664,137728,137536,137600,137984,137920,137856,137792
.long 135984,136048,136112,136176,136304,136240,136432,136368,136624,136688,136496,136560,136944,136880,136816,136752
.long 133936,134000,134064,134128,134256,134192,134384,134320,134576,134640,134448,134512,134896,134832,134768,134704
.long 134976,135040,135104,135168,135296,135232,135424,135360,135616,135680,135488,135552,135936,135872,135808,135744
.long 137056,137120,137184,137248,137376,137312,137504,137440,137696,137760,137568,137632,138016,137952,137888,137824
.long 136016,136080,136144,136208,136336,136272,136464,136400,136656,136720,136528,136592,136976,136912,136848,136784
.long 142208,142272,142336,142400,142528,142464,142656,142592,142848,142912,142720,142784,143168,143104,143040,142976
.long 143248,143312,143376,143440,143568,143504,143696,143632,143888,143952,143760,143824,144208,144144,144080,144016
.long 145328,145392,145456,145520,145648,145584,145776,145712,145968,146032,145840,145904,146288,146224,146160,146096
.long 144288,144352,144416,144480,144608,144544,144736,144672,144928,144992,144800,144864,145248,145184,145120,145056
.long 142240,142304,142368,142432,142560,142496,142688,142624,142880,142944,142752,142816,143200,143136,143072,143008
.long 143280,143344,143408,143472,143600,143536,143728,143664,143920,143984,143792,143856,144240,144176,144112,144048
.long 145360,145424,145488,145552,145680,145616,145808,145744,146000,146064,145872,145936,146320,146256,146192,146128
.long 144320,144384,144448,144512,144640,144576,144768,144704,144960,145024,144832,144896,145280,145216,145152,145088
.long 142224,142288,142352,142416,142544,142480,142672,142608,142864,142928,142736,142800,143184,143120,143056,142992
.long 143264,143328,143392,143456,143584,143520,143712,143648,143904,143968,143776,143840,144224,144160,144096,144032
.long 145344,145408,145472,145536,145664,145600,145792,145728,145984,146048,145856,145920,146304,146240,146176,146112
.long 144304,144368,144432,144496,144624,144560,144752,144688,144944,145008,144816,144880,145264,145200,145136,145072
.long 142256,142320,142384,142448,142576,142512,142704,142640,142896,142960,142768,142832,143216,143152,143088,143024
.long 143296,143360,143424,143488,143616,143552,143744,143680,143936,144000,143808,143872,144256,144192,144128,144064
.long 145376,145440,145504,145568,145696,145632,145824,145760,146016,146080,145888,145952,146336,146272,146208,146144
.long 144336,144400,144464,144528,144656,144592,144784,144720,144976,145040,144848,144912,145296,145232,145168,145104
.long 99840,0,256,1065369472,100368,128,272,1065369472,100896,0,288,0,101424,128,304,0
.long 101952,4096,320,1065369472,102480,4224,336,1065369472,103008,4096,352,0,103536,4224,368,0
.long 99844,8192,4096,1065369472,100372,8320,4112,1065369472,100900,8192,4128,0,101428,8320,4144,0
.long 101956,12288,4160,1065369472,102484,12416,4176,1065369472,103012,12288,4192,0,103540,12416,4208,0
.long 99848,16384,8448,1065369472,100376,16512,8464,1065369472,100904,16384,8480,0,101432,16512,8496,0
.long 101960,20480,8512,1065369472,102488,20608,8528,1065369472,103016,20480,8544,0,103544,20608,8560,0
.long 99852,24576,12288,1065369472,100380,24704,12304,1065369472,100908,24576,12320,0,101436,24704,12336,0
.long 101964,28672,12352,1065369472,102492,28800,12368,1065369472,103020,28672,12384,0,103548,28800,12400,0
.long 99968,32768,384,0,100496,32896,400,0,101024,32768,416,1065369472,101552,32896,432,1065369472
.long 102080,36864,448,0,102608,36992,464,0,103136,36864,480,1065369472,103664,36992,496,1065369472
.long 99972,40960,4224,0,100500,41088,4240,0,101028,40960,4256,1065369472,101556,41088,4272,1065369472
.long 102084,45056,4288,0,102612,45184,4304,0,103140,45056,4320,1065369472,103668,45184,4336,1065369472
.long 99976,49152,8576,0,100504,49280,8592,0,101032,49152,8608,1065369472,101560,49280,8624,1065369472
.long 102088,53248,8640,0,102616,53376,8656,0,103144,53248,8672,1065369472,103672,53376,8688,1065369472
.long 99980,57344,12416,0,100508,57472,12432,0,101036,57344,12448,1065369472,101564,57472,12464,1065369472
.long 102092,61440,12480,0,102620,61568,12496,0,103148,61440,12512,1065369472,103676,61568,12528,1065369472
.long 104192,0,256,1065369472,104720,128,272,1065369472,105248,0,288,0,105776,128,304,0
.long 106304,4096,320,1065369472,106832,4224,336,1065369472,107360,4096,352,0,107888,4224,368,0
.long 104196,8192,4096,1065369472,104724,8320,4112,1065369472,105252,8192,4128,0,105780,8320,4144,0
.long 106308,12288,4160,1065369472,106836,12416,4176,1065369472,107364,12288,4192,0,107892,12416,4208,0
.long 104200,16384,8448,1065369472,104728,16512,8464,1065369472,105256,16384,8480,0,105784,16512,8496,0
.long 106312,20480,8512,1065369472,106840,20608,8528,1065369472,107368,20480,8544,0,107896,20608,8560,0
.long 104204,24576,12288,1065369472,104732,24704,12304,1065369472,105260,24576,12320,0,105788,24704,12336,0
.long 106316,28672,12352,1065369472,106844,28800,12368,1065369472,107372,28672,12384,0,107900,28800,12400,0
.long 104320,32768,384,0,104848,32896,400,0,105376,32768,416,1065369472,105904,32896,432,1065369472
.long 106432,36864,448,0,106960,36992,464,0,107488,36864,480,1065369472,108016,36992,496,1065369472
.long 104324,40960,4224,0,104852,41088,4240,0,105380,40960,4256,1065369472,105908,41088,4272,1065369472
.long 106436,45056,4288,0,106964,45184,4304,0,107492,45056,4320,1065369472,108020,45184,4336,1065369472
.long 104328,49152,8576,0,104856,49280,8592,0,105384,49152,8608,1065369472,105912,49280,8624,1065369472
.long 106440,53248,8640,0,106968,53376,8656,0,107496,53248,8672,1065369472,108024,53376,8688,1065369472
.long 104332,57344,12416,0,104860,57472,12432,0,105388,57344,12448,1065369472,105916,57472,12464,1065369472
.long 106444,61440,12480,0,106972,61568,12496,0,107500,61440,12512,1065369472,108028,61568,12528,1065369472
.long 108544,0,256,1065369472,109072,128,272,1065369472,109600,0,288,0,110128,128,304,0
.long 110656,4096,320,1065369472,111184,4224,336,1065369472,111712,4096,352,0,112240,4224,368,0
.long 108548,8192,4096,1065369472,109076,8320,4112,1065369472,109604,8192,4128,0,110132,8320,4144,0
.long 110660,12288,4160,1065369472,111188,12416,4176,1065369472,111716,12288,4192,0,112244,12416,4208,0
.long 108552,16384,8448,1065369472,109080,16512,8464,1065369472,109608,16384,8480,0,110136,16512,8496,0
.long 110664,20480,8512,1065369472,111192,20608,8528,1065369472,111720,20480,8544,0,112248,20608,8560,0
.long 108556,24576,12288,1065369472,109084,24704,12304,1065369472,109612,24576,12320,0,110140,24704,12336,0
.long 110668,28672,12352,1065369472,111196,28800,12368,1065369472,111724,28672,12384,0,112252,28800,12400,0
.long 108672,32768,384,0,109200,32896,400,0,109728,32768,416,1065369472,110256,32896,432,1065369472
.long 110784,36864,448,0,111312,36992,464,0,111840,36864,480,1065369472,112368,36992,496,1065369472
.long 108676,40960,4224,0,109204,41088,4240,0,109732,40960,4256,1065369472,110260,41088,4272,1065369472
.long 110788,45056,4288,0,111316,45184,4304,0,111844,45056,4320,1065369472,112372,45184,4336,1065369472
.long 108680,49152,8576,0,109208,49280,8592,0,109736,49152,8608,1065369472,110264,49280,8624,1065369472
.long 110792,53248,8640,0,111320,53376,8656,0,111848,53248,8672,1065369472,112376,53376,8688,1065369472
.long 108684,57344,12416,0,109212,57472,12432,0,109740,57344,12448,1065369472,110268,57472,12464,1065369472
.long 110796,61440,12480,0,111324,61568,12496,0,111852,61440,12512,1065369472,112380,61568,12528,1065369472
.long 112896,0,256,1065369472,113424,128,272,1065369472,113952,0,288,0,114480,128,304,0
.long 115008,4096,320,1065369472,115536,4224,336,1065369472,116064,4096,352,0,116592,4224,368,0
.long 112900,8192,4096,1065369472,113428,8320,4112,1065369472,113956,8192,4128,0,114484,8320,4144,0
.long 115012,12288,4160,1065369472,115540,12416,4176,1065369472,116068,12288,4192,0,116596,12416,4208,0
.long 112904,16384,8448,1065369472,113432,16512,8464,1065369472,113960,16384,8480,0,114488,16512,8496,0
.long 115016,20480,8512,1065369472,115544,20608,8528,1065369472,116072,20480,8544,0,116600,20608,8560,0
.long 112908,24576,12288,1065369472,113436,24704,12304,1065369472,113964,24576,12320,0,114492,24704,12336,0
.long 115020,28672,12352,1065369472,115548,28800,12368,1065369472,116076,28672,12384,0,116604,28800,12400,0
.long 113024,32768,384,0,113552,32896,400,0,114080,32768,416,1065369472,114608,32896,432,1065369472
.long 115136,36864,448,0,115664,36992,464,0,116192,36864,480,1065369472,116720,36992,496,1065369472
.long 113028,40960,4224,0,113556,41088,4240,0,114084,40960,4256,1065369472,114612,41088,4272,1065369472
.long 115140,45056,4288,0,115668,45184,4304,0,116196,45056,4320,1065369472,116724,45184,4336,1065369472
.long 113032,49152,8576,0,113560,49280,8592,0,114088,49152,8608,1065369472,114616,49280,8624,1065369472
.long 115144,53248,8640,0,115672,53376,8656,0,116200,53248,8672,1065369472,116728,53376,8688,1065369472
.long 113036,57344,12416,0,113564,57472,12432,0,114092,57344,12448,1065369472,114620,57472,12464,1065369472
.long 115148,61440,12480,0,115676,61568,12496,0,116204,61440,12512,1065369472,116732,61568,12528,1065369472
.long 0,0,0,49920,16,0,4160,49928,32,0,2080,50048,48,0,6240,50056
.long 64,0,1040,54080,80,0,5200,54088,96,0,3120,54208,112,0,7280,54216
.long 4352,0,9360,52000,4368,0,13520,52008,4384,0,11440,52128,4400,0,15600,52136
.long 4416,0,8320,56160,4432,0,12480,56168,4448,0,10400,56288,4464,0,14560,56296
.long 8192,0,32,50960,8208,0,4192,50968,8224,0,2112,51088,8240,0,6272,51096
.long 8256,0,1072,55120,8272,0,5232,55128,8288,0,3152,55248,8304,0,7312,55256
.long 12544,0,9392,53040,12560,0,13552,53048,12576,0,11472,53168,12592,0,15632,53176
.long 12608,0,8352,57200,12624,0,12512,57208,12640,0,10432,57328,12656,0,14592,57336
.long 128,0,16,59280,144,0,4176,59288,160,0,2096,59408,176,0,6256,59416
.long 192,0,1056,63440,208,0,5216,63448,224,0,3136,63568,240,0,7296,63576
.long 4480,0,9376,61360,4496,0,13536,61368,4512,0,11456,61488,4528,0,15616,61496
.long 4544,0,8336,65520,4560,0,12496,65528,4576,0,10416,65648,4592,0,14576,65656
.long 8320,0,48,58240,8336,0,4208,58248,8352,0,2128,58368,8368,0,6288,58376
.long 8384,0,1088,62400,8400,0,5248,62408,8416,0,3168,62528,8432,0,7328,62536
.long 12672,0,9408,60320,12688,0,13568,60328,12704,0,11488,60448,12720,0,15648,60456
.long 12736,0,8368,64480,12752,0,12528,64488,12768,0,10448,64608,12784,0,14608,64616
.long 0,0,0,49920,16,0,4160,49928,32,0,2080,50048,48,0,6240,50056
.long 64,0,1040,54080,80,0,5200,54088,96,0,3120,54208,112,0,7280,54216
.long 4352,0,9360,52000,4368,0,13520,52008,4384,0,11440,52128,4400,0,15600,52136
.long 4416,0,8320,56160,4432,0,12480,56168,4448,0,10400,56288,4464,0,14560,56296
.long 8192,0,32,50960,8208,0,4192,50968,8224,0,2112,51088,8240,0,6272,51096
.long 8256,0,1072,55120,8272,0,5232,55128,8288,0,3152,55248,8304,0,7312,55256
.long 12544,0,9392,53040,12560,0,13552,53048,12576,0,11472,53168,12592,0,15632,53176
.long 12608,0,8352,57200,12624,0,12512,57208,12640,0,10432,57328,12656,0,14592,57336
.long 128,0,16,59280,144,0,4176,59288,160,0,2096,59408,176,0,6256,59416
.long 192,0,1056,63440,208,0,5216,63448,224,0,3136,63568,240,0,7296,63576
.long 4480,0,9376,61360,4496,0,13536,61368,4512,0,11456,61488,4528,0,15616,61496
.long 4544,0,8336,65520,4560,0,12496,65528,4576,0,10416,65648,4592,0,14576,65656
.long 8320,0,48,58240,8336,0,4208,58248,8352,0,2128,58368,8368,0,6288,58376
.long 8384,0,1088,62400,8400,0,5248,62408,8416,0,3168,62528,8432,0,7328,62536
.long 12672,0,9408,60320,12688,0,13568,60328,12704,0,11488,60448,12720,0,15648,60456
.long 12736,0,8368,64480,12752,0,12528,64488,12768,0,10448,64608,12784,0,14608,64616
.long 0,0,0,49920,16,0,4160,49928,32,0,2080,50048,48,0,6240,50056
.long 64,0,1040,54080,80,0,5200,54088,96,0,3120,54208,112,0,7280,54216
.long 4352,0,9360,52000,4368,0,13520,52008,4384,0,11440,52128,4400,0,15600,52136
.long 4416,0,8320,56160,4432,0,12480,56168,4448,0,10400,56288,4464,0,14560,56296
.long 8192,0,32,50960,8208,0,4192,50968,8224,0,2112,51088,8240,0,6272,51096
.long 8256,0,1072,55120,8272,0,5232,55128,8288,0,3152,55248,8304,0,7312,55256
.long 12544,0,9392,53040,12560,0,13552,53048,12576,0,11472,53168,12592,0,15632,53176
.long 12608,0,8352,57200,12624,0,12512,57208,12640,0,10432,57328,12656,0,14592,57336
.long 128,0,16,59280,144,0,4176,59288,160,0,2096,59408,176,0,6256,59416
.long 192,0,1056,63440,208,0,5216,63448,224,0,3136,63568,240,0,7296,63576
.long 4480,0,9376,61360,4496,0,13536,61368,4512,0,11456,61488,4528,0,15616,61496
.long 4544,0,8336,65520,4560,0,12496,65528,4576,0,10416,65648,4592,0,14576,65656
.long 8320,0,48,58240,8336,0,4208,58248,8352,0,2128,58368,8368,0,6288,58376
.long 8384,0,1088,62400,8400,0,5248,62408,8416,0,3168,62528,8432,0,7328,62536
.long 12672,0,9408,60320,12688,0,13568,60328,12704,0,11488,60448,12720,0,15648,60456
.long 12736,0,8368,64480,12752,0,12528,64488,12768,0,10448,64608,12784,0,14608,64616
.long 0,0,0,49920,16,0,4160,49928,32,0,2080,50048,48,0,6240,50056
.long 64,0,1040,54080,80,0,5200,54088,96,0,3120,54208,112,0,7280,54216
.long 4352,0,9360,52000,4368,0,13520,52008,4384,0,11440,52128,4400,0,15600,52136
.long 4416,0,8320,56160,4432,0,12480,56168,4448,0,10400,56288,4464,0,14560,56296
.long 8192,0,32,50960,8208,0,4192,50968,8224,0,2112,51088,8240,0,6272,51096
.long 8256,0,1072,55120,8272,0,5232,55128,8288,0,3152,55248,8304,0,7312,55256
.long 12544,0,9392,53040,12560,0,13552,53048,12576,0,11472,53168,12592,0,15632,53176
.long 12608,0,8352,57200,12624,0,12512,57208,12640,0,10432,57328,12656,0,14592,57336
.long 128,0,16,59280,144,0,4176,59288,160,0,2096,59408,176,0,6256,59416
.long 192,0,1056,63440,208,0,5216,63448,224,0,3136,63568,240,0,7296,63576
.long 4480,0,9376,61360,4496,0,13536,61368,4512,0,11456,61488,4528,0,15616,61496
.long 4544,0,8336,65520,4560,0,12496,65528,4576,0,10416,65648,4592,0,14576,65656
.long 8320,0,48,58240,8336,0,4208,58248,8352,0,2128,58368,8368,0,6288,58376
.long 8384,0,1088,62400,8400,0,5248,62408,8416,0,3168,62528,8432,0,7328,62536
.long 12672,0,9408,60320,12688,0,13568,60328,12704,0,11488,60448,12720,0,15648,60456
.long 12736,0,8368,64480,12752,0,12528,64488,12768,0,10448,64608,12784,0,14608,64616
.long 344887075,344887587,344888099,344888611,344889123,344889635,344890147,344890659,344891171,344891683,344892195,336891683,336892195,336892707,336893219,336893731
.long 336894243,336894755,336895267,336895779,179983058,179983570
.fill 42, 4, 0
.long 439600539,439601051,439601563,439602075,439602587,439603099,195711699,195712211,195712723,195713235,195713747,195714259,457168122,457168634,457169146,321163042
.long 321163554,321164066,321164578,321165090
.fill 44, 4, 0
.long 157170673,157171185,157171697,157172209,157172721,157173233,157173745,157174257,407807089,407807601,407808113,407808625,407809137,407809649,407810161,407810673
.long 407811185,407811697,407812209,407812721,407813233,407813745,407814257
.fill 41, 4, 0
.long 104857601,104858113,104858625,104859137,104859649,104860161,104860673,104861185,104861697,104862209,104862721,104863233,104863745,104864257,104864769,104865281
.long 104865793,104866305,104866817,104867329,104867841,104868353,104868865,104869377,104869889
.fill 39, 4, 0
.long 446678426,446678938,446679450,446679962,446680474,446680986,446681498,446682010,508548347,508548859,508549371,508549883,508550395,508550907,508551419,508551931
.long 508552443,508552955,508553467,508553979,508554491,508555003,508555515
.fill 41, 4, 0
.long 385786992,385787504,385788016,385788528,385789040,385789552,385790064,385790576,385791088,385791600,482333946,482334458,482334970,482335482,482335994,482336506
.long 482337018,482337530,482338042,421774747,421775259
.fill 43, 4, 0
.long 173685745,173686257,173686769,173687281,173687793,173688305,173688817,173689329,173689841,173690353,173690865,173691377,33554432,33554944,33555456,33555968
.long 33556480,33556992,33557504,33558016,134102001,134102513
.fill 42, 4, 0
.long 374252656,374253168,374253680,374254192,374254704,374255216,374255728,407807088,407807600,407808112,407808624,407809136,407809648,407810160,407810672,407811184
.long 407811696,407812208,407812720,407813232,407813744,407814256
.fill 42, 4, 0
.long 276452050,276452562,276453074,276453586,276454098,276454610,276455122,276455634,276456146,276456658,276457170,276457682,276458194,276458706,276459218,276459730
.long 276460242,276460754,276461266,276461778,276462290,276462802,276463314,276463826,276464338
.fill 39, 4, 0
.long 173685744,173686256,173686768,173687280,173687792,173688304,173688816,173689328,173689840,173690352,173690864,173691376,157170672,157171184,157171696,157172208
.long 157172720,157173232,157173744,157174256,304385826
.fill 43, 4, 0
.long 249189074,249189586,249190098,249190610,249191122,249191634,249192146,249192658,249193170,249193682,249194194,249194706,249195218,249195730,249196242,249196754
.long 249197266,249197778,8388608,8389120,352232561,352233073
.fill 42, 4, 0
.long 342134562,342135074,342135586,342136098,342136610,342137122,342137634,342138146,342138658,342139170,365864048,365864560,365865072,365865584,365866096,148782064
.long 148782576,148783088,148783600,148784112,148784624
.fill 43, 4, 0
.long 522507515,522508027,522508539,522509051,522509563,522510075,522510587,522511099,522511611,522512123,522512635,522513147,522513659,522514171,522514683,522515195
.long 522515707,522516219,522516731,430163354,430163866,430164378,430164890
.fill 41, 4, 0
.long 493868282,493868794,493869306,493869818,493870330,493870842,493871354,493871866,493872378,493872890,493873402,493873914,344887074,344887586,344888098,344888610
.long 344889122,344889634,344890146,344890658,344891170,344891682,344892194
.fill 41, 4, 0
.long 121634816,121635328,121635840,121636352,121636864,121637376,121637888,121638400,121638912,121639424,121639936,121640448,121640960,121641472,121641984,121642496
.long 121643008,121643520,121644032,121644544,121645056,121645568,121646080,121646592,121647104,121647616,121648128,121648640,121649152
.fill 35, 4, 0
.long 414426224,414426736,414427248,414427760,414428272,414428784,414429296,414429808,414430320,414430832,414431344,414431856,414432368,414432880,414433392,414433904
.long 414434416,8388609,8389121,179983059,179983571
.fill 43, 4, 0
.long 100663296,100663808,100664320,100664832,100665344,100665856,100666368,100666880,100667392,100667904,100668416,100668928,100669440,100669952,100670464,100670976
.long 100671488,100672000,100672512,100673024,100673536,100674048,100674560,100675072
.fill 40, 4, 0
.long 121634817,121635329,121635841,121636353,121636865,121637377,121637889,121638401,121638913,121639425,121639937,121640449,121640961,121641473,121641985,121642497
.long 121643009,121643521,121644033,121644545,121645057,121645569,121646081,121646593,121647105,121647617,121648129,121648641,121649153
.fill 35, 4, 0
.long 329551651,329552163,329552675,329553187,329553699,329554211,329554723,292455667,292456179,292456691,292457203,46137344,46137856,46138368,46138880,46139392
.long 46139904,46140416,46140928,46141440,46141952,46142464
.fill 42, 4, 0
.long 117440513,117441025,117441537,117442049,117442561,117443073,117443585,117444097,117444609,117445121,117445633,117446145,117446657,117447169,117447681,117448193
.long 117448705,117449217,117449729,117450241,117450753,117451265,117451777,117452289,117452801,117453313,117453825,117454337
.fill 36, 4, 0
.long 278811346,278811858,278812370,278812882,278813394,278813906,278814418,278814930,278815442,278815954,278816466,278816978,278817490,278818002,278818514,278819026
.long 278819538,278820050,278820562,278821074,278821586,278822098,278822610,278823122,278823634,278824146
.fill 38, 4, 0
.long 271209171,271209683,271210195,271210707,271211219,271211731,271212243,271212755,271213267,271213779,271214291,271214803,271215315,271215827,271216339,271216851
.long 271217363,271217875,271218387,271218899,271219411,271219923,271220435,271220947
.fill 40, 4, 0
.long 125698048,125698560,125699072,125699584,125700096,125700608,125701120,125701632,125702144,125702656,125703168,125703680,125704192,125704704,125705216,125705728
.long 125706240,125706752,125707264,125707776,125708288,125708800,125709312,125709824,125710336,125710848,125711360,125711872,125712384,125712896
.fill 34, 4, 0
.long 125698049,125698561,125699073,125699585,125700097,125700609,125701121,125701633,125702145,125702657,125703169,125703681,125704193,125704705,125705217,125705729
.long 125706241,125706753,125707265,125707777,125708289,125708801,125709313,125709825,125710337,125710849,125711361,125711873,125712385,125712897
.fill 34, 4, 0
.long 237654738,237655250,237655762,237656274,237656786,237657298,237657810,237658322,237658834,237659346,237659858,237660370,237660882,237661394,237661906,237662418
.long 365864049,365864561,365865073,365865585,365866097,304385827
.fill 42, 4, 0
.long 165559280,165559792,165560304,165560816,165561328,165561840,165562352,165562864,165563376,165563888,50331649,50332161,50332673,50333185,50333697,50334209
.long 50334721,50335233,50335745,50336257,50336769,50337281
.fill 42, 4, 0
.long 109051904,109052416,109052928,109053440,109053952,109054464,109054976,109055488,109056000,109056512,109057024,109057536,109058048,109058560,109059072,109059584
.long 109060096,109060608,109061120,109061632,109062144,109062656,109063168,109063680,109064192,109064704
.fill 38, 4, 0
.long 233460435,233460947,233461459,233461971,233462483,233462995,233463507,233464019,233464531,233465043,233465555,233466067,233466579,233467091,233467603,464508154
.long 464508666,464509178,464509690,464510202,134102000,134102512
.fill 42, 4, 0
.long 113246208,113246720,113247232,113247744,113248256,113248768,113249280,113249792,113250304,113250816,113251328,113251840,113252352,113252864,113253376,113253888
.long 113254400,113254912,113255424,113255936,113256448,113256960,113257472,113257984,113258496,113259008,113259520
.fill 37, 4, 0
.long 88080385,88080897,88081409,88081921,88082433,88082945,88083457,88083969,88084481,88084993,88085505,88086017,88086529,88087041,88087553,88088065
.long 88088577,88089089,88089601,88090113,88090625,352232560,352233072
.fill 41, 4, 0
.long 272257746,272258258,272258770,272259282,272259794,272260306,272260818,272261330,272261842,272262354,272262866,272263378,272263890,272264402,272264914,272265426
.long 272265938,272266450,272266962,272267474,272267986,272268498,272269010,272269522
.fill 40, 4, 0
.long 113246209,113246721,113247233,113247745,113248257,113248769,113249281,113249793,113250305,113250817,113251329,113251841,113252353,113252865,113253377,113253889
.long 113254401,113254913,113255425,113255937,113256449,113256961,113257473,113257985,113258497,113259009,113259521
.fill 37, 4, 0
.long 494916859,494917371,494917883,494918395,494918907,494919419,494919931,494920443,494920955,494921467,494921979,494922491,188371666,188372178,188372690,188373202
.long 292455666,292456178,292456690,292457202,284067059,284067571
.fill 42, 4, 0
.long 205148883,205149395,205149907,205150419,205150931,205151443,205151955,205152467,25165825,25166337,25166849,25167361,25167873,25168385,188371667,188372179
.long 188372691,188373203,357475440,357475952,357476464
.fill 43, 4, 0
.long 438551962,438552474,438552986,438553498,438554010,438554522,517985531,517986043,517986555,517987067,517987579,517988091,517988603,517989115,517989627,517990139
.long 517990651,517991163,517991675,517992187,517992699,517993211,517993723
.fill 41, 4, 0
.long 100663297,100663809,100664321,100664833,100665345,100665857,100666369,100666881,100667393,100667905,100668417,100668929,100669441,100669953,100670465,100670977
.long 100671489,100672001,100672513,100673025,100673537,100674049,100674561,100675073
.fill 40, 4, 0
.long 165559281,165559793,165560305,165560817,165561329,165561841,165562353,165562865,165563377,165563889,300188914,300189426,300189938,300190450,300190962,300191474
.long 16777216,16777728,16778240,16778752,449828090
.fill 43, 4, 0
.long 213537491,213538003,213538515,213539027,213539539,213540051,213540563,213541075,213541587,213542099,33554433,33554945,33555457,33555969,33556481,33556993
.long 33557505,33558017,312774434,312774946,312775458
.fill 43, 4, 0
.long 148782065,148782577,148783089,148783601,148784113,148784625,414426225,414426737,414427249,414427761,414428273,414428785,414429297,414429809,414430321,414430833
.long 414431345,414431857,414432369,414432881,414433393,414433905,414434417
.fill 41, 4, 0
.long 237654739,237655251,237655763,237656275,237656787,237657299,237657811,237658323,237658835,237659347,237659859,237660371,237660883,237661395,237661907,237662419
.long 473945338,473945850,473946362,473946874,473947386,473947898,473948410
.fill 41, 4, 0
.long 232411858,232412370,232412882,232413394,232413906,232414418,232414930,232415442,232415954,232416466,232416978,232417490,232418002,232418514,196760274,196760786
.long 196761298,196761810,196762322,196762834,457168123,457168635,457169147
.fill 41, 4, 0
.long 268063443,268063955,268064467,268064979,268065491,268066003,268066515,268067027,268067539,268068051,268068563,268069075,268069587,268070099,268070611,268071123
.long 268071635,268072147,268072659,268073171,268073683,268074195,268074707
.fill 41, 4, 0
.long 117440512,117441024,117441536,117442048,117442560,117443072,117443584,117444096,117444608,117445120,117445632,117446144,117446656,117447168,117447680,117448192
.long 117448704,117449216,117449728,117450240,117450752,117451264,117451776,117452288,117452800,117453312,117453824,117454336
.fill 36, 4, 0
.long 522507514,522508026,522508538,522509050,522509562,522510074,522510586,522511098,522511610,522512122,522512634,522513146,522513658,522514170,522514682,522515194
.long 522515706,522516218,522516730,142490608,142491120,142491632,142492144
.fill 41, 4, 0
.long 104857600,104858112,104858624,104859136,104859648,104860160,104860672,104861184,104861696,104862208,104862720,104863232,104863744,104864256,104864768,104865280
.long 104865792,104866304,104866816,104867328,104867840,104868352,104868864,104869376,104869888
.fill 39, 4, 0
.long 446678427,446678939,446679451,446679963,446680475,446680987,446681499,446682011,402564208,402564720,402565232,402565744,402566256,402566768,402567280,402567792
.long 402568304,402568816,402569328,402569840,402570352,402570864
.fill 42, 4, 0
.long 257577682,257578194,257578706,257579218,257579730,257580242,257580754,257581266,257581778,257582290,257582802,257583314,257583826,257584338,257584850,257585362
.long 257585874,257586386,257586898,257587410,312774435,312774947,312775459
.fill 41, 4, 0
.long 224023251,224023763,224024275,224024787,224025299,224025811,224026323,224026835,224027347,224027859,224028371,224028883,41943041,41943553,41944065,41944577
.long 41945089,41945601,41946113,41946625,41947137,41947649
.fill 42, 4, 0
.long 88080384,88080896,88081408,88081920,88082432,88082944,88083456,88083968,88084480,88084992,88085504,88086016,88086528,88087040,88087552,88088064
.long 88088576,88089088,88089600,88090112,88090624,422823322,422823834
.fill 41, 4, 0
.long 96468993,96469505,96470017,96470529,96471041,96471553,96472065,96472577,96473089,96473601,96474113,96474625,96475137,96475649,96476161,96476673
.long 96477185,96477697,96478209,96478721,96479233,96479745,96480257
.fill 41, 4, 0
.long 58720256,58720768,58721280,58721792,58722304,58722816,58723328,58723840,58724352,58724864,58725376,58725888,58726400,58726912,25165824,25166336
.long 25166848,25167360,25167872,25168384,284067058,284067570
.fill 42, 4, 0
.long 249189075,249189587,249190099,249190611,249191123,249191635,249192147,249192659,249193171,249193683,249194195,249194707,249195219,249195731,249196243,249196755
.long 249197267,249197779,431211931,431212443,431212955,431213467
.fill 42, 4, 0
.long 50331648,50332160,50332672,50333184,50333696,50334208,50334720,50335232,50335744,50336256,50336768,50337280,482333947,482334459,482334971,482335483
.long 482335995,482336507,482337019,482337531,482338043,451925243,451925755
.fill 41, 4, 0
.long 499111162,499111674,499112186,499112698,499113210,499113722,499114234,499114746,499115258,499115770,499116282,499116794,499117306,391029872,391030384,391030896
.long 391031408,391031920,391032432,391032944,391033456,391033968,391034480,391034992
.fill 40, 4, 0
.long 391029873,391030385,391030897,391031409,391031921,391032433,391032945,391033457,391033969,391034481,391034993,373204081,373204593,373205105,373205617,373206129
.long 373206641,373207153,140393457,140393969,140394481,140394993
.fill 42, 4, 0
.long 276452051,276452563,276453075,276453587,276454099,276454611,276455123,276455635,276456147,276456659,276457171,276457683,276458195,276458707,276459219,276459731
.long 276460243,276460755,276461267,276461779,276462291,276462803,276463315,276463827,276464339
.fill 39, 4, 0
.long 399418481,399418993,399419505,399420017,399420529,399421041,399421553,399422065,399422577,399423089,399423601,399424113,399424625,215634642,215635154,215635666
.long 215636178,215636690,215637202,215637714,215638226,215638738,215639250
.fill 41, 4, 0
.long 519034106,519034618,519035130,519035642,519036154,519036666,519037178,519037690,519038202,519038714,519039226,519039738,519040250,519040762,519041274,519041786
.long 519042298,519042810,20971521,20972033,20972545,20973057,20973569
.fill 41, 4, 0
.long 221926098,221926610,221927122,221927634,221928146,221928658,221929170,221929682,221930194,221930706,221931218,221931730,204100306,204100818,204101330,204101842
.long 204102354,204102866,204103378,204103890,357475441,357475953,357476465
.fill 41, 4, 0
.long 109051905,109052417,109052929,109053441,109053953,109054465,109054977,109055489,109056001,109056513,109057025,109057537,109058049,109058561,109059073,109059585
.long 109060097,109060609,109061121,109061633,109062145,109062657,109063169,109063681,109064193,109064705
.fill 38, 4, 0
.long 321163043,321163555,321164067,321164579,321165091,464508155,464508667,464509179,464509691,464510203,501208315,501208827,501209339,501209851,501210363,501210875
.long 501211387,501211899,501212411,501212923,501213435,501213947,501214459
.fill 41, 4, 0
.long 328503074,328503586,328504098,328504610,328505122,328505634,328506146,509596922,509597434,509597946,509598458,509598970,509599482,509599994,509600506,509601018
.long 509601530,509602042,509602554,509603066,509603578,509604090
.fill 42, 4, 0
.long 473945339,473945851,473946363,473946875,473947387,473947899,473948411,300188915,300189427,300189939,300190451,300190963,300191475,384738417,384738929,384739441
.long 384739953,384740465,384740977,384741489,384742001,384742513,384743025
.fill 41, 4, 0
.long 278811347,278811859,278812371,278812883,278813395,278813907,278814419,278814931,278815443,278815955,278816467,278816979,278817491,278818003,278818515,278819027
.long 278819539,278820051,278820563,278821075,278821587,278822099,278822611,278823123,278823635,278824147
.fill 38, 4, 0
.long 21054976,21448192,21553152,17,2,0,143,9380608,20334080,20858368,21553152,12,3,0,9260,9380608
.long 10920960,17425408,17424384,0,0,1,3669,5427712
.fill 40, 4, 0
.long 21120512,21513728,21553152,18,2,0,8236,9380608,20596224,20792832,21553152,14,0,1,10286,9380608
.long 17425408,10986496,17424384,0,0,1,3672,5427712
.fill 40, 4, 0
.long 21186048,21317120,21553152,18,0,1,10287,9380608,20661760,20989440,21553152,14,2,0,9261,9380608
.long 17425408,11052032,17424384,0,0,1,2650,5427712
.fill 40, 4, 0
.long 21251584,21382656,21553152,19,0,0,140,9380608,20727296,20923904,21553152,15,0,0,1166,9380608
.long 10855424,11183104,17424384,0,1,0,1630,5427712
.fill 40, 4, 0
.long 26818048,27276800,27914240,7,2,0,142,12950272,11642368,12166656,17424384,6,3,0,9260,5427968
.long 27980800,28505088,32653312,0,3,0,9839,13957632,19350528,19743744,21553152,4,2,1,9791,9380352
.fill 32, 4, 0
.long 26949120,27407872,27914240,8,2,0,8238,12950272,11773440,12101120,17424384,7,1,1,142,5427968
.long 28046336,28374016,32653312,1,1,1,1742,13957632,19547136,20005888,21553152,6,2,0,17726,9380352
.fill 32, 4, 0
.long 27014656,27145728,27914240,8,0,1,10287,12950272,11838976,11970048,17424384,7,0,1,1167,5427968
.long 28111872,28242944,32653312,1,0,1,1743,13957632,19612672,19940352,21553152,6,2,0,17725,9380352
.fill 32, 4, 0
.long 27080192,27211264,27914240,9,0,0,140,12950272,11904512,12035584,17424384,8,0,1,3084,5427968
.long 28177408,28308480,32653312,2,0,1,3596,13957632,19678208,19874816,21553152,7,0,0,1182,9380352
.fill 32, 4, 0
.long 9298432,9757184,10854400,11,2,0,142,3928320,24830464,25223680,25899008,25,2,0,1180,10776832
.fill 48, 4, 0
.long 9363968,9691648,10854400,11,2,0,141,3928320,24961536,25158144,25899008,26,0,1,19774,10776832
.fill 48, 4, 0
.long 9429504,9626112,10854400,12,0,1,2062,3928320,25027072,25420288,25899008,26,2,0,17727,10776832
.fill 48, 4, 0
.long 9495040,9560576,10854400,12,0,1,2061,3928320,25092608,25289216,25899008,27,0,0,1182,10776832
.fill 48, 4, 0
.long 4719104,6488576,7856128,36,12,0,16702,256
.fill 56, 4, 0
.long 4784640,6423040,7856128,36,12,0,16701,256
.fill 56, 4, 0
.long 4850176,6357504,7856128,37,10,0,16830,256
.fill 56, 4, 0
.long 4915712,6291968,7856128,37,10,0,16829,256
.fill 56, 4, 0
.long 27407360,27800576,27914240,11,2,0,143,12950016,31061504,31454720,32653312,24,2,1,17724,13957888
.fill 48, 4, 0
.long 27472896,27866112,27914240,12,2,0,8236,12950016,31127040,31716864,32653312,24,4,0,16701,13957888
.fill 48, 4, 0
.long 27538432,27669504,27914240,12,0,1,10287,12950016,31192576,31389184,32653312,25,0,1,1182,13957888
.fill 48, 4, 0
.long 27603968,27735040,27914240,13,0,0,140,12950016,31323648,31520256,32653312,26,0,1,3102,13957888
.fill 48, 4, 0
.long 23584768,23977984,25899008,15,2,0,143,10776576,29488128,30077952,32653312,12,3,0,9262,13957632
.long 27915776,26228224,27914240,0,1,0,9850,12950272
.fill 40, 4, 0
.long 23650304,24043520,25899008,16,2,0,8236,10776576,29619200,29946880,32653312,13,1,1,142,13957632
.long 25900544,26293760,27914240,0,2,0,18300,12950272
.fill 40, 4, 0
.long 23715840,23846912,25899008,16,0,1,10287,10776576,29684736,29815808,32653312,13,0,1,1167,13957632
.long 25966080,26097152,27914240,0,0,1,20351,12950272
.fill 40, 4, 0
.long 23781376,23912448,25899008,17,0,0,140,10776576,29750272,29881344,32653312,14,0,1,3084,13957632
.long 26031616,26162688,27914240,1,0,0,1756,12950272
.fill 40, 4, 0
.long 10347008,10805760,10854400,19,2,0,142,3928320,1572864,2031616,7856128,12,2,0,9262,0
.long 10854912,8053248,10854400,0,0,1,10874,3928320
.fill 40, 4, 0
.long 10412544,10740224,10854400,19,2,0,141,3928320,1638400,1966080,7856128,12,2,0,9261,0
.long 10854912,7987712,10854400,0,0,1,10872,3928320
.fill 40, 4, 0
.long 10478080,10674688,10854400,20,0,1,2062,3928320,1703936,1900544,7856128,13,0,0,1166,0
.long 7856640,8315392,10854400,0,2,0,18302,3928320
.fill 40, 4, 0
.long 10543616,10609152,10854400,20,0,1,2061,3928320,1769472,1835008,7856128,13,0,0,1165,0
.long 7922176,8249856,10854400,0,2,0,18301,3928320
.fill 40, 4, 0
.long 22732800,23060480,25899008,9,1,1,142,10776576,24698880,25419776,25899008,24,4,0,17726,10776576
.fill 48, 4, 0
.long 22863872,23257088,25899008,10,2,0,8236,10776576,24764416,25288704,25899008,24,3,0,16703,10776576
.fill 48, 4, 0
.long 22929408,23322624,25899008,10,2,0,8239,10776576,24829952,25223168,25899008,25,2,0,16828,10776576
.fill 48, 4, 0
.long 22994944,23126016,25899008,11,0,0,140,10776576,24895488,25157632,25899008,25,1,1,17855,10776576
.fill 48, 4, 0
.long 16098304,16884736,17424384,40,5,1,16700,5427712
.fill 56, 4, 0
.long 16229376,17146880,17424384,41,6,0,16828,5427712
.fill 56, 4, 0
.long 16294912,17212416,17424384,41,6,0,16831,5427712
.fill 56, 4, 0
.long 16425984,17081344,17424384,42,4,1,31,5427712
.fill 56, 4, 0
.long 10346496,10805248,10854400,19,2,0,142,3928064,9297920,9756672,10854400,11,2,0,1166,3928064
.long 18760704,21554176,21553152,0,0,0,3668,9380352
.fill 40, 4, 0
.long 10412032,10739712,10854400,19,2,0,141,3928064,9363456,9691136,10854400,11,2,0,1165,3928064
.long 18826240,21554176,21553152,0,0,0,3669,9380352
.fill 40, 4, 0
.long 10477568,10674176,10854400,20,0,1,2062,3928064,9428992,9625600,10854400,12,0,1,3086,3928064
.long 21554176,18891776,21553152,0,0,0,3672,9380352
.fill 40, 4, 0
.long 10543104,10608640,10854400,20,0,1,2061,3928064,9494528,9560064,10854400,12,0,1,3085,3928064
.long 21554176,18957312,21553152,0,0,0,3674,9380352
.fill 40, 4, 0
.long 14853120,15508480,17424384,30,4,0,8239,5427712,0,393216,7856128,0,2,0,8812,0
.long 25899520,21946880,25899008,0,2,0,600,10776832
.fill 40, 4, 0
.long 14918656,15246336,17424384,31,1,1,142,5427712,65536,458752,7856128,0,2,0,9839,0
.long 25899520,21881344,25899008,0,1,0,602,10776832
.fill 40, 4, 0
.long 14984192,15115264,17424384,31,0,1,143,5427712,131072,262144,7856128,1,0,0,1740,0
.long 25899520,21815808,25899008,0,1,0,1624,10776832
.fill 40, 4, 0
.long 15049728,15180800,17424384,32,0,1,2060,5427712,196608,327680,7856128,1,0,0,1743,0
.long 25899520,21750272,25899008,0,0,1,3674,10776832
.fill 40, 4, 0
.long 20530176,21054464,21553152,13,3,1,143,9380352,22208512,22667264,25899008,5,2,0,1678,10776576
.long 8642560,9166848,10854400,6,3,0,17724,3928064
.fill 40, 4, 0
.long 20857856,21251072,21553152,16,2,0,8236,9380352,22339584,22798336,25899008,6,2,0,8238,10776576
.long 8708096,9232384,10854400,6,3,0,16703,3928064
.fill 40, 4, 0
.long 20923392,21316608,21553152,16,2,0,8239,9380352,22405120,22536192,25899008,6,0,1,10287,10776576
.long 8904704,9035776,10854400,8,0,1,3100,3928064
.fill 40, 4, 0
.long 20988928,21120000,21553152,17,0,0,140,9380352,22470656,22601728,25899008,7,0,0,1164,10776576
.long 8970240,9101312,10854400,8,0,1,3103,3928064
.fill 40, 4, 0
.long 32110080,32634368,32653312,32,3,0,8236,13957888,26293248,26686464,27914240,3,2,0,1692,12950016
.fill 48, 4, 0
.long 32175616,32568832,32653312,32,2,1,8239,13957888,26424320,26620928,27914240,4,0,1,20286,12950016
.fill 48, 4, 0
.long 32241152,32437760,32653312,33,0,1,142,13957888,26489856,26817536,27914240,4,2,0,18237,12950016
.fill 48, 4, 0
.long 32372224,32503296,32653312,34,0,1,2060,13957888,26555392,26752000,27914240,5,0,0,1694,12950016
.fill 48, 4, 0
.long 30274560,30798848,32653312,18,3,0,8236,13957632,20595712,21185536,21553152,14,3,1,17726,9380352
.fill 48, 4, 0
.long 30405632,30733312,32653312,19,1,1,142,13957632,20661248,21382144,21553152,14,5,0,17725,9380352
.fill 48, 4, 0
.long 30471168,30602240,32653312,19,0,1,143,13957632,20726784,21447680,21553152,15,4,0,17854,9380352
.fill 48, 4, 0
.long 30536704,30667776,32653312,20,0,1,2060,13957632,20792320,21513216,21553152,15,5,0,17853,9380352
.fill 48, 4, 0
.long 3932160,7536640,7856128,30,26,0,16702
.fill 57, 4, 0
.long 3997696,7471104,7856128,30,26,0,16701
.fill 57, 4, 0
.long 4063232,7405568,7856128,31,24,0,16830
.fill 57, 4, 0
.long 4128768,7340032,7856128,31,24,0,16829
.fill 57, 4, 0
.long 25354240,25747456,25899008,29,2,0,140,10776576,512,393728,7856128,0,2,0,9836,256
.long 10921472,17425920,17424384,0,0,1,2645,5427968
.fill 40, 4, 0
.long 25485312,25681920,25899008,30,0,1,10286,10776576,66048,459264,7856128,0,2,0,9839,256
.long 17425920,10987008,17424384,0,0,1,2648,5427968
.fill 40, 4, 0
.long 25550848,25878528,25899008,30,2,0,8237,10776576,131584,262656,7856128,1,0,0,716,256
.long 17425920,11052544,17424384,0,0,1,3674,5427968
.fill 40, 4, 0
.long 25616384,25812992,25899008,31,0,0,142,10776576,197120,328192,7856128,1,0,0,1743,256
.long 10855936,11183616,17424384,0,1,0,1630,5427968
.fill 40, 4, 0
.long 5767168,6094848,7856128,44,1,0,16702
.fill 57, 4, 0
.long 5832704,6029312,7856128,44,1,0,16701
.fill 57, 4, 0
.long 5898240,6225920,7856128,45,1,0,16830
.fill 57, 4, 0
.long 5963776,6160384,7856128,45,1,0,16829
.fill 57, 4, 0
.long 3408384,7537152,7856128,26,30,0,16702,256
.fill 56, 4, 0
.long 3473920,7471616,7856128,26,30,0,16701,256
.fill 56, 4, 0
.long 3539456,7406080,7856128,27,28,0,16830,256
.fill 56, 4, 0
.long 3604992,7340544,7856128,27,28,0,16829,256
.fill 56, 4, 0
.long 19809792,20268544,21553152,8,2,1,8238,9380608,17753600,18212352,18759680,2,3,0,9773,8712960
.long 2097152,2818048,7856128,16,4,0,17726
.fill 41, 4, 0
.long 20071936,20530688,21553152,10,2,0,8238,9380608,17819136,18146816,18759680,3,1,1,654,8712960
.long 2162688,2752512,7856128,16,4,0,17725
.fill 41, 4, 0
.long 20137472,20465152,21553152,10,2,0,8237,9380608,17884672,18015744,18759680,3,0,1,655,8712960
.long 2228224,2686976,7856128,17,2,0,17854
.fill 41, 4, 0
.long 20203008,20399616,21553152,11,0,0,142,9380608,17950208,18081280,18759680,4,0,1,3596,8712960
.long 2293760,2621440,7856128,17,2,0,17853
.fill 41, 4, 0
.long 3670528,7275008,7856128,28,26,0,16702,256
.fill 56, 4, 0
.long 3736064,7209472,7856128,28,26,0,16701,256
.fill 56, 4, 0
.long 3801600,7143936,7856128,29,24,0,16830,256
.fill 56, 4, 0
.long 3867136,7078400,7856128,29,24,0,16829,256
.fill 56, 4, 0
.long 15836160,17409024,17424384,38,11,0,16700,5427712
.fill 56, 4, 0
.long 15901696,17343488,17424384,38,10,1,16703,5427712
.fill 56, 4, 0
.long 15967232,17277952,17424384,39,9,1,156,5427712
.fill 56, 4, 0
.long 16163840,17015808,17424384,40,6,2,29,5427712
.fill 56, 4, 0
.long 15902208,16426496,17424384,38,3,2,16703,5427968
.fill 56, 4, 0
.long 15967744,16754176,17424384,39,5,1,16828,5427968
.fill 56, 4, 0
.long 16033280,16885248,17424384,39,6,0,16829,5427968
.fill 56, 4, 0
.long 16164352,16819712,17424384,40,4,1,31,5427968
.fill 56, 4, 0
.long 3670016,7798784,7856128,28,30,0,16702
.fill 57, 4, 0
.long 3735552,7733248,7856128,28,30,0,16701
.fill 57, 4, 0
.long 3801088,7667712,7856128,29,28,0,16830
.fill 57, 4, 0
.long 3866624,7602176,7856128,29,28,0,16829
.fill 57, 4, 0
.long 3146240,7799296,7856128,24,34,0,16702,256
.fill 56, 4, 0
.long 3211776,7733760,7856128,24,34,0,16701,256
.fill 56, 4, 0
.long 3277312,7668224,7856128,25,32,0,16830,256
.fill 56, 4, 0
.long 3342848,7602688,7856128,25,32,0,16829,256
.fill 56, 4, 0
.long 14263296,14787584,17424384,26,3,0,8236,5427712,22209024,22667776,25899008,5,2,0,1678,10776832
.long 18761216,21554688,21553152,0,0,0,3668,9380608
.fill 40, 4, 0
.long 14328832,14722048,17424384,26,2,1,8239,5427712,22340096,22798848,25899008,6,2,0,9262,10776832
.long 18826752,21554688,21553152,0,0,0,2645,9380608
.fill 40, 4, 0
.long 14394368,14590976,17424384,27,0,1,142,5427712,22405632,22536704,25899008,6,0,1,11311,10776832
.long 21554688,18892288,21553152,0,0,0,3672,9380608
.fill 40, 4, 0
.long 14525440,14656512,17424384,28,0,1,2060,5427712,22471168,22602240,25899008,7,0,0,1164,10776832
.long 21554688,18957824,21553152,0,0,0,3674,9380608
.fill 40, 4, 0
.long 9822208,10280960,10854400,15,2,0,142,3928064,2621952,2949632,7856128,20,1,0,17726,256
.fill 48, 4, 0
.long 9887744,10215424,10854400,15,2,0,141,3928064,2687488,2884096,7856128,20,1,0,17725,256
.fill 48, 4, 0
.long 9953280,10149888,10854400,16,0,1,2062,3928064,2753024,3080704,7856128,21,1,0,17854,256
.fill 48, 4, 0
.long 10018816,10084352,10854400,16,0,1,2061,3928064,2818560,3015168,7856128,21,1,0,17853,256
.fill 48, 4, 0
.long 4980736,6750208,7856128,38,12,0,16702
.fill 57, 4, 0
.long 5046272,6684672,7856128,38,12,0,16701
.fill 57, 4, 0
.long 5111808,6619136,7856128,39,10,0,16830
.fill 57, 4, 0
.long 5177344,6553600,7856128,39,10,0,16829
.fill 57, 4, 0
.long 13739520,14525952,17424384,22,5,0,8236,5427968,28439552,28963840,32653312,4,3,0,9772,13957632
.long 10854400,8052736,10854400,0,0,1,11898,3928064
.fill 40, 4, 0
.long 13805056,14460416,17424384,22,4,1,8239,5427968,28570624,28898304,32653312,5,1,1,1678,13957632
.long 10854400,7987200,10854400,0,0,1,11896,3928064
.fill 40, 4, 0
.long 13870592,14132736,17424384,23,1,2,140,5427968,28636160,28767232,32653312,5,0,1,1679,13957632
.long 7856128,8314880,10854400,0,2,0,18302,3928064
.fill 40, 4, 0
.long 14001664,14394880,17424384,24,2,1,12,5427968,28701696,28832768,32653312,6,0,1,3084,13957632
.long 7921664,8249344,10854400,0,2,0,18301,3928064
.fill 40, 4, 0
.long 4456448,7012352,7856128,34,18,0,16702
.fill 57, 4, 0
.long 4521984,6946816,7856128,34,18,0,16701
.fill 57, 4, 0
.long 4587520,6881280,7856128,35,16,0,16830
.fill 57, 4, 0
.long 4653056,6815744,7856128,35,16,0,16829
.fill 57, 4, 0
.long 4456960,5374464,7856128,34,6,0,8236,256,25899008,21946368,25899008,0,2,0,600,10776576
.fill 48, 4, 0
.long 4522496,5440000,7856128,34,6,0,8239,256,25899008,21880832,25899008,0,1,0,602,10776576
.fill 48, 4, 0
.long 4588032,5112320,7856128,35,3,1,140,256,25899008,21815296,25899008,0,1,0,1624,10776576
.fill 48, 4, 0
.long 4653568,5177856,7856128,35,3,1,143,256,25899008,21749760,25899008,0,0,1,3674,10776576
.fill 48, 4, 0
.long 16360448,16688128,17424384,42,1,1,16702,5427712
.fill 56, 4, 0
.long 16491520,16753664,17424384,43,1,1,16828,5427712
.fill 56, 4, 0
.long 16557056,16950272,17424384,43,2,0,16831,5427712
.fill 56, 4, 0
.long 16622592,16819200,17424384,44,0,1,2078,5427712
.fill 56, 4, 0
.long 3932672,7012864,7856128,30,22,0,16702,256
.fill 56, 4, 0
.long 3998208,6947328,7856128,30,22,0,16701,256
.fill 56, 4, 0
.long 4063744,6881792,7856128,31,20,0,16830,256
.fill 56, 4, 0
.long 4129280,6816256,7856128,31,20,0,16829,256
.fill 56, 4, 0
.long 30275072,30864896,32653312,18,3,0,8238,13957888,11117568,11707392,17424384,2,3,0,9774,5427712
.long 17753088,18211840,18759680,2,3,0,9773,8712704,17491456,18761216,18759680,0,0,1,3669,8712960
.fill 32, 4, 0
.long 30406144,30733824,32653312,19,1,1,142,13957888,11248640,11576320,17424384,3,1,1,1678,5427712
.long 17818624,18146304,18759680,3,1,1,1678,8712704,18761216,17556992,18759680,0,0,1,3672,8712960
.fill 32, 4, 0
.long 30471680,30602752,32653312,19,0,1,143,13957888,11314176,11445248,17424384,3,0,1,1679,5427712
.long 17884160,18015232,18759680,3,0,1,1679,8712704,18761216,17622528,18759680,0,0,1,3674,8712960
.fill 32, 4, 0
.long 30537216,30668288,32653312,20,0,1,2060,13957888,11379712,11510784,17424384,4,0,1,3596,5427712
.long 17949696,18080768,18759680,4,0,1,3596,8712704,17425920,17688064,18759680,0,1,0,1628,8712960
.fill 32, 4, 0
.long 12232192,12756480,17424384,10,3,0,8239,5427968,786944,1442304,7856128,6,4,0,9260,256
.long 11118080,11707904,17424384,2,3,0,8750,5427968,25899008,22077440,25899008,0,3,0,9848,10776576
.fill 32, 4, 0
.long 12297728,12625408,17424384,11,1,1,142,5427968,852480,1507840,7856128,6,4,0,9263,256
.long 11249152,11576832,17424384,3,1,1,654,5427968,21553152,22142976,25899008,0,3,0,18302,10776576
.fill 32, 4, 0
.long 12363264,12494336,17424384,11,0,1,143,5427968,918016,1311232,7856128,7,2,0,1164,256
.long 11314688,11445760,17424384,3,0,1,1679,5427968,21618688,22274048,25899008,0,4,0,18303,10776576
.fill 32, 4, 0
.long 12428800,12559872,17424384,12,0,1,2060,5427968,983552,1376768,7856128,7,2,0,1167,256
.long 11380224,11511296,17424384,4,0,1,3596,5427968,21684224,22011904,25899008,1,1,1,1758,10776576
.fill 32, 4, 0
.long 26883072,27276288,27914240,7,2,0,143,12950016,31585792,31979008,32653312,28,2,1,17724,13957888
.fill 48, 4, 0
.long 26948608,27341824,27914240,8,2,0,8236,12950016,31651328,32306688,32653312,28,4,0,16703,13957888
.fill 48, 4, 0
.long 27014144,27145216,27914240,8,0,1,10287,12950016,31782400,31913472,32653312,29,0,1,1183,13957888
.fill 48, 4, 0
.long 27079680,27210752,27914240,9,0,0,140,12950016,31847936,32044544,32653312,30,0,1,3102,13957888
.fill 48, 4, 0
.long 4981248,6226432,7856128,38,8,0,16702,256
.fill 56, 4, 0
.long 5046784,6160896,7856128,38,8,0,16701,256
.fill 56, 4, 0
.long 5243392,6095360,7856128,40,5,0,30,256
.fill 56, 4, 0
.long 5308928,6029824,7856128,40,5,0,29,256
.fill 56, 4, 0
.long 9822720,10281472,10854400,15,2,0,142,3928320,18277376,18736128,18759680,6,3,0,9261,8712704
.long 524288,917504,7856128,4,2,0,9772,0,32654336,32654336,32653312,0,0,0,2640,13957632
.fill 32, 4, 0
.long 9888256,10215936,10854400,15,2,0,141,3928320,18342912,18670592,18759680,7,1,1,1166,8712704
.long 589824,983040,7856128,4,2,0,9775,0,32654336,32654336,32653312,0,0,0,2640,13957632
.fill 32, 4, 0
.long 9953792,10150400,10854400,16,0,1,2062,3928320,18408448,18539520,18759680,7,0,1,1167,8712704
.long 655360,786432,7856128,5,0,0,1676,0,32654336,32654336,32653312,0,0,0,3664,13957632
.fill 32, 4, 0
.long 10019328,10084864,10854400,16,0,1,2061,3928320,18473984,18605056,18759680,8,0,1,3084,8712704
.long 720896,851968,7856128,5,0,0,1679,0,27915264,32654336,32653312,0,0,0,3668,13957632
.fill 32, 4, 0
.long 12690944,13280768,17424384,14,3,0,8238,5427968,1573376,2032128,7856128,12,2,0,9262,256
.long 21554176,19219456,21553152,0,2,1,8826,9380352
.fill 40, 4, 0
.long 12822016,13149696,17424384,15,1,1,142,5427968,1638912,1966592,7856128,12,2,0,9261,256
.long 19022848,19481600,21553152,2,2,0,17214,9380352
.fill 40, 4, 0
.long 12887552,13018624,17424384,15,0,1,143,5427968,1704448,1901056,7856128,13,0,0,1166,256
.long 19088384,19416064,21553152,2,2,0,18237,9380352
.fill 40, 4, 0
.long 12953088,13084160,17424384,16,0,1,2060,5427968,1769984,1835520,7856128,13,0,0,1165,256
.long 19153920,19284992,21553152,3,0,0,1692,9380352
.fill 40, 4, 0
.long 8774144,9167360,10854400,7,2,0,140,3928320,25354752,25747968,25899008,29,2,0,1180,10776832
.fill 48, 4, 0
.long 8839680,9232896,10854400,7,2,0,143,3928320,25485824,25682432,25899008,30,0,1,19774,10776832
.fill 48, 4, 0
.long 8905216,9036288,10854400,8,0,1,2060,3928320,25551360,25879040,25899008,30,2,0,17725,10776832
.fill 48, 4, 0
.long 8970752,9101824,10854400,8,0,1,2063,3928320,25616896,25813504,25899008,31,0,0,1182,10776832
.fill 48, 4, 0
.long 14067200,14788096,17424384,24,5,0,8237,5427968,29029376,29291520,32653312,8,1,1,17727,13957632
.fill 48, 4, 0
.long 14198272,14591488,17424384,25,2,1,143,5427968,29094912,29357056,32653312,9,1,1,17852,13957632
.fill 48, 4, 0
.long 14263808,14657024,17424384,26,2,1,12,5427968,29160448,29553664,32653312,9,2,0,17855,13957632
.fill 48, 4, 0
.long 14329344,14722560,17424384,26,2,1,15,5427968,29225984,29422592,32653312,10,0,1,3102,13957632
.fill 48, 4, 0
.long 13739008,14459904,17424384,22,4,0,8238,5427712,11641856,12231680,17424384,6,3,0,8238,5427712
.long 32654848,28374528,32653312,0,2,1,9850,13957888
.fill 40, 4, 0
.long 13870080,14197760,17424384,23,1,1,142,5427712,11772928,12100608,17424384,7,1,1,1166,5427712
.long 32654848,28243456,32653312,0,1,1,9850,13957888
.fill 40, 4, 0
.long 13935616,14066688,17424384,23,0,1,143,5427712,11838464,11969536,17424384,7,0,1,1167,5427712
.long 27915776,28505600,32653312,0,3,0,18302,13957888
.fill 40, 4, 0
.long 14001152,14132224,17424384,24,0,1,2060,5427712,11904000,12035072,17424384,8,0,1,3084,5427712
.long 27981312,28308992,32653312,0,2,1,18301,13957888
.fill 40, 4, 0
.long 16098816,16492032,17424384,40,2,1,16700,5427968
.fill 56, 4, 0
.long 16229888,16623104,17424384,41,2,0,16828,5427968
.fill 56, 4, 0
.long 16295424,16688640,17424384,41,2,0,16831,5427968
.fill 56, 4, 0
.long 16360960,16557568,17424384,42,0,1,2078,5427968
.fill 56, 4, 0
.long 4194304,7274496,7856128,32,22,0,16702
.fill 57, 4, 0
.long 4259840,7208960,7856128,32,22,0,16701
.fill 57, 4, 0
.long 4325376,7143424,7856128,33,20,0,16830
.fill 57, 4, 0
.long 4390912,7077888,7856128,33,20,0,16829
.fill 57, 4, 0
.long 31912960,32633856,32653312,30,5,0,8237,13957632,8118272,8773632,10854400,2,4,0,18236,3928064
.fill 48, 4, 0
.long 31978496,32437248,32653312,31,2,1,142,13957632,8183808,8839168,10854400,2,4,0,18239,3928064
.fill 48, 4, 0
.long 32109568,32502784,32653312,32,2,1,12,13957632,8380416,8511488,10854400,4,0,1,3612,3928064
.fill 48, 4, 0
.long 32175104,32568320,32653312,32,2,1,15,13957632,8445952,8577024,10854400,4,0,1,3615,3928064
.fill 48, 4, 0
.long 5505024,6488064,7856128,42,6,0,16702
.fill 57, 4, 0
.long 5570560,6422528,7856128,42,6,0,16701
.fill 57, 4, 0
.long 5636096,6356992,7856128,43,4,0,16830
.fill 57, 4, 0
.long 5701632,6291456,7856128,43,4,0,16829
.fill 57, 4, 0
.long 27342336,27801088,27914240,11,2,0,142,12950272,24305664,24633344,25899008,21,1,2,1182,10776576
.fill 48, 4, 0
.long 27473408,27866624,27914240,12,2,0,8236,12950272,24436736,25092096,25899008,22,4,0,16700,10776576
.fill 48, 4, 0
.long 27538944,27670016,27914240,12,0,1,10287,12950272,24502272,25026560,25899008,22,3,0,17727,10776576
.fill 48, 4, 0
.long 27604480,27735552,27914240,13,0,0,140,12950272,24567808,24961024,25899008,23,2,0,17852,10776576
.fill 48, 4, 0
.long 15311872,15639552,17424384,34,1,1,8238,5427712,21554688,19219968,21553152,0,2,1,9850,9380608
.fill 48, 4, 0
.long 15377408,16032768,17424384,34,4,0,8239,5427712,19023360,19482112,21553152,2,2,0,17214,9380608
.fill 48, 4, 0
.long 15442944,15705088,17424384,35,1,1,140,5427712,19088896,19416576,21553152,2,2,0,18237,9380608
.fill 48, 4, 0
.long 15574016,15770624,17424384,36,0,1,2062,5427712,19154432,19285504,21553152,3,0,0,1692,9380608
.fill 48, 4, 0
.long 13215232,13936128,17424384,18,4,0,8238,5427968,2097664,2425344,7856128,16,1,0,16702,256
.fill 48, 4, 0
.long 13346304,13673984,17424384,19,1,1,142,5427968,2163200,2359808,7856128,16,1,0,17725,256
.fill 48, 4, 0
.long 13411840,13542912,17424384,19,0,1,143,5427968,2228736,2556416,7856128,17,1,0,17854,256
.fill 48, 4, 0
.long 13477376,13608448,17424384,20,0,1,2060,5427968,2294272,2490880,7856128,17,1,0,17853,256
.fill 48, 4, 0
.long 4718592,5373952,7856128,36,4,0,8236,0,27915264,26227712,27914240,0,1,0,8826,12950016
.fill 48, 4, 0
.long 4784128,5439488,7856128,36,4,0,8239,0,25900032,26358784,27914240,0,2,0,17278,12950016
.fill 48, 4, 0
.long 4849664,5242880,7856128,37,2,0,140,0,25965568,26096640,27914240,0,0,1,20351,12950016
.fill 48, 4, 0
.long 4915200,5308416,7856128,37,2,0,143,0,26031104,26162176,27914240,1,0,0,1756,12950016
.fill 48, 4, 0
.long 5505536,5833216,7856128,42,1,0,16702,256
.fill 56, 4, 0
.long 5571072,5767680,7856128,42,1,0,16701,256
.fill 56, 4, 0
.long 5636608,5964288,7856128,43,1,0,16830,256
.fill 56, 4, 0
.long 5702144,5898752,7856128,43,1,0,16829,256
.fill 56, 4, 0
.long 3145728,3538944,7856128,24,2,0,8236,0,1048576,1441792,7856128,8,2,0,8236,0
.long 17490944,18760704,18759680,0,0,1,2645,8712704
.fill 40, 4, 0
.long 3211264,3604480,7856128,24,2,0,8239,0,1114112,1507328,7856128,8,2,0,8239,0
.long 18760704,17556480,18759680,0,0,1,2648,8712704
.fill 40, 4, 0
.long 3276800,3407872,7856128,25,0,0,140,0,1179648,1310720,7856128,9,0,0,1164,0
.long 18760704,17622016,18759680,0,0,1,3674,8712704
.fill 40, 4, 0
.long 3342336,3473408,7856128,25,0,0,143,0,1245184,1376256,7856128,9,0,0,1167,0
.long 17425408,17687552,18759680,0,1,0,1628,8712704
.fill 40, 4, 0
.long 14853632,15508992,17424384,30,4,0,8239,5427968,26359296,26686976,27914240,3,2,0,669,12950272
.fill 48, 4, 0
.long 14919168,15246848,17424384,31,1,1,142,5427968,26424832,26621440,27914240,4,0,1,20286,12950272
.fill 48, 4, 0
.long 14984704,15115776,17424384,31,0,1,143,5427968,26490368,26883584,27914240,4,2,0,18239,12950272
.fill 48, 4, 0
.long 15050240,15181312,17424384,32,0,1,2060,5427968,26555904,26752512,27914240,5,0,0,1694,12950272
.fill 48, 4, 0
.long 2359296,3080192,7856128,18,4,0,8238,0,29488640,30078464,32653312,12,3,0,8238,13957888
.long 32654848,32654848,32653312,0,0,1,3664,13957888
.fill 40, 4, 0
.long 2424832,3014656,7856128,18,4,0,8237,0,29619712,29947392,32653312,13,1,1,142,13957888
.long 32654848,28046848,32653312,0,0,1,3672,13957888
.fill 40, 4, 0
.long 2490368,2949120,7856128,19,2,0,142,0,29685248,29816320,32653312,13,0,1,1167,13957888
.long 32654848,28112384,32653312,0,0,1,3674,13957888
.fill 40, 4, 0
.long 2555904,2883584,7856128,19,2,0,141,0,29750784,29881856,32653312,14,0,1,3084,13957888
.long 32654848,28177920,32653312,0,1,0,1624,13957888
.fill 40, 4, 0
.long 30012416,31126528,32653312,16,7,0,8238,13957632,23191552,24174592,25899008,12,7,0,9277,10776576
.fill 48, 4, 0
.long 30143488,30995456,32653312,17,5,1,142,13957632,23388160,24240128,25899008,14,5,0,17726,10776576
.fill 48, 4, 0
.long 30209024,30929920,32653312,17,5,1,141,13957632,23453696,24371200,25899008,14,6,0,17727,10776576
.fill 48, 4, 0
.long 30340096,30864384,32653312,18,3,1,15,13957632,23519232,24109056,25899008,15,3,1,1182,10776576
.fill 48, 4, 0
.long 23650816,24371712,25899008,16,4,0,8238,10776832,22733312,23192064,25899008,9,2,0,142,10776832
.long 8118784,8643072,10854400,2,3,0,18236,3928320
.fill 40, 4, 0
.long 23716352,24240640,25899008,16,3,0,8239,10776832,22864384,23257600,25899008,10,2,0,9260,10776832
.long 8184320,8708608,10854400,2,3,0,17215,3928320
.fill 40, 4, 0
.long 23781888,24109568,25899008,17,1,1,142,10776832,22929920,23060992,25899008,10,0,1,11311,10776832
.long 8380928,8512000,10854400,4,0,1,3612,3928320
.fill 40, 4, 0
.long 24044032,24175104,25899008,19,0,0,140,10776832,22995456,23126528,25899008,11,0,0,1164,10776832
.long 8446464,8577536,10854400,4,0,1,3615,3928320
.fill 40, 4, 0
.long 15574528,17016320,17424384,36,10,1,16700,5427968
.fill 56, 4, 0
.long 15705600,17147392,17424384,37,10,0,16828,5427968
.fill 56, 4, 0
.long 15771136,17212928,17424384,37,10,0,16831,5427968
.fill 56, 4, 0
.long 15836672,17081856,17424384,38,8,1,30,5427968
.fill 56, 4, 0
.long 24306176,24764928,25899008,21,2,0,142,10776832,12755968,13018112,17424384,14,1,1,17727,5427712
.fill 48, 4, 0
.long 24437248,24896000,25899008,22,2,0,8238,10776832,12821504,13083648,17424384,15,1,1,16828,5427712
.fill 48, 4, 0
.long 24502784,24633856,25899008,22,0,1,10287,10776832,12887040,13411328,17424384,15,3,0,17855,5427712
.fill 48, 4, 0
.long 24568320,24699392,25899008,23,0,0,140,10776832,12952576,13149184,17424384,16,0,1,3102,5427712
.fill 48, 4, 0
.long 31585280,32371712,32653312,28,5,0,8236,13957632,524800,1245696,7856128,4,4,0,18238,256
.fill 48, 4, 0
.long 31650816,32306176,32653312,28,4,1,8239,13957632,590336,1180160,7856128,4,4,0,18237,256
.fill 48, 4, 0
.long 31716352,32044032,32653312,29,1,2,142,13957632,655872,1114624,7856128,5,2,0,18366,256
.fill 48, 4, 0
.long 31847424,32240640,32653312,30,2,1,12,13957632,721408,1049088,7856128,5,2,0,18365,256
.fill 48, 4, 0
.long 13214720,13542400,17424384,18,1,1,8238,5427712,12166144,12690432,17424384,10,3,0,9260,5427712
.long 25899520,22077952,25899008,0,3,0,9848,10776832
.fill 40, 4, 0
.long 13280256,13804544,17424384,18,3,0,8239,5427712,12297216,12624896,17424384,11,1,1,1166,5427712
.long 21553664,22143488,25899008,0,3,0,18302,10776832
.fill 40, 4, 0
.long 13345792,13607936,17424384,19,1,1,140,5427712,12362752,12493824,17424384,11,0,1,1167,5427712
.long 21619200,22274560,25899008,0,4,0,18303,10776832
.fill 40, 4, 0
.long 13476864,13673472,17424384,20,0,1,2062,5427712,12428288,12559360,17424384,12,0,1,3084,5427712
.long 21684736,22012416,25899008,1,1,1,1758,10776832
.fill 40, 4, 0
.long 4194816,6750720,7856128,32,18,0,16702,256
.fill 56, 4, 0
.long 4260352,6685184,7856128,32,18,0,16701,256
.fill 56, 4, 0
.long 4325888,6619648,7856128,33,16,0,16830,256
.fill 56, 4, 0
.long 4391424,6554112,7856128,33,16,0,16829,256
.fill 56, 4, 0
.long 19351040,19744256,21553152,4,2,1,8751,9380608,28440064,28964352,32653312,4,3,0,9772,13957888
.long 30012928,30799360,32653312,16,5,1,17724,13957888
.fill 40, 4, 0
.long 19547648,20006400,21553152,6,2,0,8238,9380608,28571136,28898816,32653312,5,1,1,654,13957888
.long 30144000,30930432,32653312,17,5,1,17852,13957888
.fill 40, 4, 0
.long 19613184,19940864,21553152,6,2,0,8237,9380608,28636672,28767744,32653312,5,0,1,655,13957888
.long 30209536,31258112,32653312,17,7,0,17855,13957888
.fill 40, 4, 0
.long 19678720,19875328,21553152,7,0,0,142,9380608,28702208,28833280,32653312,6,0,1,3084,13957888
.long 30340608,30995968,32653312,18,4,1,1055,13957888
.fill 40, 4, 0
.long 19809280,20333568,21553152,8,3,0,8236,9380352,31060992,31388672,32653312,24,1,1,17726,13957632
.fill 48, 4, 0
.long 20071424,20268032,21553152,10,0,1,10286,9380352,31192064,31781888,32653312,25,3,0,17854,13957632
.fill 48, 4, 0
.long 20136960,20464640,21553152,10,2,0,8237,9380352,31257600,31519744,32653312,25,1,1,16831,13957632
.fill 48, 4, 0
.long 20202496,20399104,21553152,11,0,0,142,9380352,31323136,31454208,32653312,26,0,1,3100,13957632
.fill 48, 4, 0
.long 29029888,29554176,32653312,8,3,0,8239,13957888,18277888,18736640,18759680,6,3,0,9261,8712960
.long 23323136,23585280,25899008,13,1,2,1183,10776832
.fill 40, 4, 0
.long 29095424,29423104,32653312,9,1,1,142,13957888,18343424,18671104,18759680,7,1,1,1166,8712960
.long 23388672,23912960,25899008,14,3,0,17724,10776832
.fill 40, 4, 0
.long 29160960,29292032,32653312,9,0,1,143,13957888,18408960,18540032,18759680,7,0,1,1167,8712960
.long 23454208,23978496,25899008,14,3,0,17727,10776832
.fill 40, 4, 0
.long 29226496,29357568,32653312,10,0,1,2060,13957888,18474496,18605568,18759680,8,0,1,3084,8712960
.long 23519744,23847424,25899008,15,1,1,1182,10776832
.fill 40, 4, 0
.long 15312384,17409536,17424384,34,15,0,16700,5427968
.fill 56, 4, 0
.long 15377920,17344000,17424384,34,14,1,16703,5427968
.fill 56, 4, 0
.long 15443456,17278464,17424384,35,13,1,156,5427968
.fill 56, 4, 0
.long 15640064,16950784,17424384,36,9,2,31,5427968
.fill 56, 4, 0
.fill 9, 4, 2147418112
.long 20858369
.fill 6, 4, 2147418112
.long 3276800
.fill 56, 4, 2147418112
.long 20792833
.fill 6, 4, 2147418112
.long 3342336,2147418112,10986497
.fill 54, 4, 2147418112
.long 20989441
.fill 6, 4, 2147418112
.long 3276800,2147418112,11052033
.fill 54, 4, 2147418112
.long 20923905
.fill 6, 4, 2147418112
.long 3342336,2147418112,11183105
.fill 56, 4, 2147418112
.long 19743745
.fill 63, 4, 2147418112
.long 20005889
.fill 63, 4, 2147418112
.long 19940353
.fill 63, 4, 2147418112
.long 19874817
.fill 58, 4, 2147418112
.long 25223681
.fill 6, 4, 2147418112
.long 2490368,2147418112,12611840,2147418112,8442368
.fill 52, 4, 2147418112
.long 25158145
.fill 6, 4, 2147418112
.long 2555904,2147418112,12677376,2147418112,8507904
.fill 52, 4, 2147418112
.long 25420289
.fill 6, 4, 2147418112
.long 2490368,2147418112,12611840,2147418112,8442368
.fill 52, 4, 2147418112
.long 25289217
.fill 6, 4, 2147418112
.long 2555904,2147418112,12677376,2147418112,8507904
.fill 52, 4, 2147418112
.long 1442048,2147418112,15661568
.fill 4, 4, 2147418112
.long 7787264
.fill 56, 4, 2147418112
.long 1507584,2147418112,15727104
.fill 4, 4, 2147418112
.long 7852800
.fill 56, 4, 2147418112
.long 1442048,2147418112,15661568
.fill 4, 4, 2147418112
.long 7787264
.fill 56, 4, 2147418112
.long 1507584,2147418112,15727104
.fill 4, 4, 2147418112
.long 7852800
.fill 56, 4, 2147418112
.long 31454721
.fill 7, 4, 2147418112
.long 2883584
.fill 55, 4, 2147418112
.long 31716865
.fill 7, 4, 2147418112
.long 2949120
.fill 55, 4, 2147418112
.long 31389185
.fill 7, 4, 2147418112
.long 2883584
.fill 55, 4, 2147418112
.long 31520257
.fill 7, 4, 2147418112
.long 2949120
.fill 57, 4, 2147418112
.long 30077953
.fill 6, 4, 2147418112
.long 3277056,2147418112,26228225
.fill 54, 4, 2147418112
.long 29946881
.fill 6, 4, 2147418112
.long 3342592,2147418112,26293761
.fill 54, 4, 2147418112
.long 29815809
.fill 6, 4, 2147418112
.long 3277056,2147418112,26097153
.fill 54, 4, 2147418112
.long 29881345
.fill 6, 4, 2147418112
.long 3342592,2147418112,26162689
.fill 56, 4, 2147418112
.long 2031617
.fill 6, 4, 2147418112
.long 3407872,2147418112,8053249
.fill 54, 4, 2147418112
.long 1966081
.fill 6, 4, 2147418112
.long 3473408,2147418112,7987713
.fill 54, 4, 2147418112
.long 1900545
.fill 6, 4, 2147418112
.long 3407872,2147418112,8315393
.fill 54, 4, 2147418112
.long 1835009
.fill 6, 4, 2147418112
.long 3473408,2147418112,8249857
.fill 50, 4, 2147418112
.long 25419777
.fill 6, 4, 2147418112
.long 2883840,2147418112,2147418112,8442624
.fill 53, 4, 2147418112
.long 25288705
.fill 6, 4, 2147418112
.long 2949376,2147418112,2147418112,8508160
.fill 53, 4, 2147418112
.long 25223169
.fill 6, 4, 2147418112
.long 2883840,2147418112,2147418112,8442624
.fill 53, 4, 2147418112
.long 25157633
.fill 6, 4, 2147418112
.long 2949376,2147418112,2147418112,8508160
.fill 53, 4, 2147418112
.long 9106176,2147418112,9368320,2147418112,7393792
.fill 4, 4, 2147418112
.long 2752512
.fill 54, 4, 2147418112
.long 9171712,2147418112,9433856,2147418112,7459328
.fill 4, 4, 2147418112
.long 2818048
.fill 54, 4, 2147418112
.long 9106176,2147418112,9368320,2147418112,7393792
.fill 4, 4, 2147418112
.long 2752512
.fill 54, 4, 2147418112
.long 9171712,2147418112,9433856,2147418112,7459328
.fill 4, 4, 2147418112
.long 2818048
.fill 58, 4, 2147418112
.long 9756673
.fill 63, 4, 2147418112
.long 9691137
.fill 63, 4, 2147418112
.long 9625601
.fill 7, 4, 2147418112
.long 18891777
.fill 55, 4, 2147418112
.long 9560065
.fill 7, 4, 2147418112
.long 18957313
.fill 59, 4, 2147418112
.long 393217,2147418112,21946881
.fill 61, 4, 2147418112
.long 458753,2147418112,21881345
.fill 61, 4, 2147418112
.long 262145,2147418112,21815809
.fill 61, 4, 2147418112
.long 327681,2147418112,21750273
.fill 53, 4, 2147418112
.long 22667265,9166849
.fill 62, 4, 2147418112
.long 22798337,9232385
.fill 62, 4, 2147418112
.long 22536193,9035777
.fill 62, 4, 2147418112
.long 22601729,9101313
.fill 63, 4, 2147418112
.long 7000576,2147418112,2147418112,15923968
.fill 6, 4, 2147418112
.long 26686465
.fill 53, 4, 2147418112
.long 7066112,2147418112,2147418112,15989504
.fill 6, 4, 2147418112
.long 26620929
.fill 53, 4, 2147418112
.long 7000576,2147418112,2147418112,15923968
.fill 6, 4, 2147418112
.long 26817537
.fill 53, 4, 2147418112
.long 7066112,2147418112,2147418112,15989504
.fill 6, 4, 2147418112
.long 26752001
.fill 56, 4, 2147418112
.long 21185537
.fill 6, 4, 2147418112
.long 10691072
.fill 56, 4, 2147418112
.long 21382145
.fill 6, 4, 2147418112
.long 10756608
.fill 56, 4, 2147418112
.long 21447681
.fill 6, 4, 2147418112
.long 10691072
.fill 56, 4, 2147418112
.long 21513217
.fill 6, 4, 2147418112
.long 10756608
.fill 52, 4, 2147418112
.long 1441792,2147418112,1703936,2147418112,2147418112,9368064
.fill 5, 4, 2147418112
.long 3145728
.fill 52, 4, 2147418112
.long 1507328,2147418112,1769472,2147418112,2147418112,9433600
.fill 5, 4, 2147418112
.long 3211264
.fill 52, 4, 2147418112
.long 1441792,2147418112,1703936,2147418112,2147418112,9368064
.fill 5, 4, 2147418112
.long 3145728
.fill 52, 4, 2147418112
.long 1507328,2147418112,1769472,2147418112,2147418112,9433600
.fill 5, 4, 2147418112
.long 3211264
.fill 59, 4, 2147418112
.long 393729,10921473
.fill 62, 4, 2147418112
.long 459265,2147418112,10987009
.fill 61, 4, 2147418112
.long 262657,2147418112,11052545
.fill 61, 4, 2147418112
.long 328193,10855937,11183617
.fill 54, 4, 2147418112
.long 5370112,2147418112,7131648,2147418112,2147418112,2097152
.fill 5, 4, 2147418112
.long 12742912
.fill 52, 4, 2147418112
.long 5435648,2147418112,7197184,2147418112,2147418112,2162688
.fill 5, 4, 2147418112
.long 12808448
.fill 52, 4, 2147418112
.long 5370112,2147418112,7131648,2147418112,2147418112,2097152
.fill 5, 4, 2147418112
.long 12742912
.fill 52, 4, 2147418112
.long 5435648,2147418112,7197184,2147418112,2147418112,2162688
.fill 5, 4, 2147418112
.long 12808448
.fill 52, 4, 2147418112
.long 5369856,2147418112,2147418112,1835264,2147418112,2147418112,2147418112,16316928
.fill 56, 4, 2147418112
.long 5435392,2147418112,2147418112,1900800,2147418112,2147418112,2147418112,16382464
.fill 56, 4, 2147418112
.long 5369856,2147418112,2147418112,1835264,2147418112,2147418112,2147418112,16316928
.fill 56, 4, 2147418112
.long 5435392,2147418112,2147418112,1900800,2147418112,2147418112,2147418112,16382464
.fill 56, 4, 2147418112
.long 2818049
.fill 9, 4, 2147418112
.long 3538944
.fill 53, 4, 2147418112
.long 2752513
.fill 9, 4, 2147418112
.long 3604480
.fill 53, 4, 2147418112
.long 2686977
.fill 9, 4, 2147418112
.long 3538944
.fill 53, 4, 2147418112
.long 2621441
.fill 9, 4, 2147418112
.long 3604480
.fill 53, 4, 2147418112
.long 6869760,2147418112,2147418112,7262976,2147418112,2147418112,2147418112,2490624
.fill 56, 4, 2147418112
.long 6935296,2147418112,2147418112,7328512,2147418112,2147418112,2147418112,2556160
.fill 56, 4, 2147418112
.long 6869760,2147418112,2147418112,7262976,2147418112,2147418112,2147418112,2490624
.fill 56, 4, 2147418112
.long 6935296,2147418112,2147418112,7328512,2147418112,2147418112,2147418112,2556160
.fill 56, 4, 2147418112
.long 6869504,2147418112,15661824,2147418112,2147418112,7524864
.fill 5, 4, 2147418112
.long 8311296
.fill 52, 4, 2147418112
.long 6935040,2147418112,15727360,2147418112,2147418112,7590400
.fill 5, 4, 2147418112
.long 8376832
.fill 52, 4, 2147418112
.long 6869504,2147418112,15661824,2147418112,2147418112,7524864
.fill 5, 4, 2147418112
.long 8311296
.fill 52, 4, 2147418112
.long 6935040,2147418112,15727360,2147418112,2147418112,7590400
.fill 5, 4, 2147418112
.long 8376832
.fill 52, 4, 2147418112
.long 12218368,2147418112,2147418112,12611584
.fill 4, 4, 2147418112
.long 7918336
.fill 55, 4, 2147418112
.long 12283904,2147418112,2147418112,12677120
.fill 4, 4, 2147418112
.long 7983872
.fill 55, 4, 2147418112
.long 12218368,2147418112,2147418112,12611584
.fill 4, 4, 2147418112
.long 7918336
.fill 55, 4, 2147418112
.long 12283904,2147418112,2147418112,12677120
.fill 4, 4, 2147418112
.long 7983872
.fill 55, 4, 2147418112
.long 8843776,2147418112,2147418112,9105920,2147418112,16055040
.fill 58, 4, 2147418112
.long 8909312,2147418112,2147418112,9171456,2147418112,16120576
.fill 58, 4, 2147418112
.long 8843776,2147418112,2147418112,9105920,2147418112,16055040
.fill 58, 4, 2147418112
.long 8909312,2147418112,2147418112,9171456,2147418112,16120576
.fill 58, 4, 2147418112
.long 15399424,2147418112,2147418112,15792640
.fill 4, 4, 2147418112
.long 2752768
.fill 55, 4, 2147418112
.long 15464960,2147418112,2147418112,15858176
.fill 4, 4, 2147418112
.long 2818304
.fill 55, 4, 2147418112
.long 15399424,2147418112,2147418112,15792640
.fill 4, 4, 2147418112
.long 2752768
.fill 55, 4, 2147418112
.long 15464960,2147418112,2147418112,15858176
.fill 4, 4, 2147418112
.long 2818304
.fill 62, 4, 2147418112
.long 22667777
.fill 63, 4, 2147418112
.long 22798849
.fill 63, 4, 2147418112
.long 22536705,18892289
.fill 62, 4, 2147418112
.long 22602241,18957825
.fill 57, 4, 2147418112
.long 2949633
.fill 6, 4, 2147418112
.long 3145984,2147418112,2147418112,3801344
.fill 53, 4, 2147418112
.long 2884097
.fill 6, 4, 2147418112
.long 3211520,2147418112,2147418112,3866880
.fill 53, 4, 2147418112
.long 3080705
.fill 6, 4, 2147418112
.long 3145984,2147418112,2147418112,3801344
.fill 53, 4, 2147418112
.long 3015169
.fill 6, 4, 2147418112
.long 3211520,2147418112,2147418112,3866880
.fill 51, 4, 2147418112
.long 12218624,2147418112,2147418112,1835008,2147418112,2147418112,7655936
.fill 6, 4, 2147418112
.long 3670016
.fill 50, 4, 2147418112
.long 12284160,2147418112,2147418112,1900544,2147418112,2147418112,7721472
.fill 6, 4, 2147418112
.long 3735552
.fill 50, 4, 2147418112
.long 12218624,2147418112,2147418112,1835008,2147418112,2147418112,7655936
.fill 6, 4, 2147418112
.long 3670016
.fill 50, 4, 2147418112
.long 12284160,2147418112,2147418112,1900544,2147418112,2147418112,7721472
.fill 6, 4, 2147418112
.long 3735552
.fill 55, 4, 2147418112
.long 28963841,8052737
.fill 62, 4, 2147418112
.long 28898305,7987201
.fill 62, 4, 2147418112
.long 28767233,8314881
.fill 62, 4, 2147418112
.long 28832769,8249345
.fill 57, 4, 2147418112
.long 15399680,2147418112,2147418112,7262720,2147418112,2147418112,16186112
.fill 57, 4, 2147418112
.long 15465216,2147418112,2147418112,7328256,2147418112,2147418112,16251648
.fill 57, 4, 2147418112
.long 15399680,2147418112,2147418112,7262720,2147418112,2147418112,16186112
.fill 57, 4, 2147418112
.long 15465216,2147418112,2147418112,7328256,2147418112,2147418112,16251648
.fill 61, 4, 2147418112
.long 1966336
.fill 4, 4, 2147418112
.long 8049408,2147418112,2147418112,21946369
.fill 55, 4, 2147418112
.long 2031872
.fill 4, 4, 2147418112
.long 8114944,2147418112,2147418112,21880833
.fill 55, 4, 2147418112
.long 1966336
.fill 4, 4, 2147418112
.long 8049408,2147418112,2147418112,21815297
.fill 55, 4, 2147418112
.long 2031872
.fill 4, 4, 2147418112
.long 8114944,2147418112,2147418112,21749761
.fill 52, 4, 2147418112
.long 8974848,2147418112,15792896,2147418112,2147418112,2147418112,2359296
.fill 57, 4, 2147418112
.long 9040384,2147418112,15858432,2147418112,2147418112,2147418112,2424832
.fill 57, 4, 2147418112
.long 8974848,2147418112,15792896,2147418112,2147418112,2147418112,2359296
.fill 57, 4, 2147418112
.long 9040384,2147418112,15858432,2147418112,2147418112,2147418112,2424832
.fill 57, 4, 2147418112
.long 1573120,2147418112,2147418112,7394048
.fill 6, 4, 2147418112
.long 8311552
.fill 53, 4, 2147418112
.long 1638656,2147418112,2147418112,7459584
.fill 6, 4, 2147418112
.long 8377088
.fill 53, 4, 2147418112
.long 1573120,2147418112,2147418112,7394048
.fill 6, 4, 2147418112
.long 8311552
.fill 53, 4, 2147418112
.long 1638656,2147418112,2147418112,7459584
.fill 6, 4, 2147418112
.long 8377088
.fill 54, 4, 2147418112
.long 11707393,18211841
.fill 62, 4, 2147418112
.long 11576321,18146305,17556993
.fill 61, 4, 2147418112
.long 11445249,18015233,17622529
.fill 61, 4, 2147418112
.long 11510785,18080769,17688065
.fill 59, 4, 2147418112
.long 11707905,1442305
.fill 5, 4, 2147418112
.long 22077441
.fill 56, 4, 2147418112
.long 11576833,1507841
.fill 5, 4, 2147418112
.long 22142977
.fill 56, 4, 2147418112
.long 11445761,1311233
.fill 5, 4, 2147418112
.long 22274049
.fill 56, 4, 2147418112
.long 11511297,1376769
.fill 5, 4, 2147418112
.long 22011905
.fill 63, 4, 2147418112
.long 2621440,2147418112,3014656
.fill 61, 4, 2147418112
.long 2686976,2147418112,3080192
.fill 61, 4, 2147418112
.long 2621440,2147418112,3014656
.fill 61, 4, 2147418112
.long 2686976,2147418112,3080192
.fill 55, 4, 2147418112
.long 7000832,2147418112,2147418112,12742656
.fill 6, 4, 2147418112
.long 3408128
.fill 53, 4, 2147418112
.long 7066368,2147418112,2147418112,12808192
.fill 6, 4, 2147418112
.long 3473664
.fill 53, 4, 2147418112
.long 7000832,2147418112,2147418112,12742656
.fill 6, 4, 2147418112
.long 3408128
.fill 53, 4, 2147418112
.long 7066368,2147418112,2147418112,12808192
.fill 6, 4, 2147418112
.long 3473664
.fill 53, 4, 2147418112
.long 18736129,917505
.fill 62, 4, 2147418112
.long 18670593,983041
.fill 62, 4, 2147418112
.long 18539521,786433
.fill 62, 4, 2147418112
.long 18605057,851969
.fill 63, 4, 2147418112
.long 2032129
.fill 6, 4, 2147418112
.long 8180480,2147418112,19219457
.fill 54, 4, 2147418112
.long 1966593
.fill 6, 4, 2147418112
.long 8246016,2147418112,19481601
.fill 54, 4, 2147418112
.long 1901057
.fill 6, 4, 2147418112
.long 8180480,2147418112,19416065
.fill 54, 4, 2147418112
.long 1835521
.fill 6, 4, 2147418112
.long 8246016,2147418112,19284993
.fill 57, 4, 2147418112
.long 2228224,2147418112,7918080,2147418112,8180224,2147418112,2147418112,8573440
.fill 56, 4, 2147418112
.long 2293760,2147418112,7983616,2147418112,8245760,2147418112,2147418112,8638976
.fill 56, 4, 2147418112
.long 2228224,2147418112,7918080,2147418112,8180224,2147418112,2147418112,8573440
.fill 56, 4, 2147418112
.long 2293760,2147418112,7983616,2147418112,8245760,2147418112,2147418112,8638976
.fill 55, 4, 2147418112
.long 15923712,2147418112,2147418112,29291521
.fill 60, 4, 2147418112
.long 15989248,2147418112,2147418112,29357057
.fill 60, 4, 2147418112
.long 15923712,2147418112,2147418112,29553665
.fill 60, 4, 2147418112
.long 15989248,2147418112,2147418112,29422593
.fill 62, 4, 2147418112
.long 12231681
.fill 6, 4, 2147418112
.long 28374529
.fill 56, 4, 2147418112
.long 12100609
.fill 6, 4, 2147418112
.long 28243457
.fill 56, 4, 2147418112
.long 11969537
.fill 6, 4, 2147418112
.long 28505601
.fill 56, 4, 2147418112
.long 12035073
.fill 6, 4, 2147418112
.long 28308993
.fill 51, 4, 2147418112
.long 12349440,2147418112,2147418112,2147418112,2097408
.fill 59, 4, 2147418112
.long 12414976,2147418112,2147418112,2147418112,2162944
.fill 59, 4, 2147418112
.long 12349440,2147418112,2147418112,2147418112,2097408
.fill 59, 4, 2147418112
.long 12414976,2147418112,2147418112,2147418112,2162944
.fill 59, 4, 2147418112
.long 9237248,2147418112,2147418112,9236992,2147418112,2147418112,7787008
.fill 57, 4, 2147418112
.long 9302784,2147418112,2147418112,9302528,2147418112,2147418112,7852544
.fill 57, 4, 2147418112
.long 9237248,2147418112,2147418112,9236992,2147418112,2147418112,7787008
.fill 57, 4, 2147418112
.long 9302784,2147418112,2147418112,9302528,2147418112,2147418112,7852544
.fill 61, 4, 2147418112
.long 7525120
.fill 4, 4, 2147418112
.long 8773633
.fill 58, 4, 2147418112
.long 7590656
.fill 4, 4, 2147418112
.long 8839169
.fill 58, 4, 2147418112
.long 7525120
.fill 4, 4, 2147418112
.long 8511489
.fill 58, 4, 2147418112
.long 7590656
.fill 4, 4, 2147418112
.long 8577025
.fill 54, 4, 2147418112
.long 1572864,2147418112,2147418112,1966080,2147418112,2147418112,16317184
.fill 57, 4, 2147418112
.long 1638400,2147418112,2147418112,2031616,2147418112,2147418112,16382720
.fill 57, 4, 2147418112
.long 1572864,2147418112,2147418112,1966080,2147418112,2147418112,16317184
.fill 57, 4, 2147418112
.long 1638400,2147418112,2147418112,2031616,2147418112,2147418112,16382720
.fill 56, 4, 2147418112
.long 24633345
.fill 7, 4, 2147418112
.long 3014912,2147418112,2147418112,8704768
.fill 52, 4, 2147418112
.long 25092097
.fill 7, 4, 2147418112
.long 3080448,2147418112,2147418112,8770304
.fill 52, 4, 2147418112
.long 25026561
.fill 7, 4, 2147418112
.long 3014912,2147418112,2147418112,8704768
.fill 52, 4, 2147418112
.long 24961025
.fill 7, 4, 2147418112
.long 3080448,2147418112,2147418112,8770304
.fill 53, 4, 2147418112
.long 12349696
.fill 7, 4, 2147418112
.long 12480768,2147418112,2147418112,19219969
.fill 52, 4, 2147418112
.long 12415232
.fill 7, 4, 2147418112
.long 12546304,2147418112,2147418112,19482113
.fill 52, 4, 2147418112
.long 12349696
.fill 7, 4, 2147418112
.long 12480768,2147418112,2147418112,19416577
.fill 52, 4, 2147418112
.long 12415232
.fill 7, 4, 2147418112
.long 12546304,2147418112,2147418112,19285505
.fill 55, 4, 2147418112
.long 2425345
.fill 6, 4, 2147418112
.long 8573696
.fill 56, 4, 2147418112
.long 2359809
.fill 6, 4, 2147418112
.long 8639232
.fill 56, 4, 2147418112
.long 2556417
.fill 6, 4, 2147418112
.long 8573696
.fill 56, 4, 2147418112
.long 2490881
.fill 6, 4, 2147418112
.long 8639232
.fill 53, 4, 2147418112
.long 15530752
.fill 7, 4, 2147418112
.long 8049152,2147418112,2147418112,2147418112,26227713
.fill 51, 4, 2147418112
.long 15596288
.fill 7, 4, 2147418112
.long 8114688,2147418112,2147418112,2147418112,26358785
.fill 51, 4, 2147418112
.long 15530752
.fill 7, 4, 2147418112
.long 8049152,2147418112,2147418112,2147418112,26096641
.fill 51, 4, 2147418112
.long 15596288
.fill 7, 4, 2147418112
.long 8114688,2147418112,2147418112,2147418112,26162177
.fill 51, 4, 2147418112
.long 15530496,2147418112,2147418112,2147418112,12873728
.fill 59, 4, 2147418112
.long 15596032,2147418112,2147418112,2147418112,12939264
.fill 59, 4, 2147418112
.long 15530496,2147418112,2147418112,2147418112,12873728
.fill 59, 4, 2147418112
.long 15596032,2147418112,2147418112,2147418112,12939264
.fill 65, 4, 2147418112
.long 1441793
.fill 63, 4, 2147418112
.long 1507329
.fill 5, 4, 2147418112
.long 17556481
.fill 57, 4, 2147418112
.long 1310721
.fill 5, 4, 2147418112
.long 17622017
.fill 57, 4, 2147418112
.long 1376257
.fill 5, 4, 2147418112
.long 17687553
.fill 55, 4, 2147418112
.long 16054784
.fill 4, 4, 2147418112
.long 26686977
.fill 58, 4, 2147418112
.long 16120320
.fill 4, 4, 2147418112
.long 26621441
.fill 58, 4, 2147418112
.long 16054784
.fill 4, 4, 2147418112
.long 26883585
.fill 58, 4, 2147418112
.long 16120320
.fill 4, 4, 2147418112
.long 26752513
.fill 57, 4, 2147418112
.long 30078465
.fill 6, 4, 2147418112
.long 12873984
.fill 56, 4, 2147418112
.long 29947393
.fill 6, 4, 2147418112
.long 12939520,2147418112,28046849
.fill 54, 4, 2147418112
.long 29816321
.fill 6, 4, 2147418112
.long 12873984,2147418112,28112385
.fill 54, 4, 2147418112
.long 29881857
.fill 6, 4, 2147418112
.long 12939520,2147418112,28177921
.fill 53, 4, 2147418112
.long 24174593
.fill 8, 4, 2147418112
.long 3670272
.fill 54, 4, 2147418112
.long 24240129
.fill 8, 4, 2147418112
.long 3735808
.fill 54, 4, 2147418112
.long 24371201
.fill 8, 4, 2147418112
.long 3670272
.fill 54, 4, 2147418112
.long 24109057
.fill 8, 4, 2147418112
.long 3735808
.fill 54, 4, 2147418112
.long 23192065
.fill 6, 4, 2147418112
.long 8643073
.fill 56, 4, 2147418112
.long 23257601
.fill 6, 4, 2147418112
.long 8708609
.fill 56, 4, 2147418112
.long 23060993
.fill 6, 4, 2147418112
.long 8512001
.fill 56, 4, 2147418112
.long 23126529
.fill 6, 4, 2147418112
.long 8577537
.fill 55, 4, 2147418112
.long 1704192,2147418112,2147418112,2147418112,2228480
.fill 59, 4, 2147418112
.long 1769728,2147418112,2147418112,2147418112,2294016
.fill 59, 4, 2147418112
.long 1704192,2147418112,2147418112,2147418112,2228480
.fill 59, 4, 2147418112
.long 1769728,2147418112,2147418112,2147418112,2294016
.fill 62, 4, 2147418112
.long 13018113
.fill 6, 4, 2147418112
.long 3801088
.fill 56, 4, 2147418112
.long 13083649
.fill 6, 4, 2147418112
.long 3866624
.fill 56, 4, 2147418112
.long 13411329
.fill 6, 4, 2147418112
.long 3801088
.fill 56, 4, 2147418112
.long 13149185
.fill 6, 4, 2147418112
.long 3866624
.fill 57, 4, 2147418112
.long 7656192,2147418112,2147418112,1245697
.fill 60, 4, 2147418112
.long 7721728,2147418112,2147418112,1180161
.fill 60, 4, 2147418112
.long 7656192,2147418112,2147418112,1114625
.fill 60, 4, 2147418112
.long 7721728,2147418112,2147418112,1049089
.fill 58, 4, 2147418112
.long 12690433
.fill 7, 4, 2147418112
.long 22077953
.fill 55, 4, 2147418112
.long 12624897
.fill 7, 4, 2147418112
.long 22143489
.fill 55, 4, 2147418112
.long 12493825
.fill 7, 4, 2147418112
.long 22274561
.fill 55, 4, 2147418112
.long 12559361
.fill 7, 4, 2147418112
.long 22012417
.fill 53, 4, 2147418112
.long 7131904,2147418112,2147418112,2147418112,16185856
.fill 59, 4, 2147418112
.long 7197440,2147418112,2147418112,2147418112,16251392
.fill 59, 4, 2147418112
.long 7131904,2147418112,2147418112,2147418112,16185856
.fill 59, 4, 2147418112
.long 7197440,2147418112,2147418112,2147418112,16251392
.fill 66, 4, 2147418112
.long 13957632,2147418112,8704512
.fill 61, 4, 2147418112
.long 14023168,2147418112,8770048
.fill 61, 4, 2147418112
.long 13957632,2147418112,8704512
.fill 61, 4, 2147418112
.long 14023168,2147418112,8770048
.fill 52, 4, 2147418112
.long 31388673
.fill 5, 4, 2147418112
.long 2621696,2147418112,2147418112,2147418112,3539200
.fill 53, 4, 2147418112
.long 31781889
.fill 5, 4, 2147418112
.long 2687232,2147418112,2147418112,2147418112,3604736
.fill 53, 4, 2147418112
.long 31519745
.fill 5, 4, 2147418112
.long 2621696,2147418112,2147418112,2147418112,3539200
.fill 53, 4, 2147418112
.long 31454209
.fill 5, 4, 2147418112
.long 2687232,2147418112,2147418112,2147418112,3604736
.fill 53, 4, 2147418112
.long 18736641
.fill 5, 4, 2147418112
.long 23585281
.fill 57, 4, 2147418112
.long 18671105
.fill 5, 4, 2147418112
.long 23912961
.fill 57, 4, 2147418112
.long 18540033
.fill 5, 4, 2147418112
.long 23978497
.fill 57, 4, 2147418112
.long 18605569
.fill 5, 4, 2147418112
.long 23847425
.fill 59, 4, 2147418112
.long 12480512,2147418112,2147418112,2147418112,2359552
.fill 59, 4, 2147418112
.long 12546048,2147418112,2147418112,2147418112,2425088
.fill 59, 4, 2147418112
.long 12480512,2147418112,2147418112,2147418112,2359552
.fill 59, 4, 2147418112
.long 12546048,2147418112,2147418112,2147418112,2425088
.fill 51, 4, 2147418112
.size Ltab, 159744
.section .rodata,"a"
.p2align 6
.amdhsa_kernel standalone__ragged_sequences_varlen_flash_attn__ragged_kernel
  .amdhsa_next_free_vgpr 512
  .amdhsa_next_free_sgpr 102
  .amdhsa_accum_offset 256
  .amdhsa_group_segment_fixed_size 0
  .amdhsa_kernarg_size 56
  .amdhsa_user_sgpr_count 2
  .amdhsa_user_sgpr_kernarg_segment_ptr 1
  .amdhsa_system_sgpr_workgroup_id_x 1
.end_amdhsa_kernel
```
